```python
import torch

def _softmax(x, axis=-1):
    return torch.softmax(x, dim=axis)
def _gelu(x):
    return torch.nn.functional.gelu(x, approximate="tanh")
def _silu(x):
    return torch.nn.functional.silu(x)
def _sigmoid(x):
    return torch.sigmoid(x)
def _layernorm(x, axis=-1, eps=1e-5):
    m = x.mean(dim=axis, keepdim=True)
    v = x.var(dim=axis, keepdim=True, unbiased=False)
    return (x - m) / torch.sqrt(v + eps)
def _scatter_add(tgt, idx, src, axis=0):
    return tgt.clone().index_add_(axis, idx, src)
def _segment_sum(src, seg, n):
    out = torch.zeros((n,) + src.shape[1:], dtype=src.dtype)
    return out.index_add_(0, seg, src)
def _pad(x, pw):
    flat = tuple(v for pair in reversed(pw) for v in pair)
    return torch.nn.functional.pad(x, flat)

kernel_name = 'concat_heads__linear_kernel_hedgehog__sliding_block__prompt'

def setup_inputs():

    _w = (lambda a: (lambda t: t.to(torch.bfloat16) if t.is_floating_point() else t)(torch.as_tensor(a)))
    def _A_setup():
        B, S, D, H = 1, 2048, 640, 32
        Dh = D // H
        return {
            "x": _w((lambda *s: torch.randn(*s, dtype=torch.bfloat16) * 0.4)(B, S, D)),
            "wqkv": _w((lambda *s: torch.randn(*s, dtype=torch.bfloat16) * 1.6)(D, 3 * D)),
            "w_phi": _w((lambda *s: torch.randn(*s, dtype=torch.bfloat16) * 1.6)(H, Dh, Dh) * (Dh ** -0.5)),
            "wo": _w((lambda *s: torch.randn(*s, dtype=torch.bfloat16) * 0.2)(D, D)),
        }
    _A_in = _A_setup()

    def _B_setup():
        B, S, D = 1, 2048, 640
        return {
            "x": _w((lambda *s: torch.randn(*s, dtype=torch.bfloat16) * 0.2)(B, S, D)),
            "wqkv": _w((lambda *s: torch.randn(*s, dtype=torch.bfloat16) * 0.4)(D, 3 * D)),
            "wo": _w((lambda *s: torch.randn(*s, dtype=torch.bfloat16) * 0.2)(D, D)),
        }
    _B_in = _B_setup()

    return {
        "A_x": _A_in["x"],
        "A_wqkv": _A_in["wqkv"],
        "A_w_phi": _A_in["w_phi"],
        "A_wo": _A_in["wo"],
        "B_x": _B_in["x"],
        "B_wqkv": _B_in["wqkv"],
        "B_wo": _B_in["wo"],
    }

def reference(A_x, A_wqkv, A_w_phi, A_wo, B_x, B_wqkv, B_wo):
    def _A_ref(x, wqkv, w_phi, wo):
        B, S, D = x.shape
        H = 32; Dh = D // H
        qkv = (lambda x, *d: x.permute(*d))((x @ wqkv).reshape(B, S, 3, H, Dh), 2, 0, 3, 1, 4)
        q, k, v = qkv[0], qkv[1], qkv[2]
        pq = torch.einsum("bhsd,hdf->bhsf", q, w_phi)
        pk = torch.einsum("bhsd,hdf->bhsf", k, w_phi)
        phi_q = torch.concatenate([_softmax(pq, axis=-1), _softmax(-pq, axis=-1)], axis=-1)
        phi_k = torch.concatenate([_softmax(pk, axis=-1), _softmax(-pk, axis=-1)], axis=-1)
        kv = torch.einsum("bhsf,bhsd->bhfd", phi_k, v)
        z  = torch.einsum("bhsf->bhf", phi_k)
        num = torch.einsum("bhqf,bhfd->bhqd", phi_q, kv)
        den = torch.einsum("bhqf,bhf->bhq", phi_q, z)[..., None] + 1e-6
        o = num / den
        return (lambda x, *d: x.permute(*d))(o, 0, 2, 1, 3).reshape(B, S, D) @ wo

    def _B_ref(x, wqkv, wo):
        B, S, D = x.shape
        H = 32; Dh = D // H; W = 256
        qkv = (lambda x, *d: x.permute(*d))((x @ wqkv).reshape(B, S, 3, H, Dh), 2, 0, 3, 1, 4)
        q, k, v = qkv[0], qkv[1], qkv[2]
        scores = torch.einsum("bhqd,bhkd->bhqk", q, k) * (Dh ** -0.5)
        idx = torch.arange(S)
        mask = (idx[:, None] - idx[None, :] >= 0) & (idx[:, None] - idx[None, :] < W)
        scores = torch.where(mask[None, None], scores, -1e9)
        p = _softmax(scores, axis=-1)
        o = torch.einsum("bhqk,bhkd->bhqd", p, v)
        return (lambda x, *d: x.permute(*d))(o, 0, 2, 1, 3).reshape(B, S, D) @ wo

    a = _A_ref(A_x, A_wqkv, A_w_phi, A_wo)
    b = _B_ref(B_x, B_wqkv, B_wo)
    return torch.concatenate([a, b], axis=-1)
```

```asm
; @launch kernel=g_kernel grid=(256,1,1) block=(512,1,1) lds=163840
.amdgcn_target "amdgcn-amd-amdhsa--gfx950"
.text
.globl g_kernel
.p2align 8
.type g_kernel,@function
g_kernel:
    s_cmp_ge_u32 s2, 256
    s_cbranch_scc1 L_g_exit
    s_getpc_b64 s[100:101]
L_g_pc:
    s_and_b32 s46, s2, 7
    s_lshr_b32 s37, s46, 2
    s_xor_b32 s37, s37, 1
    s_lshl_b32 s47, s37, 5
    s_load_dwordx4 s[48:51], s[0:1], s47
    s_load_dwordx4 s[52:55], s[0:1], 64
    s_mul_i32 s47, s37, 24
    s_load_dwordx2 s[20:21], s[0:1], 56
    s_load_dwordx2 s[28:29], s[0:1], 16
    s_load_dwordx2 s[16:17], s[0:1], s47 offset:24
    v_lshrrev_b32 v1, 6, v0
    v_and_b32 v0, 63, v0
    v_readfirstlane_b32 s36, v1
    s_and_b32 s3, s2, 0xf8
    s_add_u32 s3, s3, s36
    s_mul_i32 s3, s3, 256
    s_add_u32 s3, s3, 768-(L_g_pc-g_kernel)
    s_cmp_ge_u32 s3, L_pfend-L_g_pc
    s_cbranch_scc1 L_pfretx
    s_add_u32 s100, s100, s3
    s_addc_u32 s101, s101, 0
    s_mov_b64 exec, 0
    s_setpc_b64 s[100:101]
L_pfret:
    s_mov_b64 exec, -1
L_pfretx:
    s_lshr_b32 s47, s2, 3
    s_and_b32 s38, s46, 3
    s_lshl_b32 s38, s38, 2
    s_and_b32 s39, s47, 3
    s_add_u32 s38, s38, s39
    s_lshr_b32 s39, s47, 2
    s_and_b32 s0, s38, 12
    s_lshr_b32 s0, 0x6420, s0
    s_and_b32 s0, s0, 15
    s_lshl_b32 s1, s0, 7
    s_mul_i32 s0, s0, 245760
    s_and_b32 s40, s36, 3
    s_lshr_b32 s41, s36, 2
    v_lshrrev_b32 v49, 4, v0
    s_mov_b32 s6, 2621440
    s_mov_b32 s7, 0x00020000
    s_mov_b32 s10, 2457600
    s_mov_b32 s11, 0x00020000
    s_mov_b32 s14, 0x10000000
    s_nop 0
    s_cbranch_execz L_pfret
    s_mov_b32 s15, 0x00020000
    s_lshl_b32 s42, s37, 4
    s_add_u32 s42, s42, s38
    s_lshl_b32 s42, s42, 3
    s_add_u32 s42, s42, s39
    s_lshl_b32 s64, s42, 10
    s_add_u32 s64, s64, 14680064
    s_cmp_eq_u32 s36, 0
    s_cselect_b32 s66, 0, 0x40000000
    v_mov_b32 v248, s66
    v_mov_b64 v[156:157], 0
    v_mov_b64 v[158:159], 0
    v_lshl_add_u32 v160, v0, 4, v248
    s_and_b32 s46, s2, 0xf8
    s_add_u32 s46, s46, s36
    s_mov_b32 s47, 0
    v_lshlrev_b32 v56, 7, v0
    v_mov_b32 v58, 0x7ff00000
    v_cmp_gt_u32 vcc, 10, v0
    s_nop 1
    v_cndmask_b32 v59, v58, v56, vcc
    s_lshr_b32 s98, s46, 1
    s_mul_i32 s98, s98, 1280
    s_mul_i32 s99, s46, 1280
    s_add_u32 s99, s99, s47
    s_add_u32 s98, s98, s99
    v_add_u32 v133, s98, v59
    s_lshr_b32 s98, s38, 2
    s_lshl_b32 s98, s98, 8
    s_add_u32 s98, s98, s46
    s_mul_i32 s98, s98, 2560
    v_lshrrev_b32 v57, 1, v0
    v_mul_u32_u24 v57, 1024, v57
    v_add3_u32 v132, v57, v56, s98
    v_cmp_gt_u32 vcc, 4, v0
    s_nop 1
    v_cndmask_b32 v132, v58, v132, vcc
    s_waitcnt lgkmcnt(0)
    s_mov_b32 s4, s48
    s_and_b32 s5, s49, 0xffff
    s_mov_b32 s8, s50
    s_and_b32 s9, s51, 0xffff
    s_add_u32 s56, s0, 0
    buffer_load_dword v137, v133, s[8:11], s56 offen offset:1280
    s_add_u32 s56, s1, 0
    buffer_load_dword v136, v132, s[4:7], s56 offen offset:0
    s_mov_b32 s12, s54
    s_and_b32 s13, s55, 0xffff
    s_cbranch_execz L_pfret
    buffer_store_dwordx4 v[156:159], v160, s[12:15], s64 offen sc1
    v_add_u32 v135, s99, v59
    s_mul_i32 s98, s46, 3840
    s_add_u32 s98, s98, s47
    v_mov_b32 v134, v59
    s_cmp_lg_u32 s41, 0
    s_nop 0
    s_cbranch_scc1 L_g_vpro
    s_mul_i32 s77, s39, 160
    s_mul_i32 s44, s40, 2560
    s_mul_i32 s76, s40, 30720
    s_add_u32 s76, s76, s0
    s_mul_i32 s43, s40, 5120
    s_mul_i32 s45, s40, 61440
    s_add_u32 s45, s45, s0
    s_and_b32 s46, s39, s37
    s_mul_i32 s46, s46, 1120
    s_add_u32 s77, s77, s46
    s_cmp_eq_u32 s37, 0
    s_cselect_b32 s47, 1120, 0
    s_add_u32 s46, s47, 160
    v_mul_u32_u24 v48, 205, v0
    v_lshrrev_b32 v48, 12, v48
    v_mul_u32_u24 v50, 20, v48
    v_sub_u32 v50, v0, v50
    v_mul_u32_u24 v51, 3840, v48
    v_lshl_add_u32 v249, v50, 4, v51
    v_mul_u32_u24 v50, 26, v50
    v_lshrrev_b32 v50, 8, v50
    v_mad_u32_u24 v249, v50, s47, v249
    v_add_u32 v249, s77, v249
    v_add_u32 v51, 64, v0
    v_mul_u32_u24 v48, 205, v51
    v_lshrrev_b32 v48, 12, v48
    v_mul_u32_u24 v50, 20, v48
    v_sub_u32 v50, v51, v50
    v_mul_u32_u24 v51, 3840, v48
    v_lshl_add_u32 v250, v50, 4, v51
    v_mul_u32_u24 v50, 26, v50
    v_lshrrev_b32 v50, 8, v50
    v_mad_u32_u24 v250, v50, s47, v250
    v_add_u32 v250, -1024, v250
    v_add_u32 v250, s77, v250
    s_nop 0
    s_cbranch_execz L_pfret
    v_add_u32 v51, 128, v0
    v_mul_u32_u24 v48, 205, v51
    v_lshrrev_b32 v48, 12, v48
    v_mul_u32_u24 v50, 20, v48
    v_sub_u32 v50, v51, v50
    v_mul_u32_u24 v51, 3840, v48
    v_lshl_add_u32 v251, v50, 4, v51
    v_mul_u32_u24 v50, 26, v50
    v_lshrrev_b32 v50, 8, v50
    v_mul_u32_u24 v51, 160, v50
    v_sub_u32 v251, v251, v51
    v_lshrrev_b32 v48, 3, v48
    v_xor_b32 v50, v48, v50
    v_mul_u32_u24 v50, s46, v50
    v_add_u32 v50, -2048, v50
    v_add3_u32 v251, v251, v50, s77
    v_add_u32 v51, 192, v0
    v_mul_u32_u24 v48, 205, v51
    v_lshrrev_b32 v48, 12, v48
    v_mul_u32_u24 v50, 20, v48
    v_sub_u32 v50, v51, v50
    v_mul_u32_u24 v51, 3840, v48
    v_lshl_add_u32 v252, v50, 4, v51
    v_mul_u32_u24 v50, 26, v50
    v_lshrrev_b32 v50, 8, v50
    v_mul_u32_u24 v51, 160, v50
    v_sub_u32 v252, v252, v51
    v_lshrrev_b32 v48, 3, v48
    v_xor_b32 v50, v48, v50
    v_mul_u32_u24 v50, s46, v50
    v_add_u32 v50, -3072, v50
    v_add3_u32 v252, v252, v50, s77
    v_add_u32 v51, 256, v0
    v_mul_u32_u24 v48, 205, v51
    v_lshrrev_b32 v48, 12, v48
    v_mul_u32_u24 v50, 20, v48
    v_sub_u32 v50, v51, v50
    v_mul_u32_u24 v51, 3840, v48
    v_lshl_add_u32 v253, v50, 4, v51
    v_mul_u32_u24 v50, 26, v50
    v_lshrrev_b32 v50, 8, v50
    v_mul_u32_u24 v51, 160, v50
    v_sub_u32 v253, v253, v51
    v_lshrrev_b32 v48, 3, v48
    s_cbranch_execz L_pfret
    v_xor_b32 v50, v48, v50
    v_mul_u32_u24 v50, s46, v50
    v_add_u32 v50, -4096, v50
    v_add3_u32 v253, v253, v50, s77
    s_add_u32 m0, s43, 0
    s_add_u32 s57, s45, 1280
    buffer_load_dwordx4 v249, s[8:11], s57 offen offset:0 lds
    buffer_load_dwordx4 v250, s[8:11], s57 offen offset:1024 lds
    buffer_load_dwordx4 v251, s[8:11], s57 offen offset:2048 lds
    buffer_load_dwordx4 v252, s[8:11], s57 offen offset:3072 lds
    s_add_u32 m0, s43, 1024
    s_add_u32 s57, s45, 2304
    buffer_load_dwordx4 v253, s[8:11], s57 offen offset:3072 lds
    s_add_u32 s56, s0, 491520
    buffer_load_dword v139, v133, s[8:11], s56 offen offset:1280
    s_add_u32 s56, s1, 256
    buffer_load_dword v138, v132, s[4:7], s56 offen offset:0
    v_and_b32 v48, 15, v0
    v_bfe_u32 v50, v0, 1, 3
    v_xor_b32 v50, v50, v49
    s_lshl_b32 s46, s40, 12
    v_lshlrev_b32 v51, 7, v48
    v_lshl_add_u32 v51, v50, 4, v51
    v_add_u32 v6, s46, v51
    v_xor_b32 v7, 64, v6
    v_bfe_u32 v50, v0, 2, 2
    v_bfe_u32 v51, v0, 4, 1
    v_lshl_add_u32 v50, v49, 3, v50
    v_lshl_add_u32 v50, v50, 1, v51
    v_and_b32 v53, 3, v0
    v_mad_u32_u24 v54, v53, 40, 32
    v_lshlrev_b32 v53, 3, v53
    s_movk_i32 s46, 160
    v_mad_u32_u24 v14, v50, s46, v53
    v_mad_u32_u24 v15, v50, s46, v54
    s_and_b32 s46, s37, s39
    s_cbranch_scc0 L_g_own0
    s_add_u32 m0, s43, 122880
    s_nop 0
    s_cbranch_execz L_pfret
    s_add_u32 s57, s45, 247040
    buffer_load_dwordx4 v249, s[8:11], s57 offen offset:0 lds
    buffer_load_dwordx4 v250, s[8:11], s57 offen offset:1024 lds
    buffer_load_dwordx4 v251, s[8:11], s57 offen offset:2048 lds
    buffer_load_dwordx4 v252, s[8:11], s57 offen offset:3072 lds
    s_add_u32 m0, s43, 123904
    s_add_u32 s57, s45, 248064
    buffer_load_dwordx4 v253, s[8:11], s57 offen offset:3072 lds
    s_waitcnt vmcnt(7)
    s_barrier
    ds_read_b128 v[168:171], v6 offset:20480
    ds_read_b64_tr_b16 v[48:49], v14 offset:0
    ds_read_b64_tr_b16 v[50:51], v14 offset:1280
    ds_read_b128 v[172:175], v6 offset:22528
    ds_read_b64_tr_b16 v[52:53], v14 offset:40
    ds_read_b64_tr_b16 v[54:55], v14 offset:1320
    ds_read_b64_tr_b16 v[56:57], v14 offset:80
    ds_read_b64_tr_b16 v[58:59], v14 offset:1360
    ds_read_b64_tr_b16 v[60:61], v14 offset:120
    ds_read_b64_tr_b16 v[62:63], v14 offset:1400
    ds_read_b64_tr_b16 v[64:65], v15 offset:0
    ds_read_b64_tr_b16 v[66:67], v15 offset:1280
    s_waitcnt lgkmcnt(9)
    v_mfma_f32_16x16x32_bf16 v[88:91], v[168:171], v[48:51], 0
    ds_read_b128 v[40:43], v7 offset:20480
    ds_read_b64_tr_b16 v[68:69], v14 offset:10240
    s_waitcnt lgkmcnt(10)
    v_mfma_f32_16x16x32_bf16 v[92:95], v[172:175], v[48:51], 0
    ds_read_b64_tr_b16 v[70:71], v14 offset:11520
    ds_read_b128 v[44:47], v7 offset:22528
    v_add_u32 v22, 98304, v14
    v_add_u32 v23, 98304, v15
    v_add_u32 v8, 49152, v6
    s_waitcnt lgkmcnt(10)
    s_cbranch_execz L_pfret
    v_mfma_f32_16x16x32_bf16 v[96:99], v[168:171], v[52:55], 0
    ds_read_b64_tr_b16 v[72:73], v14 offset:10280
    ds_read_b64_tr_b16 v[74:75], v14 offset:11560
    v_add_u32 v9, 49152, v7
    s_getreg_b32 s3, hwreg(HW_REG_XCC_ID, 0, 3)
    s_or_b32 s3, s3, 8
    v_mfma_f32_16x16x32_bf16 v[100:103], v[172:175], v[52:55], 0
    ds_read_b64_tr_b16 v[76:77], v14 offset:10320
    ds_read_b64_tr_b16 v[78:79], v14 offset:11600
    v_lshlrev_b32 v1, 4, v0
    v_and_b32 v158, 15, v0
    v_lshrrev_b32 v159, 4, v0
    s_waitcnt lgkmcnt(12)
    v_mfma_f32_16x16x32_bf16 v[104:107], v[168:171], v[56:59], 0
    ds_read_b64_tr_b16 v[80:81], v14 offset:10360
    ds_read_b64_tr_b16 v[82:83], v14 offset:11640
    s_mov_b32 s24, s52
    s_and_b32 s25, s53, 0xffff
    s_mov_b32 s26, 256
    v_mfma_f32_16x16x32_bf16 v[108:111], v[172:175], v[56:59], 0
    ds_read_b64_tr_b16 v[84:85], v15 offset:10240
    ds_read_b64_tr_b16 v[86:87], v15 offset:11520
    s_mov_b32 s27, 0x00020000
    s_mov_b32 s32, s54
    s_and_b32 s33, s55, 0xffff
    s_waitcnt lgkmcnt(14)
    v_mfma_f32_16x16x32_bf16 v[112:115], v[168:171], v[60:63], 0
    s_add_u32 m0, s43, 143360
    s_add_u32 s57, s45, 492800
    buffer_load_dwordx4 v249, s[8:11], s57 offen offset:0 lds
    s_lshl_b32 s34, s37, 28
    s_mov_b32 s35, 0x00020000
    s_mul_i32 s46, s40, 10240
    v_mfma_f32_16x16x32_bf16 v[116:119], v[172:175], v[60:63], 0
    buffer_load_dwordx4 v250, s[8:11], s57 offen offset:1024 lds
    v_add_u32 v160, s46, v1
    s_lshl_b32 s47, s41, 11
    v_add_u32 v10, s47, v160
    s_cbranch_execz L_pfret
    s_waitcnt lgkmcnt(12)
    v_mfma_f32_16x16x32_bf16 v[120:123], v[168:171], v[64:67], 0
    buffer_load_dwordx4 v251, s[8:11], s57 offen offset:2048 lds
    v_add_u32 v11, 40960, v10
    v_add_u32 v12, 4096, v160
    v_add_u32 v13, 45056, v160
    v_mfma_f32_16x16x32_bf16 v[124:127], v[172:175], v[64:67], 0
    buffer_load_dwordx4 v252, s[8:11], s57 offen offset:3072 lds
    s_mul_i32 s48, s41, 5120
    s_add_u32 s48, s48, 81920
    v_add_u32 v28, s48, v160
    s_add_u32 m0, s43, 144384
    s_add_u32 s57, s45, 493824
    buffer_load_dwordx4 v253, s[8:11], s57 offen offset:3072 lds
    s_add_u32 s56, s0, 983040
    s_sub_u32 s57, s56, 2457600
    s_min_u32 s56, s56, s57
    buffer_load_dword v141, v133, s[8:11], s56 offen offset:1280
    s_add_u32 s56, s1, 512
    s_sub_u32 s57, s56, 1280
    s_min_u32 s56, s56, s57
    buffer_load_dword v140, v132, s[4:7], s56 offen offset:0
    s_lshl_b32 s56, s39, 4
    s_add_u32 s56, s56, s38
    s_lshl_b32 s56, s56, 3
    s_add_u32 s56, s56, s36
    s_lshl_b32 s56, s56, 10
    s_add_u32 s56, s56, 12582912
    v_mov_b64 v[240:241], -1
    v_mov_b64 v[242:243], -1
    v_lshlrev_b32 v244, 4, v0
    v_lshl_add_u32 v244, s37, 30, v244
    buffer_store_dwordx4 v[240:243], v244, s[12:15], s56 offen sc1
    s_waitcnt vmcnt(8) lgkmcnt(0)
    s_barrier
    v_mfma_f32_16x16x32_bf16 v[88:91], v[40:43], v[68:71], v[88:91]
    ds_read_b128 v[176:179], v6 offset:36864
    ds_read_b64_tr_b16 v[48:49], v22 offset:24576
    s_nop 0
    s_cbranch_execz L_pfret
    v_mfma_f32_16x16x32_bf16 v[92:95], v[44:47], v[68:71], v[92:95]
    ds_read_b64_tr_b16 v[50:51], v22 offset:25856
    ds_read_b128 v[180:183], v6 offset:38912
    v_and_b32 v161, 31, v0
    v_lshrrev_b32 v162, 5, v0
    v_lshlrev_b32 v163, 4, v161
    v_mfma_f32_16x16x32_bf16 v[96:99], v[40:43], v[72:75], v[96:99]
    ds_read_b64_tr_b16 v[52:53], v22 offset:24616
    ds_read_b64_tr_b16 v[54:55], v22 offset:25896
    v_lshl_add_u32 v163, v162, 8, v163
    s_add_u32 s46, s46, 5120
    v_add_u32 v163, s46, v163
    v_mfma_f32_16x16x32_bf16 v[100:103], v[44:47], v[72:75], v[100:103]
    ds_read_b64_tr_b16 v[56:57], v22 offset:24656
    ds_read_b64_tr_b16 v[58:59], v22 offset:25936
    v_cmp_gt_u32 vcc, 16, v161
    s_lshl_b32 s48, s41, 7
    s_add_u32 s46, s47, 0
    v_mfma_f32_16x16x32_bf16 v[104:107], v[40:43], v[76:79], v[104:107]
    ds_read_b64_tr_b16 v[60:61], v22 offset:24696
    ds_read_b64_tr_b16 v[62:63], v22 offset:25976
    s_add_u32 s49, s48, 3840
    v_mov_b32 v164, s49
    v_mov_b32 v165, s46
    v_mfma_f32_16x16x32_bf16 v[108:111], v[44:47], v[76:79], v[108:111]
    ds_read_b64_tr_b16 v[64:65], v23 offset:24576
    ds_read_b64_tr_b16 v[66:67], v23 offset:25856
    v_cndmask_b32 v164, v164, v165, vcc
    v_add_u32 v18, v163, v164
    v_add_u32 v19, 40960, v18
    v_mfma_f32_16x16x32_bf16 v[112:115], v[40:43], v[80:83], v[112:115]
    s_add_u32 m0, s43, 0
    s_add_u32 s57, s45, 738560
    buffer_load_dwordx4 v249, s[8:11], s57 offen offset:0 lds
    s_add_u32 s46, s47, 1024
    s_add_u32 s49, s48, 3904
    v_mov_b32 v164, s49
    v_mfma_f32_16x16x32_bf16 v[116:119], v[44:47], v[80:83], v[116:119]
    s_cbranch_execz L_pfret
    buffer_load_dwordx4 v250, s[8:11], s57 offen offset:1024 lds
    v_mov_b32 v165, s46
    v_cndmask_b32 v164, v164, v165, vcc
    v_add_u32 v20, v163, v164
    v_mfma_f32_16x16x32_bf16 v[120:123], v[40:43], v[84:87], v[120:123]
    buffer_load_dwordx4 v251, s[8:11], s57 offen offset:2048 lds
    v_add_u32 v21, 40960, v20
    s_mul_i32 s46, s36, 5120
    s_add_u32 s47, s46, 122880
    v_mfma_f32_16x16x32_bf16 v[124:127], v[44:47], v[84:87], v[124:127]
    buffer_load_dwordx4 v252, s[8:11], s57 offen offset:3072 lds
    v_add_u32 v26, s47, v1
    s_sub_u32 s47, 158720, s46
    v_add_u32 v27, s47, v1
    s_waitcnt lgkmcnt(9)
    v_mfma_f32_16x16x32_bf16 v[88:91], v[176:179], v[48:51], v[88:91]
    ds_read_b128 v[40:43], v7 offset:36864
    ds_read_b64_tr_b16 v[68:69], v22 offset:34816
    s_waitcnt lgkmcnt(10)
    v_mfma_f32_16x16x32_bf16 v[92:95], v[180:183], v[48:51], v[92:95]
    ds_read_b64_tr_b16 v[70:71], v22 offset:36096
    ds_read_b128 v[44:47], v7 offset:38912
    v_bfe_u32 v164, v0, 4, 1
    v_mul_u32_u24 v165, 20480, v164
    v_lshl_add_u32 v165, v158, 4, v165
    s_waitcnt lgkmcnt(10)
    v_mfma_f32_16x16x32_bf16 v[96:99], v[176:179], v[52:55], v[96:99]
    ds_read_b64_tr_b16 v[72:73], v22 offset:34856
    ds_read_b64_tr_b16 v[74:75], v22 offset:36136
    v_lshl_add_u32 v29, v162, 8, v165
    s_sub_u32 s46, s42, s39
    s_lshl_b32 s47, s40, 1
    v_mfma_f32_16x16x32_bf16 v[100:103], v[180:183], v[52:55], v[100:103]
    ds_read_b64_tr_b16 v[76:77], v22 offset:34896
    ds_read_b64_tr_b16 v[78:79], v22 offset:36176
    s_add_u32 s46, s46, s47
    s_mul_i32 s46, s46, 20480
    s_cbranch_execz L_pfret
    s_add_u32 s46, s46, 6291456
    s_waitcnt lgkmcnt(12)
    v_mfma_f32_16x16x32_bf16 v[104:107], v[176:179], v[56:59], v[104:107]
    ds_read_b64_tr_b16 v[80:81], v22 offset:34936
    ds_read_b64_tr_b16 v[82:83], v22 offset:36216
    s_lshl_b32 s47, s40, 5
    s_add_u32 s47, s47, s41
    s_lshl_b32 s47, s47, 2
    v_mfma_f32_16x16x32_bf16 v[108:111], v[180:183], v[56:59], v[108:111]
    ds_read_b64_tr_b16 v[84:85], v23 offset:34816
    ds_read_b64_tr_b16 v[86:87], v23 offset:36096
    s_add_u32 s75, s64, s47
    s_lshr_b32 s72, s39, 1
    s_mul_i32 s48, s72, 5120
    s_waitcnt lgkmcnt(14)
    v_mfma_f32_16x16x32_bf16 v[112:115], v[176:179], v[60:63], v[112:115]
    s_add_u32 m0, s43, 1024
    s_add_u32 s57, s45, 739584
    buffer_load_dwordx4 v253, s[8:11], s57 offen offset:3072 lds
    s_add_u32 s46, s46, s48
    s_and_b32 s47, s39, 1
    s_lshl_b32 s47, s47, 1
    v_mfma_f32_16x16x32_bf16 v[116:119], v[180:183], v[60:63], v[116:119]
    s_add_u32 s56, s0, 1474560
    s_sub_u32 s57, s56, 2457600
    s_min_u32 s56, s56, s57
    buffer_load_dword v143, v133, s[8:11], s56 offen offset:1280
    s_add_u32 s47, s47, s41
    s_lshl_b32 s48, s47, 10
    s_add_u32 s73, s46, s48
    s_waitcnt lgkmcnt(12)
    v_mfma_f32_16x16x32_bf16 v[120:123], v[176:179], v[64:67], v[120:123]
    s_add_u32 s56, s1, 768
    s_sub_u32 s57, s56, 1280
    s_min_u32 s56, s56, s57
    buffer_load_dword v142, v132, s[4:7], s56 offen offset:0
    s_lshl_b32 s48, s47, 8
    s_add_u32 s74, s46, s48
    s_add_u32 s74, s74, 4096
    v_mfma_f32_16x16x32_bf16 v[124:127], v[180:183], v[64:67], v[124:127]
    s_nop 0
    s_cbranch_execz L_pfret
    s_mul_i32 s47, s39, 160
    v_mul_u32_u24 v166, 205, v0
    v_lshrrev_b32 v166, 11, v166
    s_waitcnt vmcnt(10) lgkmcnt(0)
    s_barrier
    v_mfma_f32_16x16x32_bf16 v[88:91], v[40:43], v[68:71], v[88:91]
    ds_read_b128 v[184:187], v8 offset:4096
    ds_read_b64_tr_b16 v[48:49], v22 offset:45056
    v_mfma_f32_16x16x32_bf16 v[92:95], v[44:47], v[68:71], v[92:95]
    ds_read_b64_tr_b16 v[50:51], v22 offset:46336
    ds_read_b128 v[188:191], v8 offset:6144
    v_mul_u32_u24 v166, 1120, v166
    v_add3_u32 v30, v166, v1, s47
    v_add_u32 v165, 64, v0
    v_mfma_f32_16x16x32_bf16 v[96:99], v[40:43], v[72:75], v[96:99]
    ds_read_b64_tr_b16 v[52:53], v22 offset:45096
    ds_read_b64_tr_b16 v[54:55], v22 offset:46376
    v_mul_u32_u24 v166, 205, v165
    v_lshrrev_b32 v166, 11, v166
    v_mul_u32_u24 v166, 1120, v166
    v_mfma_f32_16x16x32_bf16 v[100:103], v[44:47], v[72:75], v[100:103]
    ds_read_b64_tr_b16 v[56:57], v22 offset:45136
    ds_read_b64_tr_b16 v[58:59], v22 offset:46416
    v_add3_u32 v31, v166, v1, s47
    v_add_u32 v165, 128, v0
    v_mul_u32_u24 v166, 205, v165
    v_mfma_f32_16x16x32_bf16 v[104:107], v[40:43], v[76:79], v[104:107]
    ds_read_b64_tr_b16 v[60:61], v22 offset:45176
    ds_read_b64_tr_b16 v[62:63], v22 offset:46456
    v_lshrrev_b32 v166, 11, v166
    v_mul_u32_u24 v166, 1120, v166
    v_add3_u32 v32, v166, v1, s47
    v_mfma_f32_16x16x32_bf16 v[108:111], v[44:47], v[76:79], v[108:111]
    ds_read_b64_tr_b16 v[64:65], v23 offset:45056
    s_nop 0
    s_cbranch_execz L_pfret
    ds_read_b64_tr_b16 v[66:67], v23 offset:46336
    v_add_u32 v165, 192, v0
    v_mul_u32_u24 v166, 205, v165
    v_lshrrev_b32 v166, 11, v166
    v_mfma_f32_16x16x32_bf16 v[112:115], v[40:43], v[80:83], v[112:115]
    s_add_u32 m0, s43, 122880
    s_add_u32 s57, s45, 984320
    s_sub_u32 s56, s57, 2457600
    s_min_u32 s57, s57, s56
    buffer_load_dwordx4 v249, s[8:11], s57 offen offset:0 lds
    v_mul_u32_u24 v166, 1120, v166
    v_add3_u32 v33, v166, v1, s47
    v_add_u32 v165, 256, v0
    v_mfma_f32_16x16x32_bf16 v[116:119], v[44:47], v[80:83], v[116:119]
    buffer_load_dwordx4 v250, s[8:11], s57 offen offset:1024 lds
    v_mul_u32_u24 v166, 205, v165
    v_lshrrev_b32 v166, 11, v166
    v_mul_u32_u24 v166, 1120, v166
    v_mfma_f32_16x16x32_bf16 v[120:123], v[40:43], v[84:87], v[120:123]
    buffer_load_dwordx4 v251, s[8:11], s57 offen offset:2048 lds
    v_add3_u32 v34, v166, v1, s47
    v_add_u32 v34, 1024, v34
    s_mul_i32 s71, s36, 5120
    v_mfma_f32_16x16x32_bf16 v[124:127], v[44:47], v[84:87], v[124:127]
    buffer_load_dwordx4 v252, s[8:11], s57 offen offset:3072 lds
    s_and_b32 s46, s36, 3
    s_mul_i32 s101, s46, 5120
    s_add_u32 s101, s101, 61440
    s_waitcnt lgkmcnt(9)
    v_mfma_f32_16x16x32_bf16 v[88:91], v[184:187], v[48:51], v[88:91]
    ds_read_b128 v[40:43], v9 offset:4096
    ds_read_b64_tr_b16 v[68:69], v22 offset:55296
    s_waitcnt lgkmcnt(10)
    v_mfma_f32_16x16x32_bf16 v[92:95], v[188:191], v[48:51], v[92:95]
    s_nop 0
    s_cbranch_execz L_pfret
    ds_read_b64_tr_b16 v[70:71], v22 offset:56576
    ds_read_b128 v[44:47], v9 offset:6144
    s_mul_i32 s47, s72, 5
    s_add_u32 s46, s46, s47
    s_mul_i32 s77, s46, 40960
    s_waitcnt lgkmcnt(10)
    v_mfma_f32_16x16x32_bf16 v[96:99], v[184:187], v[52:55], v[96:99]
    ds_read_b64_tr_b16 v[72:73], v22 offset:55336
    ds_read_b64_tr_b16 v[74:75], v22 offset:56616
    s_cmp_eq_u32 s41, 0
    s_cselect_b32 s58, -1, 0
    s_cselect_b32 s59, 0, -1
    s_not_b64 s[60:61], s[58:59]
    s_mov_b32 s62, 0x000fffff
    v_mfma_f32_16x16x32_bf16 v[100:103], v[188:191], v[52:55], v[100:103]
    ds_read_b64_tr_b16 v[76:77], v22 offset:55376
    ds_read_b64_tr_b16 v[78:79], v22 offset:56656
    s_mov_b32 s63, 0x000fffff
    v_bfe_u32 v165, v0, 2, 2
    v_and_b32 v166, 3, v0
    s_waitcnt lgkmcnt(12)
    v_mfma_f32_16x16x32_bf16 v[104:107], v[184:187], v[56:59], v[104:107]
    ds_read_b64_tr_b16 v[80:81], v22 offset:55416
    ds_read_b64_tr_b16 v[82:83], v22 offset:56696
    v_lshl_add_u32 v167, v164, 2, v165
    v_mad_u32_u24 v167, v162, 20, v167
    v_mul_u32_u24 v167, 160, v167
    v_mfma_f32_16x16x32_bf16 v[108:111], v[188:191], v[56:59], v[108:111]
    ds_read_b64_tr_b16 v[84:85], v23 offset:55296
    ds_read_b64_tr_b16 v[86:87], v23 offset:56576
    v_lshl_add_u32 v167, v166, 3, v167
    v_add_u32 v35, 61440, v167
    v_add_u32 v36, 112640, v167
    s_waitcnt lgkmcnt(14)
    v_mfma_f32_16x16x32_bf16 v[112:115], v[184:187], v[60:63], v[112:115]
    s_add_u32 m0, s43, 123904
    s_nop 0
    s_cbranch_execz L_pfret
    s_add_u32 s57, s45, 985344
    s_sub_u32 s56, s57, 2457600
    s_min_u32 s57, s57, s56
    buffer_load_dwordx4 v253, s[8:11], s57 offen offset:3072 lds
    v_mad_u32_u24 v167, v159, 40, v165
    v_mul_u32_u24 v167, 160, v167
    v_lshl_add_u32 v167, v166, 3, v167
    v_mfma_f32_16x16x32_bf16 v[116:119], v[188:191], v[60:63], v[116:119]
    s_add_u32 s56, s0, 1966080
    s_sub_u32 s57, s56, 2457600
    s_min_u32 s56, s56, s57
    buffer_load_dword v145, v133, s[8:11], s56 offen offset:1280
    v_add_u32 v37, 64000, v167
    v_add_u32 v38, 115200, v167
    s_lshl_b32 s46, s38, 2
    s_waitcnt lgkmcnt(12)
    v_mfma_f32_16x16x32_bf16 v[120:123], v[184:187], v[64:67], v[120:123]
    s_add_u32 s56, s1, 1024
    s_sub_u32 s57, s56, 1280
    s_min_u32 s56, s56, s57
    buffer_load_dword v144, v132, s[4:7], s56 offen offset:0
    s_add_u32 s47, s46, s40
    s_min_u32 s67, s47, 8
    s_add_u32 s46, s46, s36
    v_mfma_f32_16x16x32_bf16 v[124:127], v[188:191], v[64:67], v[124:127]
    s_cmp_lt_u32 s46, 8
    s_cselect_b32 s70, 1, 0
    s_cmp_eq_u32 s37, 0
    s_cselect_b32 s70, 1, s70
    s_mov_b32 s98, 1051011932
    s_waitcnt vmcnt(9) lgkmcnt(0)
    s_barrier
    v_mfma_f32_16x16x32_bf16 v[88:91], v[40:43], v[68:71], v[88:91]
    ds_read_b128 v[192:195], v6 offset:20480
    ds_read_b64_tr_b16 v[48:49], v14 offset:0
    v_mfma_f32_16x16x32_bf16 v[92:95], v[44:47], v[68:71], v[92:95]
    ds_read_b64_tr_b16 v[50:51], v14 offset:1280
    ds_read_b128 v[196:199], v6 offset:22528
    s_mov_b32 s99, s98
    s_cbranch_execz L_pfret
    s_sub_u32 s46, s46, 8
    s_mul_i32 s46, s46, 10240
    v_mfma_f32_16x16x32_bf16 v[96:99], v[40:43], v[72:75], v[96:99]
    ds_read_b64_tr_b16 v[52:53], v14 offset:40
    ds_read_b64_tr_b16 v[54:55], v14 offset:1320
    s_mul_i32 s47, s39, 655360
    s_add_u32 s68, s46, s47
    s_lshl_b32 s46, s41, 13
    v_mfma_f32_16x16x32_bf16 v[100:103], v[44:47], v[72:75], v[100:103]
    ds_read_b64_tr_b16 v[56:57], v14 offset:80
    ds_read_b64_tr_b16 v[58:59], v14 offset:1360
    s_and_b32 s47, s36, 3
    s_lshl_b32 s47, s47, 7
    s_add_u32 s46, s46, s47
    v_mfma_f32_16x16x32_bf16 v[104:107], v[40:43], v[76:79], v[104:107]
    ds_read_b64_tr_b16 v[60:61], v14 offset:120
    ds_read_b64_tr_b16 v[62:63], v14 offset:1400
    s_add_u32 s46, s46, s64
    s_sub_u32 s69, s46, 15872
    s_mov_b32 s100, 0xf0000000
    v_mfma_f32_16x16x32_bf16 v[108:111], v[44:47], v[76:79], v[108:111]
    ds_read_b64_tr_b16 v[64:65], v15 offset:0
    ds_read_b64_tr_b16 v[66:67], v15 offset:1280
    s_mov_b32 s18, 819200
    s_mov_b32 s19, 0x00020000
    s_mov_b32 s22, 5242880
    v_mfma_f32_16x16x32_bf16 v[112:115], v[40:43], v[80:83], v[112:115]
    s_add_u32 m0, s43, 143360
    s_add_u32 s57, s45, 1230080
    s_sub_u32 s56, s57, 2457600
    s_min_u32 s57, s57, s56
    buffer_load_dwordx4 v249, s[8:11], s57 offen offset:0 lds
    s_mov_b32 s23, 0x00020000
    s_mov_b32 s30, 25600
    s_mov_b32 s31, 0x00020000
    s_nop 0
    s_cbranch_execz L_pfret
    v_mfma_f32_16x16x32_bf16 v[116:119], v[44:47], v[80:83], v[116:119]
    buffer_load_dwordx4 v250, s[8:11], s57 offen offset:1024 lds
    s_and_b32 s17, s17, 0xffff
    s_and_b32 s21, s21, 0xffff
    s_and_b32 s29, s29, 0xffff
    v_mfma_f32_16x16x32_bf16 v[120:123], v[40:43], v[84:87], v[120:123]
    buffer_load_dwordx4 v251, s[8:11], s57 offen offset:2048 lds
    s_xor_b32 s75, s75, 0x404
    s_xor_b32 s46, s39, 1
    s_lshl_b32 s46, s46, 4
    v_mfma_f32_16x16x32_bf16 v[124:127], v[44:47], v[84:87], v[124:127]
    buffer_load_dwordx4 v252, s[8:11], s57 offen offset:3072 lds
    s_add_u32 s46, s46, s38
    s_lshl_b32 s46, s46, 2
    s_add_u32 s46, s46, s40
    s_waitcnt lgkmcnt(9)
    v_mfma_f32_16x16x32_bf16 v[88:91], v[192:195], v[48:51], v[88:91]
    ds_read_b128 v[40:43], v7 offset:20480
    ds_read_b64_tr_b16 v[68:69], v14 offset:10240
    s_waitcnt lgkmcnt(10)
    v_mfma_f32_16x16x32_bf16 v[92:95], v[196:199], v[48:51], v[92:95]
    ds_read_b64_tr_b16 v[70:71], v14 offset:11520
    ds_read_b128 v[44:47], v7 offset:22528
    s_lshl_b32 s46, s46, 1
    s_add_u32 s46, s46, s41
    s_xor_b32 s46, s46, 1
    s_waitcnt lgkmcnt(10)
    v_mfma_f32_16x16x32_bf16 v[96:99], v[192:195], v[52:55], v[96:99]
    ds_read_b64_tr_b16 v[72:73], v14 offset:10280
    ds_read_b64_tr_b16 v[74:75], v14 offset:11560
    s_mul_i32 s46, s46, 5120
    s_mul_i32 s47, s37, 20971520
    s_sub_u32 s46, s46, s47
    v_mfma_f32_16x16x32_bf16 v[100:103], v[196:199], v[52:55], v[100:103]
    ds_read_b64_tr_b16 v[76:77], v14 offset:10320
    ds_read_b64_tr_b16 v[78:79], v14 offset:11600
    s_add_u32 s65, s46, 20971520
    s_lshl_b32 s52, s39, 4
    s_cbranch_execz L_pfret
    s_add_u32 s52, s52, s38
    s_waitcnt lgkmcnt(12)
    v_mfma_f32_16x16x32_bf16 v[104:107], v[192:195], v[56:59], v[104:107]
    ds_read_b64_tr_b16 v[80:81], v14 offset:10360
    ds_read_b64_tr_b16 v[82:83], v14 offset:11640
    s_lshl_b32 s52, s52, 3
    s_add_u32 s52, s52, s36
    s_lshl_b32 s52, s52, 10
    v_mfma_f32_16x16x32_bf16 v[108:111], v[196:199], v[56:59], v[108:111]
    ds_read_b64_tr_b16 v[84:85], v15 offset:10240
    ds_read_b64_tr_b16 v[86:87], v15 offset:11520
    s_add_u32 s52, s52, 12582912
    s_cmp_lg_u32 s37, 0
    s_cselect_b64 vcc, -1, 0
    s_waitcnt lgkmcnt(14)
    v_mfma_f32_16x16x32_bf16 v[112:115], v[192:195], v[60:63], v[112:115]
    s_add_u32 m0, s43, 144384
    s_add_u32 s57, s45, 1231104
    s_sub_u32 s56, s57, 2457600
    s_min_u32 s57, s57, s56
    buffer_load_dwordx4 v253, s[8:11], s57 offen offset:3072 lds
    v_mfma_f32_16x16x32_bf16 v[116:119], v[196:199], v[60:63], v[116:119]
    s_lshl_b32 s50, s37, 5
    s_add_u32 s50, s50, s38
    s_lshl_b32 s50, s50, 2
    s_lshl_b32 s51, s39, 2
    s_lshl_b32 s51, s3, s51
    v_mov_b32 v39, s51
    s_mov_b64 exec, 1
    buffer_atomic_or v39, v248, s[24:27], s50 offen sc1
    s_mov_b64 exec, -1
    s_waitcnt lgkmcnt(12)
    v_mfma_f32_16x16x32_bf16 v[120:123], v[192:195], v[64:67], v[120:123]
    s_and_b32 s56, s2, 0xf8
    s_add_u32 s56, s56, s36
    s_mul_i32 s56, s56, 3840
    s_add_u32 s56, s56, s0
    s_add_u32 s56, s56, 0
    s_sub_u32 s57, s56, 2457600
    s_min_u32 s56, s56, s57
    buffer_load_dword v146, v134, s[8:11], s56 offen offset:0
    v_mfma_f32_16x16x32_bf16 v[124:127], v[196:199], v[64:67], v[124:127]
    s_waitcnt vmcnt(9) lgkmcnt(0)
    s_cbranch_execz L_pfret
    s_barrier
    v_mfma_f32_16x16x32_bf16 v[88:91], v[40:43], v[68:71], v[88:91]
    ds_read_b128 v[200:203], v6 offset:36864
    ds_read_b64_tr_b16 v[48:49], v22 offset:24576
    v_mfma_f32_16x16x32_bf16 v[92:95], v[44:47], v[68:71], v[92:95]
    ds_read_b64_tr_b16 v[50:51], v22 offset:25856
    ds_read_b128 v[204:207], v6 offset:38912
    v_mfma_f32_16x16x32_bf16 v[96:99], v[40:43], v[72:75], v[96:99]
    ds_read_b64_tr_b16 v[52:53], v22 offset:24616
    ds_read_b64_tr_b16 v[54:55], v22 offset:25896
    v_mfma_f32_16x16x32_bf16 v[100:103], v[44:47], v[72:75], v[100:103]
    ds_read_b64_tr_b16 v[56:57], v22 offset:24656
    ds_read_b64_tr_b16 v[58:59], v22 offset:25936
    v_mfma_f32_16x16x32_bf16 v[104:107], v[40:43], v[76:79], v[104:107]
    ds_read_b64_tr_b16 v[60:61], v22 offset:24696
    ds_read_b64_tr_b16 v[62:63], v22 offset:25976
    v_mfma_f32_16x16x32_bf16 v[108:111], v[44:47], v[76:79], v[108:111]
    ds_read_b64_tr_b16 v[64:65], v23 offset:24576
    ds_read_b64_tr_b16 v[66:67], v23 offset:25856
    v_mfma_f32_16x16x32_bf16 v[112:115], v[40:43], v[80:83], v[112:115]
    s_add_u32 m0, s43, 0
    s_add_u32 s57, s45, 1475840
    s_sub_u32 s56, s57, 2457600
    s_min_u32 s57, s57, s56
    buffer_load_dwordx4 v249, s[8:11], s57 offen offset:0 lds
    v_mfma_f32_16x16x32_bf16 v[116:119], v[44:47], v[80:83], v[116:119]
    buffer_load_dwordx4 v250, s[8:11], s57 offen offset:1024 lds
    v_mfma_f32_16x16x32_bf16 v[120:123], v[40:43], v[84:87], v[120:123]
    buffer_load_dwordx4 v251, s[8:11], s57 offen offset:2048 lds
    v_mfma_f32_16x16x32_bf16 v[124:127], v[44:47], v[84:87], v[124:127]
    buffer_load_dwordx4 v252, s[8:11], s57 offen offset:3072 lds
    s_waitcnt lgkmcnt(9)
    v_mfma_f32_16x16x32_bf16 v[88:91], v[200:203], v[48:51], v[88:91]
    s_nop 0
    s_cbranch_execz L_pfret
    ds_read_b128 v[40:43], v7 offset:36864
    ds_read_b64_tr_b16 v[68:69], v22 offset:34816
    s_waitcnt lgkmcnt(10)
    v_mfma_f32_16x16x32_bf16 v[92:95], v[204:207], v[48:51], v[92:95]
    ds_read_b64_tr_b16 v[70:71], v22 offset:36096
    ds_read_b128 v[44:47], v7 offset:38912
    s_waitcnt lgkmcnt(10)
    v_mfma_f32_16x16x32_bf16 v[96:99], v[200:203], v[52:55], v[96:99]
    ds_read_b64_tr_b16 v[72:73], v22 offset:34856
    ds_read_b64_tr_b16 v[74:75], v22 offset:36136
    v_mfma_f32_16x16x32_bf16 v[100:103], v[204:207], v[52:55], v[100:103]
    ds_read_b64_tr_b16 v[76:77], v22 offset:34896
    ds_read_b64_tr_b16 v[78:79], v22 offset:36176
    s_waitcnt lgkmcnt(12)
    v_mfma_f32_16x16x32_bf16 v[104:107], v[200:203], v[56:59], v[104:107]
    ds_read_b64_tr_b16 v[80:81], v22 offset:34936
    ds_read_b64_tr_b16 v[82:83], v22 offset:36216
    v_mfma_f32_16x16x32_bf16 v[108:111], v[204:207], v[56:59], v[108:111]
    ds_read_b64_tr_b16 v[84:85], v23 offset:34816
    ds_read_b64_tr_b16 v[86:87], v23 offset:36096
    s_waitcnt lgkmcnt(14)
    v_mfma_f32_16x16x32_bf16 v[112:115], v[200:203], v[60:63], v[112:115]
    s_add_u32 m0, s43, 1024
    s_add_u32 s57, s45, 1476864
    s_sub_u32 s56, s57, 2457600
    s_min_u32 s57, s57, s56
    buffer_load_dwordx4 v253, s[8:11], s57 offen offset:3072 lds
    v_mfma_f32_16x16x32_bf16 v[116:119], v[204:207], v[60:63], v[116:119]
    s_and_b32 s56, s2, 0xf8
    s_add_u32 s56, s56, s36
    s_mul_i32 s56, s56, 3840
    s_add_u32 s56, s56, s0
    s_add_u32 s56, s56, 983040
    s_sub_u32 s57, s56, 2457600
    s_min_u32 s56, s56, s57
    s_nop 0
    s_cbranch_execz L_pfret
    buffer_load_dword v148, v134, s[8:11], s56 offen offset:0
    s_waitcnt lgkmcnt(12)
    v_mfma_f32_16x16x32_bf16 v[120:123], v[200:203], v[64:67], v[120:123]
    v_mfma_f32_16x16x32_bf16 v[124:127], v[204:207], v[64:67], v[124:127]
    s_waitcnt vmcnt(8) lgkmcnt(0)
    s_barrier
    v_mfma_f32_16x16x32_bf16 v[88:91], v[40:43], v[68:71], v[88:91]
    ds_read_b128 v[208:211], v8 offset:4096
    ds_read_b64_tr_b16 v[48:49], v22 offset:45056
    v_mfma_f32_16x16x32_bf16 v[92:95], v[44:47], v[68:71], v[92:95]
    ds_read_b64_tr_b16 v[50:51], v22 offset:46336
    ds_read_b128 v[212:215], v8 offset:6144
    v_mfma_f32_16x16x32_bf16 v[96:99], v[40:43], v[72:75], v[96:99]
    ds_read_b64_tr_b16 v[52:53], v22 offset:45096
    ds_read_b64_tr_b16 v[54:55], v22 offset:46376
    v_mfma_f32_16x16x32_bf16 v[100:103], v[44:47], v[72:75], v[100:103]
    ds_read_b64_tr_b16 v[56:57], v22 offset:45136
    ds_read_b64_tr_b16 v[58:59], v22 offset:46416
    v_mfma_f32_16x16x32_bf16 v[104:107], v[40:43], v[76:79], v[104:107]
    ds_read_b64_tr_b16 v[60:61], v22 offset:45176
    ds_read_b64_tr_b16 v[62:63], v22 offset:46456
    v_mfma_f32_16x16x32_bf16 v[108:111], v[44:47], v[76:79], v[108:111]
    ds_read_b64_tr_b16 v[64:65], v23 offset:45056
    ds_read_b64_tr_b16 v[66:67], v23 offset:46336
    v_mfma_f32_16x16x32_bf16 v[112:115], v[40:43], v[80:83], v[112:115]
    s_add_u32 m0, s43, 122880
    s_add_u32 s57, s45, 1721600
    s_sub_u32 s56, s57, 2457600
    s_min_u32 s57, s57, s56
    buffer_load_dwordx4 v249, s[8:11], s57 offen offset:0 lds
    v_mfma_f32_16x16x32_bf16 v[116:119], v[44:47], v[80:83], v[116:119]
    buffer_load_dwordx4 v250, s[8:11], s57 offen offset:1024 lds
    v_mfma_f32_16x16x32_bf16 v[120:123], v[40:43], v[84:87], v[120:123]
    s_nop 0
    s_cbranch_execz L_pfret
    buffer_load_dwordx4 v251, s[8:11], s57 offen offset:2048 lds
    v_mfma_f32_16x16x32_bf16 v[124:127], v[44:47], v[84:87], v[124:127]
    buffer_load_dwordx4 v252, s[8:11], s57 offen offset:3072 lds
    s_waitcnt lgkmcnt(9)
    v_mfma_f32_16x16x32_bf16 v[88:91], v[208:211], v[48:51], v[88:91]
    ds_read_b128 v[40:43], v9 offset:4096
    ds_read_b64_tr_b16 v[68:69], v22 offset:55296
    s_waitcnt lgkmcnt(10)
    v_mfma_f32_16x16x32_bf16 v[92:95], v[212:215], v[48:51], v[92:95]
    ds_read_b64_tr_b16 v[70:71], v22 offset:56576
    ds_read_b128 v[44:47], v9 offset:6144
    s_waitcnt lgkmcnt(10)
    v_mfma_f32_16x16x32_bf16 v[96:99], v[208:211], v[52:55], v[96:99]
    ds_read_b64_tr_b16 v[72:73], v22 offset:55336
    ds_read_b64_tr_b16 v[74:75], v22 offset:56616
    v_mfma_f32_16x16x32_bf16 v[100:103], v[212:215], v[52:55], v[100:103]
    ds_read_b64_tr_b16 v[76:77], v22 offset:55376
    ds_read_b64_tr_b16 v[78:79], v22 offset:56656
    s_waitcnt lgkmcnt(12)
    v_mfma_f32_16x16x32_bf16 v[104:107], v[208:211], v[56:59], v[104:107]
    ds_read_b64_tr_b16 v[80:81], v22 offset:55416
    ds_read_b64_tr_b16 v[82:83], v22 offset:56696
    v_mfma_f32_16x16x32_bf16 v[108:111], v[212:215], v[56:59], v[108:111]
    ds_read_b64_tr_b16 v[84:85], v23 offset:55296
    ds_read_b64_tr_b16 v[86:87], v23 offset:56576
    s_waitcnt lgkmcnt(14)
    v_mfma_f32_16x16x32_bf16 v[112:115], v[208:211], v[60:63], v[112:115]
    s_add_u32 m0, s43, 123904
    s_add_u32 s57, s45, 1722624
    s_sub_u32 s56, s57, 2457600
    s_min_u32 s57, s57, s56
    buffer_load_dwordx4 v253, s[8:11], s57 offen offset:3072 lds
    v_mfma_f32_16x16x32_bf16 v[116:119], v[212:215], v[60:63], v[116:119]
    s_mul_i32 s54, s36, 800
    s_nop 0
    s_cbranch_execz L_pfret
    s_add_u32 m0, s54, 77824
    s_mul_i32 s53, s39, 3200
    s_add_u32 s54, s54, s53
    s_mov_b32 exec_hi, 0x3ffff
    buffer_load_dwordx4 v1, s[28:31], s54 offen lds
    s_mov_b32 exec_hi, -1
    s_waitcnt lgkmcnt(12)
    v_mfma_f32_16x16x32_bf16 v[120:123], v[208:211], v[64:67], v[120:123]
    s_and_b32 s56, s2, 0xf8
    s_add_u32 s56, s56, s36
    s_mul_i32 s56, s56, 3840
    s_add_u32 s56, s56, s0
    s_add_u32 s56, s56, 1966080
    s_sub_u32 s57, s56, 2457600
    s_min_u32 s56, s56, s57
    buffer_load_dword v150, v134, s[8:11], s56 offen offset:0
    v_mfma_f32_16x16x32_bf16 v[124:127], v[212:215], v[64:67], v[124:127]
    s_waitcnt vmcnt(8) lgkmcnt(0)
    s_barrier
    v_mfma_f32_16x16x32_bf16 v[88:91], v[40:43], v[68:71], v[88:91]
    ds_read_b128 v[216:219], v6 offset:20480
    ds_read_b64_tr_b16 v[48:49], v14 offset:0
    v_mfma_f32_16x16x32_bf16 v[92:95], v[44:47], v[68:71], v[92:95]
    ds_read_b64_tr_b16 v[50:51], v14 offset:1280
    ds_read_b128 v[220:223], v6 offset:22528
    v_mfma_f32_16x16x32_bf16 v[96:99], v[40:43], v[72:75], v[96:99]
    ds_read_b64_tr_b16 v[52:53], v14 offset:40
    ds_read_b64_tr_b16 v[54:55], v14 offset:1320
    v_mfma_f32_16x16x32_bf16 v[100:103], v[44:47], v[72:75], v[100:103]
    ds_read_b64_tr_b16 v[56:57], v14 offset:80
    ds_read_b64_tr_b16 v[58:59], v14 offset:1360
    v_mfma_f32_16x16x32_bf16 v[104:107], v[40:43], v[76:79], v[104:107]
    ds_read_b64_tr_b16 v[60:61], v14 offset:120
    ds_read_b64_tr_b16 v[62:63], v14 offset:1400
    v_mfma_f32_16x16x32_bf16 v[108:111], v[44:47], v[76:79], v[108:111]
    s_nop 0
    s_cbranch_execz L_pfret
    ds_read_b64_tr_b16 v[64:65], v15 offset:0
    ds_read_b64_tr_b16 v[66:67], v15 offset:1280
    v_mfma_f32_16x16x32_bf16 v[112:115], v[40:43], v[80:83], v[112:115]
    s_add_u32 m0, s43, 143360
    s_add_u32 s57, s45, 1967360
    s_sub_u32 s56, s57, 2457600
    s_min_u32 s57, s57, s56
    buffer_load_dwordx4 v249, s[8:11], s57 offen offset:0 lds
    v_mfma_f32_16x16x32_bf16 v[116:119], v[44:47], v[80:83], v[116:119]
    buffer_load_dwordx4 v250, s[8:11], s57 offen offset:1024 lds
    v_mfma_f32_16x16x32_bf16 v[120:123], v[40:43], v[84:87], v[120:123]
    buffer_load_dwordx4 v251, s[8:11], s57 offen offset:2048 lds
    v_mfma_f32_16x16x32_bf16 v[124:127], v[44:47], v[84:87], v[124:127]
    buffer_load_dwordx4 v252, s[8:11], s57 offen offset:3072 lds
    s_waitcnt lgkmcnt(9)
    v_mfma_f32_16x16x32_bf16 v[88:91], v[216:219], v[48:51], v[88:91]
    ds_read_b128 v[40:43], v7 offset:20480
    ds_read_b64_tr_b16 v[68:69], v14 offset:10240
    s_waitcnt lgkmcnt(10)
    v_mfma_f32_16x16x32_bf16 v[92:95], v[220:223], v[48:51], v[92:95]
    ds_read_b64_tr_b16 v[70:71], v14 offset:11520
    ds_read_b128 v[44:47], v7 offset:22528
    s_waitcnt lgkmcnt(10)
    v_mfma_f32_16x16x32_bf16 v[96:99], v[216:219], v[52:55], v[96:99]
    ds_read_b64_tr_b16 v[72:73], v14 offset:10280
    ds_read_b64_tr_b16 v[74:75], v14 offset:11560
    v_mfma_f32_16x16x32_bf16 v[100:103], v[220:223], v[52:55], v[100:103]
    ds_read_b64_tr_b16 v[76:77], v14 offset:10320
    ds_read_b64_tr_b16 v[78:79], v14 offset:11600
    s_waitcnt lgkmcnt(12)
    v_mfma_f32_16x16x32_bf16 v[104:107], v[216:219], v[56:59], v[104:107]
    ds_read_b64_tr_b16 v[80:81], v14 offset:10360
    ds_read_b64_tr_b16 v[82:83], v14 offset:11640
    v_mfma_f32_16x16x32_bf16 v[108:111], v[220:223], v[56:59], v[108:111]
    s_cbranch_execz L_pfret
    ds_read_b64_tr_b16 v[84:85], v15 offset:10240
    ds_read_b64_tr_b16 v[86:87], v15 offset:11520
    s_waitcnt lgkmcnt(14)
    v_mfma_f32_16x16x32_bf16 v[112:115], v[216:219], v[60:63], v[112:115]
    s_add_u32 m0, s43, 144384
    s_add_u32 s57, s45, 1968384
    s_sub_u32 s56, s57, 2457600
    s_min_u32 s57, s57, s56
    buffer_load_dwordx4 v253, s[8:11], s57 offen offset:3072 lds
    v_mfma_f32_16x16x32_bf16 v[116:119], v[220:223], v[60:63], v[116:119]
    s_lshl_b32 s48, s37, 7
    v_and_b32 v39, 15, v0
    v_lshlrev_b32 v39, 2, v39
    buffer_load_dword v39, v39, s[24:27], s48 offen sc1
    s_waitcnt lgkmcnt(12)
    v_mfma_f32_16x16x32_bf16 v[120:123], v[216:219], v[64:67], v[120:123]
    v_mfma_f32_16x16x32_bf16 v[124:127], v[220:223], v[64:67], v[124:127]
    s_waitcnt vmcnt(8) lgkmcnt(0)
    s_barrier
    v_mfma_f32_16x16x32_bf16 v[88:91], v[40:43], v[68:71], v[88:91]
    ds_read_b128 v[224:227], v6 offset:36864
    ds_read_b64_tr_b16 v[48:49], v22 offset:24576
    v_mfma_f32_16x16x32_bf16 v[92:95], v[44:47], v[68:71], v[92:95]
    ds_read_b64_tr_b16 v[50:51], v22 offset:25856
    ds_read_b128 v[228:231], v6 offset:38912
    v_mfma_f32_16x16x32_bf16 v[96:99], v[40:43], v[72:75], v[96:99]
    ds_read_b64_tr_b16 v[52:53], v22 offset:24616
    ds_read_b64_tr_b16 v[54:55], v22 offset:25896
    v_mfma_f32_16x16x32_bf16 v[100:103], v[44:47], v[72:75], v[100:103]
    ds_read_b64_tr_b16 v[56:57], v22 offset:24656
    ds_read_b64_tr_b16 v[58:59], v22 offset:25936
    v_mfma_f32_16x16x32_bf16 v[104:107], v[40:43], v[76:79], v[104:107]
    ds_read_b64_tr_b16 v[60:61], v22 offset:24696
    ds_read_b64_tr_b16 v[62:63], v22 offset:25976
    v_mfma_f32_16x16x32_bf16 v[108:111], v[44:47], v[76:79], v[108:111]
    s_nop 0
    s_cbranch_execz L_pfret
    ds_read_b64_tr_b16 v[64:65], v23 offset:24576
    ds_read_b64_tr_b16 v[66:67], v23 offset:25856
    v_mfma_f32_16x16x32_bf16 v[112:115], v[40:43], v[80:83], v[112:115]
    s_add_u32 m0, s43, 0
    s_add_u32 s57, s45, 2213120
    s_sub_u32 s56, s57, 2457600
    s_min_u32 s57, s57, s56
    buffer_load_dwordx4 v249, s[8:11], s57 offen offset:0 lds
    v_mfma_f32_16x16x32_bf16 v[116:119], v[44:47], v[80:83], v[116:119]
    buffer_load_dwordx4 v250, s[8:11], s57 offen offset:1024 lds
    v_mfma_f32_16x16x32_bf16 v[120:123], v[40:43], v[84:87], v[120:123]
    buffer_load_dwordx4 v251, s[8:11], s57 offen offset:2048 lds
    v_mfma_f32_16x16x32_bf16 v[124:127], v[44:47], v[84:87], v[124:127]
    buffer_load_dwordx4 v252, s[8:11], s57 offen offset:3072 lds
    s_waitcnt lgkmcnt(9)
    v_mfma_f32_16x16x32_bf16 v[88:91], v[224:227], v[48:51], v[88:91]
    ds_read_b128 v[40:43], v7 offset:36864
    ds_read_b64_tr_b16 v[68:69], v22 offset:34816
    s_waitcnt lgkmcnt(10)
    v_mfma_f32_16x16x32_bf16 v[92:95], v[228:231], v[48:51], v[92:95]
    ds_read_b64_tr_b16 v[70:71], v22 offset:36096
    ds_read_b128 v[44:47], v7 offset:38912
    s_waitcnt lgkmcnt(10)
    v_mfma_f32_16x16x32_bf16 v[96:99], v[224:227], v[52:55], v[96:99]
    ds_read_b64_tr_b16 v[72:73], v22 offset:34856
    ds_read_b64_tr_b16 v[74:75], v22 offset:36136
    v_mfma_f32_16x16x32_bf16 v[100:103], v[228:231], v[52:55], v[100:103]
    ds_read_b64_tr_b16 v[76:77], v22 offset:34896
    ds_read_b64_tr_b16 v[78:79], v22 offset:36176
    s_waitcnt lgkmcnt(12)
    v_mfma_f32_16x16x32_bf16 v[104:107], v[224:227], v[56:59], v[104:107]
    ds_read_b64_tr_b16 v[80:81], v22 offset:34936
    ds_read_b64_tr_b16 v[82:83], v22 offset:36216
    v_mfma_f32_16x16x32_bf16 v[108:111], v[228:231], v[56:59], v[108:111]
    s_nop 0
    s_cbranch_execz L_pfret
    ds_read_b64_tr_b16 v[84:85], v23 offset:34816
    ds_read_b64_tr_b16 v[86:87], v23 offset:36096
    s_waitcnt lgkmcnt(14)
    v_mfma_f32_16x16x32_bf16 v[112:115], v[224:227], v[60:63], v[112:115]
    s_add_u32 m0, s43, 1024
    s_add_u32 s57, s45, 2214144
    s_sub_u32 s56, s57, 2457600
    s_min_u32 s57, s57, s56
    buffer_load_dwordx4 v253, s[8:11], s57 offen offset:3072 lds
    v_mfma_f32_16x16x32_bf16 v[116:119], v[228:231], v[60:63], v[116:119]
    s_mov_b32 s56, 0
    buffer_load_dword v152, v135, s[16:19], s56 offen offset:0
    s_waitcnt lgkmcnt(12)
    v_mfma_f32_16x16x32_bf16 v[120:123], v[224:227], v[64:67], v[120:123]
    s_mov_b32 s56, 327680
    buffer_load_dword v154, v135, s[16:19], s56 offen offset:0
    v_mfma_f32_16x16x32_bf16 v[124:127], v[228:231], v[64:67], v[124:127]
    s_mov_b32 s56, 655360
    buffer_load_dword v156, v135, s[16:19], s56 offen offset:0
    s_waitcnt vmcnt(9) lgkmcnt(0)
    s_barrier
    v_mfma_f32_16x16x32_bf16 v[88:91], v[40:43], v[68:71], v[88:91]
    ds_read_b128 v[232:235], v8 offset:4096
    ds_read_b64_tr_b16 v[48:49], v22 offset:45056
    v_mfma_f32_16x16x32_bf16 v[92:95], v[44:47], v[68:71], v[92:95]
    ds_read_b64_tr_b16 v[50:51], v22 offset:46336
    ds_read_b128 v[236:239], v8 offset:6144
    v_mfma_f32_16x16x32_bf16 v[96:99], v[40:43], v[72:75], v[96:99]
    ds_read_b64_tr_b16 v[52:53], v22 offset:45096
    ds_read_b64_tr_b16 v[54:55], v22 offset:46376
    v_mfma_f32_16x16x32_bf16 v[100:103], v[44:47], v[72:75], v[100:103]
    ds_read_b64_tr_b16 v[56:57], v22 offset:45136
    ds_read_b64_tr_b16 v[58:59], v22 offset:46416
    v_mfma_f32_16x16x32_bf16 v[104:107], v[40:43], v[76:79], v[104:107]
    s_nop 0
    s_cbranch_execz L_pfret
    ds_read_b64_tr_b16 v[60:61], v22 offset:45176
    ds_read_b64_tr_b16 v[62:63], v22 offset:46456
    v_mfma_f32_16x16x32_bf16 v[108:111], v[44:47], v[76:79], v[108:111]
    ds_read_b64_tr_b16 v[64:65], v23 offset:45056
    ds_read_b64_tr_b16 v[66:67], v23 offset:46336
    v_mfma_f32_16x16x32_bf16 v[112:115], v[40:43], v[80:83], v[112:115]
    s_mul_i32 s53, s39, 160
    s_and_b32 s54, s36, 1
    v_mul_u32_u24 v158, 205, v0
    v_lshrrev_b32 v158, 12, v158
    v_mul_u32_u24 v160, 20, v158
    v_sub_u32 v160, v0, v160
    v_mul_u32_u24 v161, 3840, v158
    v_lshl_add_u32 v249, v160, 4, v161
    v_mul_u32_u24 v160, 26, v160
    v_lshrrev_b32 v160, 8, v160
    v_mul_u32_u24 v161, 160, v160
    v_sub_u32 v249, v249, v161
    v_xor_b32 v160, s54, v160
    v_mul_u32_u24 v160, 122880, v160
    v_add3_u32 v249, v249, v160, s53
    s_add_u32 m0, s44, 122880
    s_add_u32 s57, s76, 0
    buffer_load_dwordx4 v249, s[8:11], s57 offen offset:0 lds
    v_mfma_f32_16x16x32_bf16 v[116:119], v[44:47], v[80:83], v[116:119]
    v_add_u32 v161, 64, v0
    v_mul_u32_u24 v158, 205, v161
    v_lshrrev_b32 v158, 12, v158
    v_mul_u32_u24 v160, 20, v158
    v_sub_u32 v160, v161, v160
    v_mul_u32_u24 v161, 3840, v158
    v_lshl_add_u32 v250, v160, 4, v161
    v_mul_u32_u24 v160, 26, v160
    v_lshrrev_b32 v160, 8, v160
    v_mul_u32_u24 v161, 160, v160
    v_sub_u32 v250, v250, v161
    v_xor_b32 v160, s54, v160
    v_mul_u32_u24 v160, 122880, v160
    v_add_u32 v160, -1024, v160
    v_add3_u32 v250, v250, v160, s53
    s_cbranch_execz L_pfret
    buffer_load_dwordx4 v250, s[8:11], s57 offen offset:1024 lds
    v_mfma_f32_16x16x32_bf16 v[120:123], v[40:43], v[84:87], v[120:123]
    v_add_u32 v161, 128, v0
    v_mul_u32_u24 v158, 205, v161
    v_lshrrev_b32 v158, 12, v158
    v_mul_u32_u24 v160, 20, v158
    v_sub_u32 v160, v161, v160
    v_mul_u32_u24 v161, 3840, v158
    v_lshl_add_u32 v251, v160, 4, v161
    v_mul_u32_u24 v160, 26, v160
    v_lshrrev_b32 v160, 8, v160
    v_mul_u32_u24 v161, 160, v160
    v_sub_u32 v251, v251, v161
    v_xor_b32 v160, s54, v160
    v_mul_u32_u24 v160, 122880, v160
    v_add_u32 v160, -2048, v160
    v_add3_u32 v251, v251, v160, s53
    s_mov_b64 exec, 0xffffffff
    buffer_load_dwordx4 v251, s[8:11], s57 offen offset:2048 lds
    s_mov_b64 exec, -1
    v_mfma_f32_16x16x32_bf16 v[124:127], v[44:47], v[84:87], v[124:127]
    s_waitcnt lgkmcnt(9)
    v_mfma_f32_16x16x32_bf16 v[88:91], v[232:235], v[48:51], v[88:91]
    ds_read_b128 v[40:43], v9 offset:4096
    ds_read_b64_tr_b16 v[68:69], v22 offset:55296
    s_waitcnt lgkmcnt(10)
    v_mfma_f32_16x16x32_bf16 v[92:95], v[236:239], v[48:51], v[92:95]
    ds_read_b64_tr_b16 v[70:71], v22 offset:56576
    ds_read_b128 v[44:47], v9 offset:6144
    s_waitcnt lgkmcnt(10)
    v_mfma_f32_16x16x32_bf16 v[96:99], v[232:235], v[52:55], v[96:99]
    ds_read_b64_tr_b16 v[72:73], v22 offset:55336
    ds_read_b64_tr_b16 v[74:75], v22 offset:56616
    v_mfma_f32_16x16x32_bf16 v[100:103], v[236:239], v[52:55], v[100:103]
    ds_read_b64_tr_b16 v[76:77], v22 offset:55376
    ds_read_b64_tr_b16 v[78:79], v22 offset:56656
    s_waitcnt lgkmcnt(12)
    s_nop 0
    s_cbranch_execz L_pfret
    v_mfma_f32_16x16x32_bf16 v[104:107], v[232:235], v[56:59], v[104:107]
    ds_read_b64_tr_b16 v[80:81], v22 offset:55416
    ds_read_b64_tr_b16 v[82:83], v22 offset:56696
    v_mfma_f32_16x16x32_bf16 v[108:111], v[236:239], v[56:59], v[108:111]
    ds_read_b64_tr_b16 v[84:85], v23 offset:55296
    ds_read_b64_tr_b16 v[86:87], v23 offset:56576
    s_waitcnt lgkmcnt(14)
    v_mfma_f32_16x16x32_bf16 v[112:115], v[232:235], v[60:63], v[112:115]
    v_mfma_f32_16x16x32_bf16 v[116:119], v[236:239], v[60:63], v[116:119]
    s_waitcnt lgkmcnt(12)
    v_mfma_f32_16x16x32_bf16 v[120:123], v[232:235], v[64:67], v[120:123]
    v_mfma_f32_16x16x32_bf16 v[124:127], v[236:239], v[64:67], v[124:127]
    s_waitcnt vmcnt(6)
    s_mov_b32 s48, 0x88888888
    v_and_b32 v254, s48, v39
    v_cmp_ne_u32 s[46:47], s48, v254
    s_nop 0
    s_cmp_eq_u64 s[46:47], 0
    s_cbranch_scc1 L_cnt_ok0f
    s_mov_b32 s49, 100000
L_cnt_poll0f:
    s_lshl_b32 s48, s37, 7
    v_and_b32 v39, 15, v0
    v_lshlrev_b32 v39, 2, v39
    buffer_load_dword v39, v39, s[24:27], s48 offen sc1
    s_waitcnt vmcnt(0)
    s_sub_u32 s49, s49, 1
    s_cbranch_scc1 L_cnt_ok0f
    s_mov_b32 s48, 0x88888888
    v_and_b32 v254, s48, v39
    v_cmp_ne_u32 s[46:47], s48, v254
    s_nop 0
    s_cmp_eq_u64 s[46:47], 0
    s_cbranch_scc0 L_cnt_poll0f
    s_nop 1
L_cnt_ok0f:
    s_waitcnt lgkmcnt(0)
    s_barrier
    v_mfma_f32_16x16x32_bf16 v[88:91], v[40:43], v[68:71], v[88:91]
    ds_read_b128 v[240:243], v6 offset:20480
    ds_read_b64_tr_b16 v[48:49], v14 offset:0
    v_mfma_f32_16x16x32_bf16 v[92:95], v[44:47], v[68:71], v[92:95]
    ds_read_b64_tr_b16 v[50:51], v14 offset:1280
    s_nop 0
    s_cbranch_execz L_pfret
    ds_read_b128 v[244:247], v6 offset:22528
    v_mfma_f32_16x16x32_bf16 v[96:99], v[40:43], v[72:75], v[96:99]
    ds_read_b64_tr_b16 v[52:53], v14 offset:40
    ds_read_b64_tr_b16 v[54:55], v14 offset:1320
    v_mfma_f32_16x16x32_bf16 v[100:103], v[44:47], v[72:75], v[100:103]
    ds_read_b64_tr_b16 v[56:57], v14 offset:80
    ds_read_b64_tr_b16 v[58:59], v14 offset:1360
    v_mfma_f32_16x16x32_bf16 v[104:107], v[40:43], v[76:79], v[104:107]
    ds_read_b64_tr_b16 v[60:61], v14 offset:120
    ds_read_b64_tr_b16 v[62:63], v14 offset:1400
    v_mfma_f32_16x16x32_bf16 v[108:111], v[44:47], v[76:79], v[108:111]
    ds_read_b64_tr_b16 v[64:65], v15 offset:0
    ds_read_b64_tr_b16 v[66:67], v15 offset:1280
    v_mfma_f32_16x16x32_bf16 v[112:115], v[40:43], v[80:83], v[112:115]
    s_add_u32 m0, s44, 143360
    s_add_u32 s57, s76, 491520
    buffer_load_dwordx4 v249, s[8:11], s57 offen offset:0 lds
    v_mfma_f32_16x16x32_bf16 v[116:119], v[44:47], v[80:83], v[116:119]
    buffer_load_dwordx4 v250, s[8:11], s57 offen offset:1024 lds
    v_mfma_f32_16x16x32_bf16 v[120:123], v[40:43], v[84:87], v[120:123]
    s_mov_b64 exec, 0xffffffff
    buffer_load_dwordx4 v251, s[8:11], s57 offen offset:2048 lds
    s_mov_b64 exec, -1
    v_mfma_f32_16x16x32_bf16 v[124:127], v[44:47], v[84:87], v[124:127]
    s_add_u32 m0, s44, 36864
    s_add_u32 s57, s76, 983040
    s_sub_u32 s56, s57, 2457600
    s_min_u32 s57, s57, s56
    buffer_load_dwordx4 v249, s[8:11], s57 offen offset:0 lds
    s_waitcnt lgkmcnt(9)
    v_mfma_f32_16x16x32_bf16 v[88:91], v[240:243], v[48:51], v[88:91]
    ds_read_b128 v[40:43], v7 offset:20480
    ds_read_b64_tr_b16 v[68:69], v14 offset:10240
    s_cbranch_execz L_pfret
    s_waitcnt lgkmcnt(10)
    v_mfma_f32_16x16x32_bf16 v[92:95], v[244:247], v[48:51], v[92:95]
    ds_read_b64_tr_b16 v[70:71], v14 offset:11520
    ds_read_b128 v[44:47], v7 offset:22528
    s_waitcnt lgkmcnt(10)
    v_mfma_f32_16x16x32_bf16 v[96:99], v[240:243], v[52:55], v[96:99]
    ds_read_b64_tr_b16 v[72:73], v14 offset:10280
    ds_read_b64_tr_b16 v[74:75], v14 offset:11560
    v_mfma_f32_16x16x32_bf16 v[100:103], v[244:247], v[52:55], v[100:103]
    ds_read_b64_tr_b16 v[76:77], v14 offset:10320
    ds_read_b64_tr_b16 v[78:79], v14 offset:11600
    s_waitcnt lgkmcnt(12)
    v_mfma_f32_16x16x32_bf16 v[104:107], v[240:243], v[56:59], v[104:107]
    ds_read_b64_tr_b16 v[80:81], v14 offset:10360
    ds_read_b64_tr_b16 v[82:83], v14 offset:11640
    v_mfma_f32_16x16x32_bf16 v[108:111], v[244:247], v[56:59], v[108:111]
    ds_read_b64_tr_b16 v[84:85], v15 offset:10240
    ds_read_b64_tr_b16 v[86:87], v15 offset:11520
    s_waitcnt lgkmcnt(14)
    v_mfma_f32_16x16x32_bf16 v[112:115], v[240:243], v[60:63], v[112:115]
    buffer_load_dwordx4 v250, s[8:11], s57 offen offset:1024 lds
    v_mfma_f32_16x16x32_bf16 v[116:119], v[244:247], v[60:63], v[116:119]
    s_mov_b64 exec, 0xffffffff
    buffer_load_dwordx4 v251, s[8:11], s57 offen offset:2048 lds
    s_mov_b64 exec, -1
    s_waitcnt lgkmcnt(12)
    v_mfma_f32_16x16x32_bf16 v[120:123], v[240:243], v[64:67], v[120:123]
    s_add_u32 s47, s38, 1
    s_add_u32 s48, s38, 2
    s_mul_i32 s3, s3, 0x11111111
    v_readlane_b32 s46, v39, s38
    v_readlane_b32 s47, v39, s47
    v_readlane_b32 s48, v39, s48
    v_mfma_f32_16x16x32_bf16 v[124:127], v[244:247], v[64:67], v[124:127]
    s_lshl_b32 s49, s39, 2
    s_xor_b32 s49, s49, 4
    s_xor_b32 s47, s47, s3
    s_cbranch_execz L_pfret
    s_xor_b32 s48, s48, s3
    s_or_b32 s47, s47, s48
    s_lshr_b32 s47, s47, s49
    s_cmp_eq_u32 s46, s3
    s_cselect_b32 s3, 1, 0
    s_mul_i32 s47, s47, s37
    s_and_b32 s47, s47, 15
    s_cselect_b32 s47, 0, 2
    s_mul_i32 s47, s47, s3
    s_or_b32 s3, s3, s47
    s_waitcnt vmcnt(6) lgkmcnt(0)
    s_barrier
    v_mfma_f32_16x16x32_bf16 v[88:91], v[40:43], v[68:71], v[88:91]
    ds_read_b64_tr_b16 v[48:49], v22 offset:24576
    ds_read_b64_tr_b16 v[50:51], v22 offset:25856
    v_mfma_f32_16x16x32_bf16 v[92:95], v[44:47], v[68:71], v[92:95]
    ds_read_b64_tr_b16 v[52:53], v22 offset:24616
    ds_read_b64_tr_b16 v[54:55], v22 offset:25896
    v_mfma_f32_16x16x32_bf16 v[96:99], v[40:43], v[72:75], v[96:99]
    ds_read_b64_tr_b16 v[56:57], v22 offset:24656
    ds_read_b64_tr_b16 v[58:59], v22 offset:25936
    v_mfma_f32_16x16x32_bf16 v[100:103], v[44:47], v[72:75], v[100:103]
    ds_read_b64_tr_b16 v[60:61], v22 offset:24696
    ds_read_b64_tr_b16 v[62:63], v22 offset:25976
    v_mfma_f32_16x16x32_bf16 v[104:107], v[40:43], v[76:79], v[104:107]
    ds_read_b64_tr_b16 v[64:65], v23 offset:24576
    ds_read_b64_tr_b16 v[66:67], v23 offset:25856
    v_mfma_f32_16x16x32_bf16 v[108:111], v[44:47], v[76:79], v[108:111]
    v_mfma_f32_16x16x32_bf16 v[112:115], v[40:43], v[80:83], v[112:115]
    v_mfma_f32_16x16x32_bf16 v[116:119], v[44:47], v[80:83], v[116:119]
    v_mfma_f32_16x16x32_bf16 v[120:123], v[40:43], v[84:87], v[120:123]
    v_mfma_f32_16x16x32_bf16 v[124:127], v[44:47], v[84:87], v[124:127]
    s_waitcnt lgkmcnt(8)
    v_mfma_f32_16x16x32_bf16 v[128:131], v[48:51], v[168:171], 0
    ds_read_b64_tr_b16 v[68:69], v22 offset:34816
    ds_read_b64_tr_b16 v[70:71], v22 offset:36096
    v_mfma_f32_16x16x32_bf16 v[132:135], v[48:51], v[172:175], 0
    ds_read_b64_tr_b16 v[72:73], v22 offset:34856
    s_cbranch_execz L_pfret
    ds_read_b64_tr_b16 v[74:75], v22 offset:36136
    v_mov_b64 v[40:41], -1
    v_mov_b64 v[42:43], -1
    v_cvt_pk_bf16_f32 v88, v88, v89
    v_cvt_pk_bf16_f32 v89, v90, v91
    s_waitcnt lgkmcnt(10)
    v_mfma_f32_16x16x32_bf16 v[136:139], v[52:55], v[168:171], 0
    ds_read_b64_tr_b16 v[76:77], v22 offset:34896
    ds_read_b64_tr_b16 v[78:79], v22 offset:36176
    v_cvt_pk_bf16_f32 v90, v92, v93
    v_cvt_pk_bf16_f32 v91, v94, v95
    s_nop 0
    v_permlane32_swap_b32 v88, v90
    v_permlane32_swap_b32 v89, v91
    v_mfma_f32_16x16x32_bf16 v[140:143], v[52:55], v[172:175], 0
    ds_read_b64_tr_b16 v[80:81], v22 offset:34936
    ds_read_b64_tr_b16 v[82:83], v22 offset:36216
    s_bitcmp1_b32 s3, 1
    s_cbranch_scc0 L_pc0f0
    buffer_store_dwordx4 v[88:91], v1, s[12:15], s65 offen offset:0 sc1
    s_branch L_pa0f0
L_pc0f0:
    buffer_store_dwordx4 v[88:91], v1, s[12:15], s65 offen offset:0 sc1
L_pa0f0:
    s_waitcnt lgkmcnt(12)
    v_mfma_f32_16x16x32_bf16 v[144:147], v[56:59], v[168:171], 0
    ds_read_b64_tr_b16 v[84:85], v23 offset:34816
    ds_read_b64_tr_b16 v[86:87], v23 offset:36096
    v_cvt_pk_bf16_f32 v96, v96, v97
    v_cvt_pk_bf16_f32 v97, v98, v99
    v_cvt_pk_bf16_f32 v98, v100, v101
    v_cvt_pk_bf16_f32 v99, v102, v103
    v_mfma_f32_16x16x32_bf16 v[148:151], v[56:59], v[172:175], 0
    s_add_u32 m0, s44, 0
    s_add_u32 s57, s76, 1474560
    s_sub_u32 s56, s57, 2457600
    s_min_u32 s57, s57, s56
    buffer_load_dwordx4 v249, s[8:11], s57 offen offset:0 lds
    v_permlane32_swap_b32 v96, v98
    v_permlane32_swap_b32 v97, v99
    s_bitcmp1_b32 s3, 1
    s_cbranch_execz L_pfret
    s_cbranch_scc0 L_pc0f1
    buffer_store_dwordx4 v[96:99], v1, s[12:15], s65 offen offset:1024 sc1
    s_branch L_pa0f1
L_pc0f1:
    buffer_store_dwordx4 v[96:99], v1, s[12:15], s65 offen offset:1024 sc1
L_pa0f1:
    s_waitcnt lgkmcnt(12)
    v_mfma_f32_16x16x32_bf16 v[152:155], v[60:63], v[168:171], 0
    buffer_load_dwordx4 v250, s[8:11], s57 offen offset:1024 lds
    v_cvt_pk_bf16_f32 v104, v104, v105
    v_cvt_pk_bf16_f32 v105, v106, v107
    v_cvt_pk_bf16_f32 v106, v108, v109
    v_cvt_pk_bf16_f32 v107, v110, v111
    v_mfma_f32_16x16x32_bf16 v[156:159], v[60:63], v[172:175], 0
    s_mov_b64 exec, 0xffffffff
    buffer_load_dwordx4 v251, s[8:11], s57 offen offset:2048 lds
    s_mov_b64 exec, -1
    v_permlane32_swap_b32 v104, v106
    v_permlane32_swap_b32 v105, v107
    s_waitcnt lgkmcnt(10)
    v_mfma_f32_16x16x32_bf16 v[160:163], v[64:67], v[168:171], 0
    s_add_u32 m0, s44, 57344
    s_add_u32 s57, s76, 1966080
    s_sub_u32 s56, s57, 2457600
    s_min_u32 s57, s57, s56
    buffer_load_dwordx4 v249, s[8:11], s57 offen offset:0 lds
    v_mfma_f32_16x16x32_bf16 v[164:167], v[64:67], v[172:175], 0
    buffer_load_dwordx4 v250, s[8:11], s57 offen offset:1024 lds
    s_mov_b64 exec, 0xffffffff
    buffer_load_dwordx4 v251, s[8:11], s57 offen offset:2048 lds
    s_mov_b64 exec, -1
    s_waitcnt vmcnt(11) lgkmcnt(0)
    s_barrier
    v_mfma_f32_16x16x32_bf16 v[128:131], v[68:71], v[176:179], v[128:131]
    ds_read_b64_tr_b16 v[48:49], v22 offset:45056
    ds_read_b64_tr_b16 v[50:51], v22 offset:46336
    v_mfma_f32_16x16x32_bf16 v[132:135], v[68:71], v[180:183], v[132:135]
    ds_read_b64_tr_b16 v[52:53], v22 offset:45096
    ds_read_b64_tr_b16 v[54:55], v22 offset:46376
    s_cbranch_execz L_pfret
    s_bitcmp1_b32 s3, 1
    s_cbranch_scc0 L_pc0f2
    buffer_store_dwordx4 v[104:107], v1, s[12:15], s65 offen offset:2048 sc1
    s_branch L_pa0f2
L_pc0f2:
    buffer_store_dwordx4 v[104:107], v1, s[12:15], s65 offen offset:2048 sc1
L_pa0f2:
    v_mfma_f32_16x16x32_bf16 v[136:139], v[72:75], v[176:179], v[136:139]
    ds_read_b64_tr_b16 v[56:57], v22 offset:45136
    ds_read_b64_tr_b16 v[58:59], v22 offset:46416
    v_cvt_pk_bf16_f32 v112, v112, v113
    v_cvt_pk_bf16_f32 v113, v114, v115
    v_cvt_pk_bf16_f32 v114, v116, v117
    v_cvt_pk_bf16_f32 v115, v118, v119
    v_mfma_f32_16x16x32_bf16 v[140:143], v[72:75], v[180:183], v[140:143]
    ds_read_b64_tr_b16 v[60:61], v22 offset:45176
    ds_read_b64_tr_b16 v[62:63], v22 offset:46456
    v_permlane32_swap_b32 v112, v114
    v_permlane32_swap_b32 v113, v115
    s_bitcmp1_b32 s3, 1
    s_cbranch_scc0 L_pc0f3
    buffer_store_dwordx4 v[112:115], v1, s[12:15], s65 offen offset:3072 sc1
    s_branch L_pa0f3
L_pc0f3:
    buffer_store_dwordx4 v[112:115], v1, s[12:15], s65 offen offset:3072 sc1
L_pa0f3:
    v_mfma_f32_16x16x32_bf16 v[144:147], v[76:79], v[176:179], v[144:147]
    ds_read_b64_tr_b16 v[64:65], v23 offset:45056
    ds_read_b64_tr_b16 v[66:67], v23 offset:46336
    v_cvt_pk_bf16_f32 v120, v120, v121
    v_cvt_pk_bf16_f32 v121, v122, v123
    v_cvt_pk_bf16_f32 v122, v124, v125
    v_cvt_pk_bf16_f32 v123, v126, v127
    v_mfma_f32_16x16x32_bf16 v[148:151], v[76:79], v[180:183], v[148:151]
    v_permlane32_swap_b32 v120, v122
    v_permlane32_swap_b32 v121, v123
    s_add_u32 s55, s65, 4096
    s_bitcmp1_b32 s3, 1
    s_cbranch_scc0 L_pc0f4
    buffer_store_dwordx4 v[120:123], v1, s[12:15], s55 offen sc1
    s_branch L_pa0f4
L_pc0f4:
    buffer_store_dwordx4 v[120:123], v1, s[12:15], s55 offen sc1
L_pa0f4:
    s_cbranch_execz L_pfret
    v_mfma_f32_16x16x32_bf16 v[152:155], v[80:83], v[176:179], v[152:155]
    s_mul_i32 s43, s72, 5
    s_add_u32 s43, s43, 19
    s_sub_u32 s43, s43, s36
    s_sub_u32 s52, s43, 20
    s_cselect_b32 s43, s43, s52
    s_mul_i32 s43, s43, 40960
    s_mul_i32 s45, s72, 5
    s_add_u32 s45, s45, 4
    s_add_u32 s45, s45, s36
    s_sub_u32 s52, s45, 20
    s_cselect_b32 s45, s45, s52
    s_mul_i32 s45, s45, 40960
    v_mfma_f32_16x16x32_bf16 v[156:159], v[80:83], v[180:183], v[156:159]
    v_mov_b32 v252, v30
    v_mov_b32 v253, v31
    v_mfma_f32_16x16x32_bf16 v[160:163], v[84:87], v[176:179], v[160:163]
    s_mov_b32 s50, 1065369472
    s_mov_b32 s51, 1065369472
    v_mfma_f32_16x16x32_bf16 v[164:167], v[84:87], v[180:183], v[164:167]
    v_mov_b64 v[2:3], s[50:51]
    v_mov_b64 v[4:5], s[50:51]
    s_waitcnt lgkmcnt(8)
    v_mfma_f32_16x16x32_bf16 v[128:131], v[48:51], v[184:187], v[128:131]
    ds_read_b64_tr_b16 v[68:69], v22 offset:55296
    ds_read_b64_tr_b16 v[70:71], v22 offset:56576
    v_mfma_f32_16x16x32_bf16 v[132:135], v[48:51], v[188:191], v[132:135]
    ds_read_b64_tr_b16 v[72:73], v22 offset:55336
    ds_read_b64_tr_b16 v[74:75], v22 offset:56616
    v_mov_b64 v[6:7], s[50:51]
    v_mov_b64 v[8:9], s[50:51]
    s_waitcnt lgkmcnt(10)
    v_mfma_f32_16x16x32_bf16 v[136:139], v[52:55], v[184:187], v[136:139]
    ds_read_b64_tr_b16 v[76:77], v22 offset:55376
    ds_read_b64_tr_b16 v[78:79], v22 offset:56656
    v_mov_b64 v[92:93], s[50:51]
    v_mov_b64 v[94:95], s[50:51]
    v_mfma_f32_16x16x32_bf16 v[140:143], v[52:55], v[188:191], v[140:143]
    ds_read_b64_tr_b16 v[80:81], v22 offset:55416
    ds_read_b64_tr_b16 v[82:83], v22 offset:56696
    v_mov_b64 v[100:101], s[50:51]
    v_mov_b64 v[102:103], s[50:51]
    s_waitcnt lgkmcnt(12)
    s_cbranch_execz L_pfret
    v_mfma_f32_16x16x32_bf16 v[144:147], v[56:59], v[184:187], v[144:147]
    ds_read_b64_tr_b16 v[84:85], v23 offset:55296
    ds_read_b64_tr_b16 v[86:87], v23 offset:56576
    s_movk_i32 s51, 0x3f80
    v_mov_b64 v[40:41], s[50:51]
    v_mfma_f32_16x16x32_bf16 v[148:151], v[56:59], v[188:191], v[148:151]
    v_mov_b64 v[42:43], s[50:51]
    v_mov_b64 v[44:45], s[50:51]
    s_waitcnt lgkmcnt(12)
    v_mfma_f32_16x16x32_bf16 v[152:155], v[60:63], v[184:187], v[152:155]
    v_mov_b64 v[46:47], s[50:51]
    v_mov_b64 v[108:109], 0
    v_mfma_f32_16x16x32_bf16 v[156:159], v[60:63], v[188:191], v[156:159]
    v_mov_b64 v[110:111], 0
    v_lshrrev_b32 v116, 5, v0
    s_waitcnt lgkmcnt(10)
    v_mfma_f32_16x16x32_bf16 v[160:163], v[64:67], v[184:187], v[160:163]
    v_and_b32 v117, 31, v0
    v_lshlrev_b32 v116, 2, v116
    v_mfma_f32_16x16x32_bf16 v[164:167], v[64:67], v[188:191], v[164:167]
    v_sub_u32 v116, v117, v116
    v_subrev_u32 v168, 0, v116
    s_waitcnt vmcnt(11) lgkmcnt(0)
    s_barrier
    v_mfma_f32_16x16x32_bf16 v[128:131], v[68:71], v[192:195], v[128:131]
    ds_read_b64_tr_b16 v[48:49], v14 offset:36864
    ds_read_b64_tr_b16 v[50:51], v14 offset:38144
    v_mfma_f32_16x16x32_bf16 v[132:135], v[68:71], v[196:199], v[132:135]
    ds_read_b64_tr_b16 v[52:53], v14 offset:36904
    ds_read_b64_tr_b16 v[54:55], v14 offset:38184
    v_and_b32 v168, s100, v168
    v_subrev_u32 v169, 1, v116
    v_mfma_f32_16x16x32_bf16 v[136:139], v[72:75], v[192:195], v[136:139]
    ds_read_b64_tr_b16 v[56:57], v14 offset:36944
    ds_read_b64_tr_b16 v[58:59], v14 offset:38224
    v_and_b32 v169, s100, v169
    v_subrev_u32 v170, 2, v116
    v_mfma_f32_16x16x32_bf16 v[140:143], v[72:75], v[196:199], v[140:143]
    ds_read_b64_tr_b16 v[60:61], v14 offset:36984
    ds_read_b64_tr_b16 v[62:63], v14 offset:38264
    v_and_b32 v170, s100, v170
    v_subrev_u32 v171, 3, v116
    s_nop 0
    s_cbranch_execz L_pfret
    v_mfma_f32_16x16x32_bf16 v[144:147], v[76:79], v[192:195], v[144:147]
    ds_read_b64_tr_b16 v[64:65], v15 offset:36864
    ds_read_b64_tr_b16 v[66:67], v15 offset:38144
    v_and_b32 v171, s100, v171
    v_subrev_u32 v172, 8, v116
    v_mfma_f32_16x16x32_bf16 v[148:151], v[76:79], v[196:199], v[148:151]
    v_and_b32 v172, s100, v172
    v_subrev_u32 v173, 9, v116
    v_mfma_f32_16x16x32_bf16 v[152:155], v[80:83], v[192:195], v[152:155]
    v_and_b32 v173, s100, v173
    v_subrev_u32 v174, 10, v116
    v_mfma_f32_16x16x32_bf16 v[156:159], v[80:83], v[196:199], v[156:159]
    v_and_b32 v174, s100, v174
    v_subrev_u32 v175, 11, v116
    v_mfma_f32_16x16x32_bf16 v[160:163], v[84:87], v[192:195], v[160:163]
    v_and_b32 v175, s100, v175
    v_subrev_u32 v176, 16, v116
    v_mfma_f32_16x16x32_bf16 v[164:167], v[84:87], v[196:199], v[164:167]
    v_and_b32 v176, s100, v176
    v_subrev_u32 v177, 17, v116
    s_waitcnt lgkmcnt(8)
    v_mfma_f32_16x16x32_bf16 v[128:131], v[48:51], v[200:203], v[128:131]
    ds_read_b64_tr_b16 v[68:69], v14 offset:47104
    ds_read_b64_tr_b16 v[70:71], v14 offset:48384
    v_mfma_f32_16x16x32_bf16 v[132:135], v[48:51], v[204:207], v[132:135]
    ds_read_b64_tr_b16 v[72:73], v14 offset:47144
    ds_read_b64_tr_b16 v[74:75], v14 offset:48424
    v_and_b32 v177, s100, v177
    v_subrev_u32 v178, 18, v116
    s_waitcnt lgkmcnt(10)
    v_mfma_f32_16x16x32_bf16 v[136:139], v[52:55], v[200:203], v[136:139]
    ds_read_b64_tr_b16 v[76:77], v14 offset:47184
    ds_read_b64_tr_b16 v[78:79], v14 offset:48464
    v_and_b32 v178, s100, v178
    v_subrev_u32 v179, 19, v116
    v_mfma_f32_16x16x32_bf16 v[140:143], v[52:55], v[204:207], v[140:143]
    ds_read_b64_tr_b16 v[80:81], v14 offset:47224
    ds_read_b64_tr_b16 v[82:83], v14 offset:48504
    v_and_b32 v179, s100, v179
    v_subrev_u32 v180, 24, v116
    s_waitcnt lgkmcnt(12)
    v_mfma_f32_16x16x32_bf16 v[144:147], v[56:59], v[200:203], v[144:147]
    s_cbranch_execz L_pfret
    ds_read_b64_tr_b16 v[84:85], v15 offset:47104
    ds_read_b64_tr_b16 v[86:87], v15 offset:48384
    v_and_b32 v180, s100, v180
    v_subrev_u32 v181, 25, v116
    v_mfma_f32_16x16x32_bf16 v[148:151], v[56:59], v[204:207], v[148:151]
    v_and_b32 v181, s100, v181
    v_subrev_u32 v182, 26, v116
    s_waitcnt lgkmcnt(12)
    v_mfma_f32_16x16x32_bf16 v[152:155], v[60:63], v[200:203], v[152:155]
    v_and_b32 v182, s100, v182
    v_subrev_u32 v183, 27, v116
    v_mfma_f32_16x16x32_bf16 v[156:159], v[60:63], v[204:207], v[156:159]
    v_and_b32 v183, s100, v183
    v_xor_b32 v184, s100, v168
    s_waitcnt lgkmcnt(10)
    v_mfma_f32_16x16x32_bf16 v[160:163], v[64:67], v[200:203], v[160:163]
    v_xor_b32 v185, s100, v169
    v_xor_b32 v186, s100, v170
    v_mfma_f32_16x16x32_bf16 v[164:167], v[64:67], v[204:207], v[164:167]
    v_xor_b32 v187, s100, v171
    v_xor_b32 v188, s100, v172
    s_waitcnt vmcnt(0)
    s_mov_b64 exec, 1
    s_bitcmp1_b32 s3, 1
    s_cbranch_scc0 L_fc0f
    buffer_store_dword v26, off, s[12:15], s75 offset:512
    s_branch L_fd0f
L_fc0f:
    buffer_store_dword v26, off, s[12:15], s75 offset:512 sc1
L_fd0f:
    s_mov_b64 exec, -1
    s_waitcnt lgkmcnt(0)
    s_barrier
    v_mfma_f32_16x16x32_bf16 v[128:131], v[68:71], v[208:211], v[128:131]
    ds_read_b64_tr_b16 v[48:49], v14 offset:0
    ds_read_b64_tr_b16 v[50:51], v14 offset:1280
    v_mfma_f32_16x16x32_bf16 v[132:135], v[68:71], v[212:215], v[132:135]
    ds_read_b64_tr_b16 v[52:53], v14 offset:40
    ds_read_b64_tr_b16 v[54:55], v14 offset:1320
    v_xor_b32 v189, s100, v173
    v_xor_b32 v190, s100, v174
    v_mfma_f32_16x16x32_bf16 v[136:139], v[72:75], v[208:211], v[136:139]
    ds_read_b64_tr_b16 v[56:57], v14 offset:80
    ds_read_b64_tr_b16 v[58:59], v14 offset:1360
    v_xor_b32 v191, s100, v175
    v_xor_b32 v192, s100, v176
    s_nop 0
    s_cbranch_execz L_pfret
    v_mfma_f32_16x16x32_bf16 v[140:143], v[72:75], v[212:215], v[140:143]
    ds_read_b64_tr_b16 v[60:61], v14 offset:120
    ds_read_b64_tr_b16 v[62:63], v14 offset:1400
    v_xor_b32 v193, s100, v177
    v_xor_b32 v194, s100, v178
    v_mfma_f32_16x16x32_bf16 v[144:147], v[76:79], v[208:211], v[144:147]
    ds_read_b64_tr_b16 v[64:65], v15 offset:0
    ds_read_b64_tr_b16 v[66:67], v15 offset:1280
    v_xor_b32 v195, s100, v179
    v_xor_b32 v196, s100, v180
    v_mfma_f32_16x16x32_bf16 v[148:151], v[76:79], v[212:215], v[148:151]
    v_xor_b32 v197, s100, v181
    v_xor_b32 v198, s100, v182
    v_mfma_f32_16x16x32_bf16 v[152:155], v[80:83], v[208:211], v[152:155]
    v_xor_b32 v199, s100, v183
    v_mfma_f32_16x16x32_bf16 v[156:159], v[80:83], v[212:215], v[156:159]
    v_mfma_f32_16x16x32_bf16 v[160:163], v[84:87], v[208:211], v[160:163]
    v_mfma_f32_16x16x32_bf16 v[164:167], v[84:87], v[212:215], v[164:167]
    s_waitcnt lgkmcnt(8)
    v_mfma_f32_16x16x32_bf16 v[128:131], v[48:51], v[216:219], v[128:131]
    ds_read_b64_tr_b16 v[68:69], v14 offset:10240
    ds_read_b64_tr_b16 v[70:71], v14 offset:11520
    v_mfma_f32_16x16x32_bf16 v[132:135], v[48:51], v[220:223], v[132:135]
    ds_read_b64_tr_b16 v[72:73], v14 offset:10280
    ds_read_b64_tr_b16 v[74:75], v14 offset:11560
    s_mul_i32 s52, s39, 1016
    s_sub_u32 s76, s64, s52
    s_lshl_b32 s52, s40, 6
    s_add_u32 s76, s76, s52
    s_lshl_b32 s52, s41, 2
    s_add_u32 s76, s76, s52
    s_waitcnt lgkmcnt(10)
    v_mfma_f32_16x16x32_bf16 v[136:139], v[52:55], v[216:219], v[136:139]
    ds_read_b64_tr_b16 v[76:77], v14 offset:10320
    ds_read_b64_tr_b16 v[78:79], v14 offset:11600
    v_mfma_f32_16x16x32_bf16 v[140:143], v[52:55], v[220:223], v[140:143]
    ds_read_b64_tr_b16 v[80:81], v14 offset:10360
    ds_read_b64_tr_b16 v[82:83], v14 offset:11640
    s_waitcnt lgkmcnt(12)
    s_cbranch_execz L_pfret
    v_mfma_f32_16x16x32_bf16 v[144:147], v[56:59], v[216:219], v[144:147]
    ds_read_b64_tr_b16 v[84:85], v15 offset:10240
    ds_read_b64_tr_b16 v[86:87], v15 offset:11520
    v_mfma_f32_16x16x32_bf16 v[148:151], v[56:59], v[220:223], v[148:151]
    s_waitcnt lgkmcnt(12)
    v_mfma_f32_16x16x32_bf16 v[152:155], v[60:63], v[216:219], v[152:155]
    v_mfma_f32_16x16x32_bf16 v[156:159], v[60:63], v[220:223], v[156:159]
    s_waitcnt lgkmcnt(10)
    v_mfma_f32_16x16x32_bf16 v[160:163], v[64:67], v[216:219], v[160:163]
    v_mfma_f32_16x16x32_bf16 v[164:167], v[64:67], v[220:223], v[164:167]
    buffer_load_dwordx2 v[254:255], off, s[12:15], s69 sc1
    s_xor_b32 s54, s75, 0x404
    buffer_load_dword v124, off, s[12:15], s54 offset:512 sc1
    s_lshl_b32 s46, s39, 4
    s_add_u32 s46, s46, s38
    s_lshl_b32 s46, s46, 2
    s_add_u32 s46, s46, s40
    s_lshl_b32 s46, s46, 1
    s_add_u32 s46, s46, s41
    s_mul_i32 s46, s46, 5120
    s_mul_i32 s47, s37, 20971520
    s_sub_u32 s46, s46, s47
    s_add_u32 s48, s46, 20971520
    s_lshl_b32 s49, s40, 1
    s_add_u32 s49, s49, s41
    s_mul_i32 s49, s49, 5120
    s_add_u32 s49, s49, 81920
    s_mov_b32 s53, 100000
    s_waitcnt lgkmcnt(0)
    s_barrier
    v_mfma_f32_16x16x32_bf16 v[128:131], v[68:71], v[224:227], v[128:131]
    ds_read_b64_tr_b16 v[48:49], v14 offset:57344
    ds_read_b64_tr_b16 v[50:51], v14 offset:58624
    v_mfma_f32_16x16x32_bf16 v[132:135], v[68:71], v[228:231], v[132:135]
    ds_read_b64_tr_b16 v[52:53], v14 offset:57384
    ds_read_b64_tr_b16 v[54:55], v14 offset:58664
    v_mfma_f32_16x16x32_bf16 v[136:139], v[72:75], v[224:227], v[136:139]
    ds_read_b64_tr_b16 v[56:57], v14 offset:57424
    s_cbranch_execz L_pfret
    ds_read_b64_tr_b16 v[58:59], v14 offset:58704
    v_mfma_f32_16x16x32_bf16 v[140:143], v[72:75], v[228:231], v[140:143]
    ds_read_b64_tr_b16 v[60:61], v14 offset:57464
    ds_read_b64_tr_b16 v[62:63], v14 offset:58744
    v_mfma_f32_16x16x32_bf16 v[144:147], v[76:79], v[224:227], v[144:147]
    ds_read_b64_tr_b16 v[64:65], v15 offset:57344
    ds_read_b64_tr_b16 v[66:67], v15 offset:58624
    v_mfma_f32_16x16x32_bf16 v[148:151], v[76:79], v[228:231], v[148:151]
    v_mfma_f32_16x16x32_bf16 v[152:155], v[80:83], v[224:227], v[152:155]
    v_mfma_f32_16x16x32_bf16 v[156:159], v[80:83], v[228:231], v[156:159]
    v_mfma_f32_16x16x32_bf16 v[160:163], v[84:87], v[224:227], v[160:163]
    v_mfma_f32_16x16x32_bf16 v[164:167], v[84:87], v[228:231], v[164:167]
    s_waitcnt vmcnt(0)
L_it0f28l:
    v_readfirstlane_b32 s46, v124
    s_nop 0
    s_cmp_eq_u32 s46, 0
    s_cbranch_scc1 L_it0f28r
    s_add_u32 m0, s49, 0
    s_add_u32 s47, s48, 0
    buffer_load_dwordx4 v1, s[12:15], s47 offen offset:0 lds
    buffer_load_dwordx4 v1, s[12:15], s47 offen offset:1024 lds
    buffer_load_dwordx4 v1, s[12:15], s47 offen offset:2048 lds
    buffer_load_dwordx4 v1, s[12:15], s47 offen offset:3072 lds
    s_add_u32 m0, s49, 4096
    s_add_u32 s47, s48, 4096
    buffer_load_dwordx4 v1, s[12:15], s47 offen offset:0 lds
    s_mov_b32 s53, 0
    s_branch L_it0f28
L_it0f28r:
    buffer_load_dword v124, off, s[12:15], s54 offset:512 sc1
L_it0f28:
    s_waitcnt lgkmcnt(8)
    v_mfma_f32_16x16x32_bf16 v[128:131], v[48:51], v[232:235], v[128:131]
    ds_read_b64_tr_b16 v[68:69], v14 offset:20480
    ds_read_b64_tr_b16 v[70:71], v14 offset:21760
    v_mfma_f32_16x16x32_bf16 v[132:135], v[48:51], v[236:239], v[132:135]
    ds_read_b64_tr_b16 v[72:73], v14 offset:20520
    ds_read_b64_tr_b16 v[74:75], v14 offset:21800
    s_waitcnt lgkmcnt(10)
    s_cbranch_execz L_pfret
    v_mfma_f32_16x16x32_bf16 v[136:139], v[52:55], v[232:235], v[136:139]
    ds_read_b64_tr_b16 v[76:77], v14 offset:20560
    ds_read_b64_tr_b16 v[78:79], v14 offset:21840
    v_mfma_f32_16x16x32_bf16 v[140:143], v[52:55], v[236:239], v[140:143]
    ds_read_b64_tr_b16 v[80:81], v14 offset:20600
    ds_read_b64_tr_b16 v[82:83], v14 offset:21880
    s_waitcnt lgkmcnt(12)
    v_mfma_f32_16x16x32_bf16 v[144:147], v[56:59], v[232:235], v[144:147]
    ds_read_b64_tr_b16 v[84:85], v15 offset:20480
    ds_read_b64_tr_b16 v[86:87], v15 offset:21760
    v_mfma_f32_16x16x32_bf16 v[148:151], v[56:59], v[236:239], v[148:151]
    s_waitcnt lgkmcnt(12)
    v_mfma_f32_16x16x32_bf16 v[152:155], v[60:63], v[232:235], v[152:155]
    v_mfma_f32_16x16x32_bf16 v[156:159], v[60:63], v[236:239], v[156:159]
    s_waitcnt lgkmcnt(10)
    v_mfma_f32_16x16x32_bf16 v[160:163], v[64:67], v[232:235], v[160:163]
    v_mfma_f32_16x16x32_bf16 v[164:167], v[64:67], v[236:239], v[164:167]
    s_cmp_eq_u32 s53, 0
    s_cbranch_scc1 L_it0f29
L_it0f29l:
    s_waitcnt vmcnt(0)
    v_readfirstlane_b32 s46, v124
    s_nop 0
    s_cmp_eq_u32 s46, 0
    s_cbranch_scc1 L_it0f29r
    s_add_u32 m0, s49, 0
    s_add_u32 s47, s48, 0
    buffer_load_dwordx4 v1, s[12:15], s47 offen offset:0 lds
    buffer_load_dwordx4 v1, s[12:15], s47 offen offset:1024 lds
    buffer_load_dwordx4 v1, s[12:15], s47 offen offset:2048 lds
    buffer_load_dwordx4 v1, s[12:15], s47 offen offset:3072 lds
    s_add_u32 m0, s49, 4096
    s_add_u32 s47, s48, 4096
    buffer_load_dwordx4 v1, s[12:15], s47 offen offset:0 lds
    s_mov_b32 s53, 0
    s_branch L_it0f29
L_it0f29r:
    buffer_load_dword v124, off, s[12:15], s54 offset:512 sc1
L_it0f29:
    s_waitcnt lgkmcnt(0)
    s_barrier
    v_mfma_f32_16x16x32_bf16 v[160:163], v[84:87], v[240:243], v[160:163]
    s_nop 0
    s_cbranch_execz L_pfret
    v_mfma_f32_16x16x32_bf16 v[164:167], v[84:87], v[244:247], v[164:167]
    v_mfma_f32_16x16x32_bf16 v[144:147], v[76:79], v[240:243], v[144:147]
    v_mfma_f32_16x16x32_bf16 v[148:151], v[76:79], v[244:247], v[148:151]
    v_mfma_f32_16x16x32_bf16 v[152:155], v[80:83], v[240:243], v[152:155]
    s_nop 4
    v_permlane32_swap_b32 v160, v164
    v_permlane32_swap_b32 v161, v165
    v_mfma_f32_16x16x32_bf16 v[156:159], v[80:83], v[244:247], v[156:159]
    v_permlane32_swap_b32 v162, v166
    v_permlane32_swap_b32 v163, v167
    v_mfma_f32_16x16x32_bf16 v[128:131], v[68:71], v[240:243], v[128:131]
    ds_write_b128 v26, v[144:147]
    ds_write_b128 v26, v[148:151] offset:1024
    v_mfma_f32_16x16x32_bf16 v[132:135], v[68:71], v[244:247], v[132:135]
    ds_write_b128 v26, v[164:167] offset:4096
    v_mfma_f32_16x16x32_bf16 v[136:139], v[72:75], v[240:243], v[136:139]
    ds_write_b128 v26, v[152:155] offset:2048
    v_mfma_f32_16x16x32_bf16 v[140:143], v[72:75], v[244:247], v[140:143]
    ds_write_b128 v26, v[156:159] offset:3072
    s_cmp_eq_u32 s53, 0
    s_cbranch_scc1 L_it0fz
L_it0fzl:
    s_waitcnt vmcnt(0)
    v_readfirstlane_b32 s46, v124
    s_sub_u32 s53, s53, 1
    s_cmp_eq_u32 s53, 0
    s_cselect_b32 s46, 1, s46
    s_cmp_eq_u32 s46, 0
    s_cbranch_scc1 L_it0fzr
    s_add_u32 m0, s49, 0
    s_add_u32 s47, s48, 0
    buffer_load_dwordx4 v1, s[12:15], s47 offen offset:0 lds
    buffer_load_dwordx4 v1, s[12:15], s47 offen offset:1024 lds
    buffer_load_dwordx4 v1, s[12:15], s47 offen offset:2048 lds
    buffer_load_dwordx4 v1, s[12:15], s47 offen offset:3072 lds
    s_add_u32 m0, s49, 4096
    s_add_u32 s47, s48, 4096
    buffer_load_dwordx4 v1, s[12:15], s47 offen offset:0 lds
    s_mov_b32 s53, 0
    s_branch L_it0fz
L_it0fzr:
    buffer_load_dword v124, off, s[12:15], s54 offset:512 sc1
    s_branch L_it0fzl
L_it0fz:
    s_cbranch_execz L_pfret
    s_waitcnt vmcnt(0)
    s_nop 3
    s_branch L_g_post
L_g_own0:
    s_add_u32 m0, s43, 122880
    s_add_u32 s57, s45, 247040
    buffer_load_dwordx4 v249, s[8:11], s57 offen offset:0 lds
    buffer_load_dwordx4 v250, s[8:11], s57 offen offset:1024 lds
    buffer_load_dwordx4 v251, s[8:11], s57 offen offset:2048 lds
    buffer_load_dwordx4 v252, s[8:11], s57 offen offset:3072 lds
    s_add_u32 m0, s43, 123904
    s_add_u32 s57, s45, 248064
    buffer_load_dwordx4 v253, s[8:11], s57 offen offset:3072 lds
    s_waitcnt vmcnt(7)
    s_barrier
    ds_read_b128 v[168:171], v6 offset:20480
    ds_read_b64_tr_b16 v[48:49], v14 offset:0
    ds_read_b64_tr_b16 v[50:51], v14 offset:1280
    ds_read_b128 v[172:175], v6 offset:22528
    ds_read_b64_tr_b16 v[52:53], v14 offset:40
    ds_read_b64_tr_b16 v[54:55], v14 offset:1320
    ds_read_b64_tr_b16 v[56:57], v14 offset:80
    ds_read_b64_tr_b16 v[58:59], v14 offset:1360
    ds_read_b64_tr_b16 v[60:61], v14 offset:120
    ds_read_b64_tr_b16 v[62:63], v14 offset:1400
    ds_read_b64_tr_b16 v[64:65], v15 offset:0
    ds_read_b64_tr_b16 v[66:67], v15 offset:1280
    s_waitcnt lgkmcnt(9)
    v_mfma_f32_16x16x32_bf16 v[88:91], v[48:51], v[168:171], 0
    ds_read_b128 v[40:43], v7 offset:20480
    ds_read_b64_tr_b16 v[68:69], v14 offset:10240
    s_waitcnt lgkmcnt(10)
    v_mfma_f32_16x16x32_bf16 v[92:95], v[48:51], v[172:175], 0
    ds_read_b64_tr_b16 v[70:71], v14 offset:11520
    ds_read_b128 v[44:47], v7 offset:22528
    v_add_u32 v22, 98304, v14
    s_cbranch_execz L_pfret
    v_add_u32 v23, 98304, v15
    v_add_u32 v8, 49152, v6
    s_waitcnt lgkmcnt(10)
    v_mfma_f32_16x16x32_bf16 v[96:99], v[52:55], v[168:171], 0
    ds_read_b64_tr_b16 v[72:73], v14 offset:10280
    ds_read_b64_tr_b16 v[74:75], v14 offset:11560
    v_add_u32 v9, 49152, v7
    s_getreg_b32 s3, hwreg(HW_REG_XCC_ID, 0, 3)
    s_or_b32 s3, s3, 8
    v_mfma_f32_16x16x32_bf16 v[100:103], v[52:55], v[172:175], 0
    ds_read_b64_tr_b16 v[76:77], v14 offset:10320
    ds_read_b64_tr_b16 v[78:79], v14 offset:11600
    v_lshlrev_b32 v1, 4, v0
    v_and_b32 v158, 15, v0
    v_lshrrev_b32 v159, 4, v0
    s_waitcnt lgkmcnt(12)
    v_mfma_f32_16x16x32_bf16 v[104:107], v[56:59], v[168:171], 0
    ds_read_b64_tr_b16 v[80:81], v14 offset:10360
    ds_read_b64_tr_b16 v[82:83], v14 offset:11640
    s_mov_b32 s24, s52
    s_and_b32 s25, s53, 0xffff
    s_mov_b32 s26, 256
    v_mfma_f32_16x16x32_bf16 v[108:111], v[56:59], v[172:175], 0
    ds_read_b64_tr_b16 v[84:85], v15 offset:10240
    ds_read_b64_tr_b16 v[86:87], v15 offset:11520
    s_mov_b32 s27, 0x00020000
    s_mov_b32 s32, s54
    s_and_b32 s33, s55, 0xffff
    s_waitcnt lgkmcnt(14)
    v_mfma_f32_16x16x32_bf16 v[112:115], v[60:63], v[168:171], 0
    s_add_u32 m0, s43, 143360
    s_add_u32 s57, s45, 492800
    buffer_load_dwordx4 v249, s[8:11], s57 offen offset:0 lds
    s_lshl_b32 s34, s37, 28
    s_mov_b32 s35, 0x00020000
    s_mul_i32 s46, s40, 10240
    v_mfma_f32_16x16x32_bf16 v[116:119], v[60:63], v[172:175], 0
    s_cbranch_execz L_pfret
    buffer_load_dwordx4 v250, s[8:11], s57 offen offset:1024 lds
    v_add_u32 v160, s46, v1
    s_lshl_b32 s47, s41, 11
    v_add_u32 v10, s47, v160
    s_waitcnt lgkmcnt(12)
    v_mfma_f32_16x16x32_bf16 v[120:123], v[64:67], v[168:171], 0
    buffer_load_dwordx4 v251, s[8:11], s57 offen offset:2048 lds
    v_add_u32 v11, 40960, v10
    v_add_u32 v12, 4096, v160
    v_add_u32 v13, 45056, v160
    v_mfma_f32_16x16x32_bf16 v[124:127], v[64:67], v[172:175], 0
    buffer_load_dwordx4 v252, s[8:11], s57 offen offset:3072 lds
    s_mul_i32 s48, s41, 5120
    s_add_u32 s48, s48, 81920
    v_add_u32 v28, s48, v160
    s_add_u32 m0, s43, 144384
    s_add_u32 s57, s45, 493824
    buffer_load_dwordx4 v253, s[8:11], s57 offen offset:3072 lds
    s_add_u32 s56, s0, 983040
    s_sub_u32 s57, s56, 2457600
    s_min_u32 s56, s56, s57
    buffer_load_dword v141, v133, s[8:11], s56 offen offset:1280
    s_add_u32 s56, s1, 512
    s_sub_u32 s57, s56, 1280
    s_min_u32 s56, s56, s57
    buffer_load_dword v140, v132, s[4:7], s56 offen offset:0
    s_lshl_b32 s56, s39, 4
    s_add_u32 s56, s56, s38
    s_lshl_b32 s56, s56, 3
    s_add_u32 s56, s56, s36
    s_lshl_b32 s56, s56, 10
    s_add_u32 s56, s56, 12582912
    v_mov_b64 v[240:241], -1
    v_mov_b64 v[242:243], -1
    v_lshlrev_b32 v244, 4, v0
    v_lshl_add_u32 v244, s37, 30, v244
    buffer_store_dwordx4 v[240:243], v244, s[12:15], s56 offen sc1
    s_waitcnt vmcnt(8) lgkmcnt(0)
    s_barrier
    v_mfma_f32_16x16x32_bf16 v[88:91], v[68:71], v[40:43], v[88:91]
    s_cbranch_execz L_pfret
    ds_read_b128 v[176:179], v6 offset:36864
    ds_read_b64_tr_b16 v[48:49], v22 offset:24576
    v_mfma_f32_16x16x32_bf16 v[92:95], v[68:71], v[44:47], v[92:95]
    ds_read_b64_tr_b16 v[50:51], v22 offset:25856
    ds_read_b128 v[180:183], v6 offset:38912
    v_and_b32 v161, 31, v0
    v_lshrrev_b32 v162, 5, v0
    v_lshlrev_b32 v163, 4, v161
    v_mfma_f32_16x16x32_bf16 v[96:99], v[72:75], v[40:43], v[96:99]
    ds_read_b64_tr_b16 v[52:53], v22 offset:24616
    ds_read_b64_tr_b16 v[54:55], v22 offset:25896
    v_lshl_add_u32 v163, v162, 8, v163
    s_add_u32 s46, s46, 5120
    v_add_u32 v163, s46, v163
    v_mfma_f32_16x16x32_bf16 v[100:103], v[72:75], v[44:47], v[100:103]
    ds_read_b64_tr_b16 v[56:57], v22 offset:24656
    ds_read_b64_tr_b16 v[58:59], v22 offset:25936
    v_cmp_gt_u32 vcc, 16, v161
    s_lshl_b32 s48, s41, 7
    s_add_u32 s46, s47, 0
    v_mfma_f32_16x16x32_bf16 v[104:107], v[76:79], v[40:43], v[104:107]
    ds_read_b64_tr_b16 v[60:61], v22 offset:24696
    ds_read_b64_tr_b16 v[62:63], v22 offset:25976
    s_add_u32 s49, s48, 3840
    v_mov_b32 v164, s49
    v_mov_b32 v165, s46
    v_mfma_f32_16x16x32_bf16 v[108:111], v[76:79], v[44:47], v[108:111]
    ds_read_b64_tr_b16 v[64:65], v23 offset:24576
    ds_read_b64_tr_b16 v[66:67], v23 offset:25856
    v_cndmask_b32 v164, v164, v165, vcc
    v_add_u32 v18, v163, v164
    v_add_u32 v19, 40960, v18
    v_mfma_f32_16x16x32_bf16 v[112:115], v[80:83], v[40:43], v[112:115]
    s_add_u32 m0, s43, 0
    s_add_u32 s57, s45, 738560
    buffer_load_dwordx4 v249, s[8:11], s57 offen offset:0 lds
    s_add_u32 s46, s47, 1024
    s_nop 0
    s_cbranch_execz L_pfret
    s_add_u32 s49, s48, 3904
    v_mov_b32 v164, s49
    v_mfma_f32_16x16x32_bf16 v[116:119], v[80:83], v[44:47], v[116:119]
    buffer_load_dwordx4 v250, s[8:11], s57 offen offset:1024 lds
    v_mov_b32 v165, s46
    v_cndmask_b32 v164, v164, v165, vcc
    v_add_u32 v20, v163, v164
    v_mfma_f32_16x16x32_bf16 v[120:123], v[84:87], v[40:43], v[120:123]
    buffer_load_dwordx4 v251, s[8:11], s57 offen offset:2048 lds
    v_add_u32 v21, 40960, v20
    s_mul_i32 s46, s36, 5120
    s_add_u32 s47, s46, 122880
    v_mfma_f32_16x16x32_bf16 v[124:127], v[84:87], v[44:47], v[124:127]
    buffer_load_dwordx4 v252, s[8:11], s57 offen offset:3072 lds
    v_add_u32 v26, s47, v1
    s_sub_u32 s47, 158720, s46
    v_add_u32 v27, s47, v1
    s_waitcnt lgkmcnt(9)
    v_mfma_f32_16x16x32_bf16 v[88:91], v[48:51], v[176:179], v[88:91]
    ds_read_b128 v[40:43], v7 offset:36864
    ds_read_b64_tr_b16 v[68:69], v22 offset:34816
    s_waitcnt lgkmcnt(10)
    v_mfma_f32_16x16x32_bf16 v[92:95], v[48:51], v[180:183], v[92:95]
    ds_read_b64_tr_b16 v[70:71], v22 offset:36096
    ds_read_b128 v[44:47], v7 offset:38912
    v_bfe_u32 v164, v0, 4, 1
    v_mul_u32_u24 v165, 20480, v164
    v_lshl_add_u32 v165, v158, 4, v165
    s_waitcnt lgkmcnt(10)
    v_mfma_f32_16x16x32_bf16 v[96:99], v[52:55], v[176:179], v[96:99]
    ds_read_b64_tr_b16 v[72:73], v22 offset:34856
    ds_read_b64_tr_b16 v[74:75], v22 offset:36136
    v_lshl_add_u32 v29, v162, 8, v165
    s_sub_u32 s46, s42, s39
    s_lshl_b32 s47, s40, 1
    v_mfma_f32_16x16x32_bf16 v[100:103], v[52:55], v[180:183], v[100:103]
    ds_read_b64_tr_b16 v[76:77], v22 offset:34896
    s_cbranch_execz L_pfret
    ds_read_b64_tr_b16 v[78:79], v22 offset:36176
    s_add_u32 s46, s46, s47
    s_mul_i32 s46, s46, 20480
    s_add_u32 s46, s46, 6291456
    s_waitcnt lgkmcnt(12)
    v_mfma_f32_16x16x32_bf16 v[104:107], v[56:59], v[176:179], v[104:107]
    ds_read_b64_tr_b16 v[80:81], v22 offset:34936
    ds_read_b64_tr_b16 v[82:83], v22 offset:36216
    s_lshl_b32 s47, s40, 5
    s_add_u32 s47, s47, s41
    s_lshl_b32 s47, s47, 2
    v_mfma_f32_16x16x32_bf16 v[108:111], v[56:59], v[180:183], v[108:111]
    ds_read_b64_tr_b16 v[84:85], v23 offset:34816
    ds_read_b64_tr_b16 v[86:87], v23 offset:36096
    s_add_u32 s75, s64, s47
    s_lshr_b32 s72, s39, 1
    s_mul_i32 s48, s72, 5120
    s_waitcnt lgkmcnt(14)
    v_mfma_f32_16x16x32_bf16 v[112:115], v[60:63], v[176:179], v[112:115]
    s_add_u32 m0, s43, 1024
    s_add_u32 s57, s45, 739584
    buffer_load_dwordx4 v253, s[8:11], s57 offen offset:3072 lds
    s_add_u32 s46, s46, s48
    s_and_b32 s47, s39, 1
    s_lshl_b32 s47, s47, 1
    v_mfma_f32_16x16x32_bf16 v[116:119], v[60:63], v[180:183], v[116:119]
    s_add_u32 s56, s0, 1474560
    s_sub_u32 s57, s56, 2457600
    s_min_u32 s56, s56, s57
    buffer_load_dword v143, v133, s[8:11], s56 offen offset:1280
    s_add_u32 s47, s47, s41
    s_lshl_b32 s48, s47, 10
    s_add_u32 s73, s46, s48
    s_waitcnt lgkmcnt(12)
    v_mfma_f32_16x16x32_bf16 v[120:123], v[64:67], v[176:179], v[120:123]
    s_add_u32 s56, s1, 768
    s_sub_u32 s57, s56, 1280
    s_min_u32 s56, s56, s57
    buffer_load_dword v142, v132, s[4:7], s56 offen offset:0
    s_lshl_b32 s48, s47, 8
    s_add_u32 s74, s46, s48
    s_cbranch_execz L_pfret
    s_add_u32 s74, s74, 4096
    v_mfma_f32_16x16x32_bf16 v[124:127], v[64:67], v[180:183], v[124:127]
    s_mul_i32 s47, s39, 160
    v_mul_u32_u24 v166, 205, v0
    v_lshrrev_b32 v166, 11, v166
    s_waitcnt vmcnt(10) lgkmcnt(0)
    s_barrier
    v_mfma_f32_16x16x32_bf16 v[88:91], v[68:71], v[40:43], v[88:91]
    ds_read_b128 v[184:187], v8 offset:4096
    ds_read_b64_tr_b16 v[48:49], v22 offset:45056
    v_mfma_f32_16x16x32_bf16 v[92:95], v[68:71], v[44:47], v[92:95]
    ds_read_b64_tr_b16 v[50:51], v22 offset:46336
    ds_read_b128 v[188:191], v8 offset:6144
    v_mul_u32_u24 v166, 1120, v166
    v_add3_u32 v30, v166, v1, s47
    v_add_u32 v165, 64, v0
    v_mfma_f32_16x16x32_bf16 v[96:99], v[72:75], v[40:43], v[96:99]
    ds_read_b64_tr_b16 v[52:53], v22 offset:45096
    ds_read_b64_tr_b16 v[54:55], v22 offset:46376
    v_mul_u32_u24 v166, 205, v165
    v_lshrrev_b32 v166, 11, v166
    v_mul_u32_u24 v166, 1120, v166
    v_mfma_f32_16x16x32_bf16 v[100:103], v[72:75], v[44:47], v[100:103]
    ds_read_b64_tr_b16 v[56:57], v22 offset:45136
    ds_read_b64_tr_b16 v[58:59], v22 offset:46416
    v_add3_u32 v31, v166, v1, s47
    v_add_u32 v165, 128, v0
    v_mul_u32_u24 v166, 205, v165
    v_mfma_f32_16x16x32_bf16 v[104:107], v[76:79], v[40:43], v[104:107]
    ds_read_b64_tr_b16 v[60:61], v22 offset:45176
    ds_read_b64_tr_b16 v[62:63], v22 offset:46456
    v_lshrrev_b32 v166, 11, v166
    v_mul_u32_u24 v166, 1120, v166
    v_add3_u32 v32, v166, v1, s47
    s_nop 0
    s_cbranch_execz L_pfret
    v_mfma_f32_16x16x32_bf16 v[108:111], v[76:79], v[44:47], v[108:111]
    ds_read_b64_tr_b16 v[64:65], v23 offset:45056
    ds_read_b64_tr_b16 v[66:67], v23 offset:46336
    v_add_u32 v165, 192, v0
    v_mul_u32_u24 v166, 205, v165
    v_lshrrev_b32 v166, 11, v166
    v_mfma_f32_16x16x32_bf16 v[112:115], v[80:83], v[40:43], v[112:115]
    s_add_u32 m0, s43, 122880
    s_add_u32 s57, s45, 984320
    s_sub_u32 s56, s57, 2457600
    s_min_u32 s57, s57, s56
    buffer_load_dwordx4 v249, s[8:11], s57 offen offset:0 lds
    v_mul_u32_u24 v166, 1120, v166
    v_add3_u32 v33, v166, v1, s47
    v_add_u32 v165, 256, v0
    v_mfma_f32_16x16x32_bf16 v[116:119], v[80:83], v[44:47], v[116:119]
    buffer_load_dwordx4 v250, s[8:11], s57 offen offset:1024 lds
    v_mul_u32_u24 v166, 205, v165
    v_lshrrev_b32 v166, 11, v166
    v_mul_u32_u24 v166, 1120, v166
    v_mfma_f32_16x16x32_bf16 v[120:123], v[84:87], v[40:43], v[120:123]
    buffer_load_dwordx4 v251, s[8:11], s57 offen offset:2048 lds
    v_add3_u32 v34, v166, v1, s47
    v_add_u32 v34, 1024, v34
    s_mul_i32 s71, s36, 5120
    v_mfma_f32_16x16x32_bf16 v[124:127], v[84:87], v[44:47], v[124:127]
    buffer_load_dwordx4 v252, s[8:11], s57 offen offset:3072 lds
    s_and_b32 s46, s36, 3
    s_mul_i32 s101, s46, 5120
    s_add_u32 s101, s101, 61440
    s_waitcnt lgkmcnt(9)
    v_mfma_f32_16x16x32_bf16 v[88:91], v[48:51], v[184:187], v[88:91]
    ds_read_b128 v[40:43], v9 offset:4096
    ds_read_b64_tr_b16 v[68:69], v22 offset:55296
    s_cbranch_execz L_pfret
    s_waitcnt lgkmcnt(10)
    v_mfma_f32_16x16x32_bf16 v[92:95], v[48:51], v[188:191], v[92:95]
    ds_read_b64_tr_b16 v[70:71], v22 offset:56576
    ds_read_b128 v[44:47], v9 offset:6144
    s_mul_i32 s47, s72, 5
    s_add_u32 s46, s46, s47
    s_mul_i32 s77, s46, 40960
    s_waitcnt lgkmcnt(10)
    v_mfma_f32_16x16x32_bf16 v[96:99], v[52:55], v[184:187], v[96:99]
    ds_read_b64_tr_b16 v[72:73], v22 offset:55336
    ds_read_b64_tr_b16 v[74:75], v22 offset:56616
    s_cmp_eq_u32 s41, 0
    s_cselect_b32 s58, -1, 0
    s_cselect_b32 s59, 0, -1
    s_not_b64 s[60:61], s[58:59]
    s_mov_b32 s62, 0x000fffff
    v_mfma_f32_16x16x32_bf16 v[100:103], v[52:55], v[188:191], v[100:103]
    ds_read_b64_tr_b16 v[76:77], v22 offset:55376
    ds_read_b64_tr_b16 v[78:79], v22 offset:56656
    s_mov_b32 s63, 0x000fffff
    v_bfe_u32 v165, v0, 2, 2
    v_and_b32 v166, 3, v0
    s_waitcnt lgkmcnt(12)
    v_mfma_f32_16x16x32_bf16 v[104:107], v[56:59], v[184:187], v[104:107]
    ds_read_b64_tr_b16 v[80:81], v22 offset:55416
    ds_read_b64_tr_b16 v[82:83], v22 offset:56696
    v_lshl_add_u32 v167, v164, 2, v165
    v_mad_u32_u24 v167, v162, 20, v167
    v_mul_u32_u24 v167, 160, v167
    v_mfma_f32_16x16x32_bf16 v[108:111], v[56:59], v[188:191], v[108:111]
    ds_read_b64_tr_b16 v[84:85], v23 offset:55296
    ds_read_b64_tr_b16 v[86:87], v23 offset:56576
    v_lshl_add_u32 v167, v166, 3, v167
    v_add_u32 v35, 61440, v167
    v_add_u32 v36, 112640, v167
    s_waitcnt lgkmcnt(14)
    v_mfma_f32_16x16x32_bf16 v[112:115], v[60:63], v[184:187], v[112:115]
    s_cbranch_execz L_pfret
    s_add_u32 m0, s43, 123904
    s_add_u32 s57, s45, 985344
    s_sub_u32 s56, s57, 2457600
    s_min_u32 s57, s57, s56
    buffer_load_dwordx4 v253, s[8:11], s57 offen offset:3072 lds
    v_mad_u32_u24 v167, v159, 40, v165
    v_mul_u32_u24 v167, 160, v167
    v_lshl_add_u32 v167, v166, 3, v167
    v_mfma_f32_16x16x32_bf16 v[116:119], v[60:63], v[188:191], v[116:119]
    s_add_u32 s56, s0, 1966080
    s_sub_u32 s57, s56, 2457600
    s_min_u32 s56, s56, s57
    buffer_load_dword v145, v133, s[8:11], s56 offen offset:1280
    v_add_u32 v37, 64000, v167
    v_add_u32 v38, 115200, v167
    s_lshl_b32 s46, s38, 2
    s_waitcnt lgkmcnt(12)
    v_mfma_f32_16x16x32_bf16 v[120:123], v[64:67], v[184:187], v[120:123]
    s_add_u32 s56, s1, 1024
    s_sub_u32 s57, s56, 1280
    s_min_u32 s56, s56, s57
    buffer_load_dword v144, v132, s[4:7], s56 offen offset:0
    s_add_u32 s47, s46, s40
    s_min_u32 s67, s47, 8
    s_add_u32 s46, s46, s36
    v_mfma_f32_16x16x32_bf16 v[124:127], v[64:67], v[188:191], v[124:127]
    s_cmp_lt_u32 s46, 8
    s_cselect_b32 s70, 1, 0
    s_cmp_eq_u32 s37, 0
    s_cselect_b32 s70, 1, s70
    s_mov_b32 s98, 1051011932
    s_waitcnt vmcnt(9) lgkmcnt(0)
    s_barrier
    v_mfma_f32_16x16x32_bf16 v[88:91], v[68:71], v[40:43], v[88:91]
    ds_read_b128 v[192:195], v6 offset:20480
    ds_read_b64_tr_b16 v[48:49], v14 offset:0
    v_mfma_f32_16x16x32_bf16 v[92:95], v[68:71], v[44:47], v[92:95]
    ds_read_b64_tr_b16 v[50:51], v14 offset:1280
    s_nop 0
    s_cbranch_execz L_pfret
    ds_read_b128 v[196:199], v6 offset:22528
    s_mov_b32 s99, s98
    s_sub_u32 s46, s46, 8
    s_mul_i32 s46, s46, 10240
    v_mfma_f32_16x16x32_bf16 v[96:99], v[72:75], v[40:43], v[96:99]
    ds_read_b64_tr_b16 v[52:53], v14 offset:40
    ds_read_b64_tr_b16 v[54:55], v14 offset:1320
    s_mul_i32 s47, s39, 655360
    s_add_u32 s68, s46, s47
    s_lshl_b32 s46, s41, 13
    v_mfma_f32_16x16x32_bf16 v[100:103], v[72:75], v[44:47], v[100:103]
    ds_read_b64_tr_b16 v[56:57], v14 offset:80
    ds_read_b64_tr_b16 v[58:59], v14 offset:1360
    s_and_b32 s47, s36, 3
    s_lshl_b32 s47, s47, 7
    s_add_u32 s46, s46, s47
    v_mfma_f32_16x16x32_bf16 v[104:107], v[76:79], v[40:43], v[104:107]
    ds_read_b64_tr_b16 v[60:61], v14 offset:120
    ds_read_b64_tr_b16 v[62:63], v14 offset:1400
    s_add_u32 s46, s46, s64
    s_sub_u32 s69, s46, 15872
    s_mov_b32 s100, 0xf0000000
    v_mfma_f32_16x16x32_bf16 v[108:111], v[76:79], v[44:47], v[108:111]
    ds_read_b64_tr_b16 v[64:65], v15 offset:0
    ds_read_b64_tr_b16 v[66:67], v15 offset:1280
    s_mov_b32 s18, 819200
    s_mov_b32 s19, 0x00020000
    s_mov_b32 s22, 5242880
    v_mfma_f32_16x16x32_bf16 v[112:115], v[80:83], v[40:43], v[112:115]
    s_add_u32 m0, s43, 143360
    s_add_u32 s57, s45, 1230080
    s_sub_u32 s56, s57, 2457600
    s_min_u32 s57, s57, s56
    buffer_load_dwordx4 v249, s[8:11], s57 offen offset:0 lds
    s_mov_b32 s23, 0x00020000
    s_mov_b32 s30, 25600
    s_cbranch_execz L_pfret
    s_mov_b32 s31, 0x00020000
    v_mfma_f32_16x16x32_bf16 v[116:119], v[80:83], v[44:47], v[116:119]
    buffer_load_dwordx4 v250, s[8:11], s57 offen offset:1024 lds
    s_and_b32 s17, s17, 0xffff
    s_and_b32 s21, s21, 0xffff
    s_and_b32 s29, s29, 0xffff
    v_mfma_f32_16x16x32_bf16 v[120:123], v[84:87], v[40:43], v[120:123]
    buffer_load_dwordx4 v251, s[8:11], s57 offen offset:2048 lds
    s_lshl_b32 s46, s39, 4
    s_add_u32 s46, s46, s38
    s_mul_i32 s46, s46, 40960
    v_mfma_f32_16x16x32_bf16 v[124:127], v[84:87], v[44:47], v[124:127]
    buffer_load_dwordx4 v252, s[8:11], s57 offen offset:3072 lds
    s_mul_i32 s47, s40, 10240
    s_add_u32 s46, s46, s47
    s_mul_i32 s47, s41, 5120
    s_waitcnt lgkmcnt(9)
    v_mfma_f32_16x16x32_bf16 v[88:91], v[48:51], v[192:195], v[88:91]
    ds_read_b128 v[40:43], v7 offset:20480
    ds_read_b64_tr_b16 v[68:69], v14 offset:10240
    s_waitcnt lgkmcnt(10)
    v_mfma_f32_16x16x32_bf16 v[92:95], v[48:51], v[196:199], v[92:95]
    ds_read_b64_tr_b16 v[70:71], v14 offset:11520
    ds_read_b128 v[44:47], v7 offset:22528
    s_add_u32 s65, s46, s47
    s_lshl_b32 s52, s39, 4
    s_add_u32 s52, s52, s38
    s_waitcnt lgkmcnt(10)
    v_mfma_f32_16x16x32_bf16 v[96:99], v[52:55], v[192:195], v[96:99]
    ds_read_b64_tr_b16 v[72:73], v14 offset:10280
    ds_read_b64_tr_b16 v[74:75], v14 offset:11560
    s_lshl_b32 s52, s52, 3
    s_add_u32 s52, s52, s36
    s_lshl_b32 s52, s52, 10
    v_mfma_f32_16x16x32_bf16 v[100:103], v[52:55], v[196:199], v[100:103]
    ds_read_b64_tr_b16 v[76:77], v14 offset:10320
    ds_read_b64_tr_b16 v[78:79], v14 offset:11600
    s_nop 0
    s_cbranch_execz L_pfret
    s_add_u32 s52, s52, 12582912
    s_cmp_lg_u32 s37, 0
    s_cselect_b64 vcc, -1, 0
    s_waitcnt lgkmcnt(12)
    v_mfma_f32_16x16x32_bf16 v[104:107], v[56:59], v[192:195], v[104:107]
    ds_read_b64_tr_b16 v[80:81], v14 offset:10360
    ds_read_b64_tr_b16 v[82:83], v14 offset:11640
    v_mfma_f32_16x16x32_bf16 v[108:111], v[56:59], v[196:199], v[108:111]
    ds_read_b64_tr_b16 v[84:85], v15 offset:10240
    ds_read_b64_tr_b16 v[86:87], v15 offset:11520
    s_waitcnt lgkmcnt(14)
    v_mfma_f32_16x16x32_bf16 v[112:115], v[60:63], v[192:195], v[112:115]
    s_add_u32 m0, s43, 144384
    s_add_u32 s57, s45, 1231104
    s_sub_u32 s56, s57, 2457600
    s_min_u32 s57, s57, s56
    buffer_load_dwordx4 v253, s[8:11], s57 offen offset:3072 lds
    v_mfma_f32_16x16x32_bf16 v[116:119], v[60:63], v[196:199], v[116:119]
    s_lshl_b32 s50, s37, 5
    s_add_u32 s50, s50, s38
    s_lshl_b32 s50, s50, 2
    s_lshl_b32 s51, s39, 2
    s_lshl_b32 s51, s3, s51
    v_mov_b32 v39, s51
    s_mov_b64 exec, 1
    buffer_atomic_or v39, v248, s[24:27], s50 offen sc1
    s_mov_b64 exec, -1
    s_waitcnt lgkmcnt(12)
    v_mfma_f32_16x16x32_bf16 v[120:123], v[64:67], v[192:195], v[120:123]
    s_and_b32 s56, s2, 0xf8
    s_add_u32 s56, s56, s36
    s_mul_i32 s56, s56, 3840
    s_add_u32 s56, s56, s0
    s_add_u32 s56, s56, 0
    s_sub_u32 s57, s56, 2457600
    s_min_u32 s56, s56, s57
    buffer_load_dword v146, v134, s[8:11], s56 offen offset:0
    v_mfma_f32_16x16x32_bf16 v[124:127], v[64:67], v[196:199], v[124:127]
    s_waitcnt vmcnt(9) lgkmcnt(0)
    s_barrier
    v_mfma_f32_16x16x32_bf16 v[88:91], v[68:71], v[40:43], v[88:91]
    s_nop 0
    s_cbranch_execz L_pfret
    ds_read_b128 v[200:203], v6 offset:36864
    ds_read_b64_tr_b16 v[48:49], v22 offset:24576
    v_mfma_f32_16x16x32_bf16 v[92:95], v[68:71], v[44:47], v[92:95]
    ds_read_b64_tr_b16 v[50:51], v22 offset:25856
    ds_read_b128 v[204:207], v6 offset:38912
    v_mfma_f32_16x16x32_bf16 v[96:99], v[72:75], v[40:43], v[96:99]
    ds_read_b64_tr_b16 v[52:53], v22 offset:24616
    ds_read_b64_tr_b16 v[54:55], v22 offset:25896
    v_mfma_f32_16x16x32_bf16 v[100:103], v[72:75], v[44:47], v[100:103]
    ds_read_b64_tr_b16 v[56:57], v22 offset:24656
    ds_read_b64_tr_b16 v[58:59], v22 offset:25936
    v_mfma_f32_16x16x32_bf16 v[104:107], v[76:79], v[40:43], v[104:107]
    ds_read_b64_tr_b16 v[60:61], v22 offset:24696
    ds_read_b64_tr_b16 v[62:63], v22 offset:25976
    v_mfma_f32_16x16x32_bf16 v[108:111], v[76:79], v[44:47], v[108:111]
    ds_read_b64_tr_b16 v[64:65], v23 offset:24576
    ds_read_b64_tr_b16 v[66:67], v23 offset:25856
    v_mfma_f32_16x16x32_bf16 v[112:115], v[80:83], v[40:43], v[112:115]
    s_add_u32 m0, s43, 0
    s_add_u32 s57, s45, 1475840
    s_sub_u32 s56, s57, 2457600
    s_min_u32 s57, s57, s56
    buffer_load_dwordx4 v249, s[8:11], s57 offen offset:0 lds
    v_mfma_f32_16x16x32_bf16 v[116:119], v[80:83], v[44:47], v[116:119]
    buffer_load_dwordx4 v250, s[8:11], s57 offen offset:1024 lds
    v_mfma_f32_16x16x32_bf16 v[120:123], v[84:87], v[40:43], v[120:123]
    buffer_load_dwordx4 v251, s[8:11], s57 offen offset:2048 lds
    v_mfma_f32_16x16x32_bf16 v[124:127], v[84:87], v[44:47], v[124:127]
    buffer_load_dwordx4 v252, s[8:11], s57 offen offset:3072 lds
    s_waitcnt lgkmcnt(9)
    v_mfma_f32_16x16x32_bf16 v[88:91], v[48:51], v[200:203], v[88:91]
    ds_read_b128 v[40:43], v7 offset:36864
    ds_read_b64_tr_b16 v[68:69], v22 offset:34816
    s_cbranch_execz L_pfret
    s_waitcnt lgkmcnt(10)
    v_mfma_f32_16x16x32_bf16 v[92:95], v[48:51], v[204:207], v[92:95]
    ds_read_b64_tr_b16 v[70:71], v22 offset:36096
    ds_read_b128 v[44:47], v7 offset:38912
    s_waitcnt lgkmcnt(10)
    v_mfma_f32_16x16x32_bf16 v[96:99], v[52:55], v[200:203], v[96:99]
    ds_read_b64_tr_b16 v[72:73], v22 offset:34856
    ds_read_b64_tr_b16 v[74:75], v22 offset:36136
    v_mfma_f32_16x16x32_bf16 v[100:103], v[52:55], v[204:207], v[100:103]
    ds_read_b64_tr_b16 v[76:77], v22 offset:34896
    ds_read_b64_tr_b16 v[78:79], v22 offset:36176
    s_waitcnt lgkmcnt(12)
    v_mfma_f32_16x16x32_bf16 v[104:107], v[56:59], v[200:203], v[104:107]
    ds_read_b64_tr_b16 v[80:81], v22 offset:34936
    ds_read_b64_tr_b16 v[82:83], v22 offset:36216
    v_mfma_f32_16x16x32_bf16 v[108:111], v[56:59], v[204:207], v[108:111]
    ds_read_b64_tr_b16 v[84:85], v23 offset:34816
    ds_read_b64_tr_b16 v[86:87], v23 offset:36096
    s_waitcnt lgkmcnt(14)
    v_mfma_f32_16x16x32_bf16 v[112:115], v[60:63], v[200:203], v[112:115]
    s_add_u32 m0, s43, 1024
    s_add_u32 s57, s45, 1476864
    s_sub_u32 s56, s57, 2457600
    s_min_u32 s57, s57, s56
    buffer_load_dwordx4 v253, s[8:11], s57 offen offset:3072 lds
    v_mfma_f32_16x16x32_bf16 v[116:119], v[60:63], v[204:207], v[116:119]
    s_and_b32 s56, s2, 0xf8
    s_add_u32 s56, s56, s36
    s_mul_i32 s56, s56, 3840
    s_add_u32 s56, s56, s0
    s_add_u32 s56, s56, 983040
    s_sub_u32 s57, s56, 2457600
    s_min_u32 s56, s56, s57
    buffer_load_dword v148, v134, s[8:11], s56 offen offset:0
    s_waitcnt lgkmcnt(12)
    v_mfma_f32_16x16x32_bf16 v[120:123], v[64:67], v[200:203], v[120:123]
    s_cbranch_execz L_pfret
    v_mfma_f32_16x16x32_bf16 v[124:127], v[64:67], v[204:207], v[124:127]
    s_waitcnt vmcnt(8) lgkmcnt(0)
    s_barrier
    v_mfma_f32_16x16x32_bf16 v[88:91], v[68:71], v[40:43], v[88:91]
    ds_read_b128 v[208:211], v8 offset:4096
    ds_read_b64_tr_b16 v[48:49], v22 offset:45056
    v_mfma_f32_16x16x32_bf16 v[92:95], v[68:71], v[44:47], v[92:95]
    ds_read_b64_tr_b16 v[50:51], v22 offset:46336
    ds_read_b128 v[212:215], v8 offset:6144
    v_mfma_f32_16x16x32_bf16 v[96:99], v[72:75], v[40:43], v[96:99]
    ds_read_b64_tr_b16 v[52:53], v22 offset:45096
    ds_read_b64_tr_b16 v[54:55], v22 offset:46376
    v_mfma_f32_16x16x32_bf16 v[100:103], v[72:75], v[44:47], v[100:103]
    ds_read_b64_tr_b16 v[56:57], v22 offset:45136
    ds_read_b64_tr_b16 v[58:59], v22 offset:46416
    v_mfma_f32_16x16x32_bf16 v[104:107], v[76:79], v[40:43], v[104:107]
    ds_read_b64_tr_b16 v[60:61], v22 offset:45176
    ds_read_b64_tr_b16 v[62:63], v22 offset:46456
    v_mfma_f32_16x16x32_bf16 v[108:111], v[76:79], v[44:47], v[108:111]
    ds_read_b64_tr_b16 v[64:65], v23 offset:45056
    ds_read_b64_tr_b16 v[66:67], v23 offset:46336
    v_mfma_f32_16x16x32_bf16 v[112:115], v[80:83], v[40:43], v[112:115]
    s_add_u32 m0, s43, 122880
    s_add_u32 s57, s45, 1721600
    s_sub_u32 s56, s57, 2457600
    s_min_u32 s57, s57, s56
    buffer_load_dwordx4 v249, s[8:11], s57 offen offset:0 lds
    v_mfma_f32_16x16x32_bf16 v[116:119], v[80:83], v[44:47], v[116:119]
    buffer_load_dwordx4 v250, s[8:11], s57 offen offset:1024 lds
    v_mfma_f32_16x16x32_bf16 v[120:123], v[84:87], v[40:43], v[120:123]
    buffer_load_dwordx4 v251, s[8:11], s57 offen offset:2048 lds
    v_mfma_f32_16x16x32_bf16 v[124:127], v[84:87], v[44:47], v[124:127]
    buffer_load_dwordx4 v252, s[8:11], s57 offen offset:3072 lds
    s_cbranch_execz L_pfret
    s_waitcnt lgkmcnt(9)
    v_mfma_f32_16x16x32_bf16 v[88:91], v[48:51], v[208:211], v[88:91]
    ds_read_b128 v[40:43], v9 offset:4096
    ds_read_b64_tr_b16 v[68:69], v22 offset:55296
    s_waitcnt lgkmcnt(10)
    v_mfma_f32_16x16x32_bf16 v[92:95], v[48:51], v[212:215], v[92:95]
    ds_read_b64_tr_b16 v[70:71], v22 offset:56576
    ds_read_b128 v[44:47], v9 offset:6144
    s_waitcnt lgkmcnt(10)
    v_mfma_f32_16x16x32_bf16 v[96:99], v[52:55], v[208:211], v[96:99]
    ds_read_b64_tr_b16 v[72:73], v22 offset:55336
    ds_read_b64_tr_b16 v[74:75], v22 offset:56616
    v_mfma_f32_16x16x32_bf16 v[100:103], v[52:55], v[212:215], v[100:103]
    ds_read_b64_tr_b16 v[76:77], v22 offset:55376
    ds_read_b64_tr_b16 v[78:79], v22 offset:56656
    s_waitcnt lgkmcnt(12)
    v_mfma_f32_16x16x32_bf16 v[104:107], v[56:59], v[208:211], v[104:107]
    ds_read_b64_tr_b16 v[80:81], v22 offset:55416
    ds_read_b64_tr_b16 v[82:83], v22 offset:56696
    v_mfma_f32_16x16x32_bf16 v[108:111], v[56:59], v[212:215], v[108:111]
    ds_read_b64_tr_b16 v[84:85], v23 offset:55296
    ds_read_b64_tr_b16 v[86:87], v23 offset:56576
    s_waitcnt lgkmcnt(14)
    v_mfma_f32_16x16x32_bf16 v[112:115], v[60:63], v[208:211], v[112:115]
    s_add_u32 m0, s43, 123904
    s_add_u32 s57, s45, 1722624
    s_sub_u32 s56, s57, 2457600
    s_min_u32 s57, s57, s56
    buffer_load_dwordx4 v253, s[8:11], s57 offen offset:3072 lds
    v_mfma_f32_16x16x32_bf16 v[116:119], v[60:63], v[212:215], v[116:119]
    s_mul_i32 s54, s36, 800
    s_add_u32 m0, s54, 77824
    s_mul_i32 s53, s39, 3200
    s_add_u32 s54, s54, s53
    s_mov_b32 exec_hi, 0x3ffff
    s_cbranch_execz L_pfret
    buffer_load_dwordx4 v1, s[28:31], s54 offen lds
    s_mov_b32 exec_hi, -1
    s_waitcnt lgkmcnt(12)
    v_mfma_f32_16x16x32_bf16 v[120:123], v[64:67], v[208:211], v[120:123]
    s_and_b32 s56, s2, 0xf8
    s_add_u32 s56, s56, s36
    s_mul_i32 s56, s56, 3840
    s_add_u32 s56, s56, s0
    s_add_u32 s56, s56, 1966080
    s_sub_u32 s57, s56, 2457600
    s_min_u32 s56, s56, s57
    buffer_load_dword v150, v134, s[8:11], s56 offen offset:0
    v_mfma_f32_16x16x32_bf16 v[124:127], v[64:67], v[212:215], v[124:127]
    s_waitcnt vmcnt(8) lgkmcnt(0)
    s_barrier
    v_mfma_f32_16x16x32_bf16 v[88:91], v[68:71], v[40:43], v[88:91]
    ds_read_b128 v[216:219], v6 offset:20480
    ds_read_b64_tr_b16 v[48:49], v14 offset:0
    v_mfma_f32_16x16x32_bf16 v[92:95], v[68:71], v[44:47], v[92:95]
    ds_read_b64_tr_b16 v[50:51], v14 offset:1280
    ds_read_b128 v[220:223], v6 offset:22528
    v_mfma_f32_16x16x32_bf16 v[96:99], v[72:75], v[40:43], v[96:99]
    ds_read_b64_tr_b16 v[52:53], v14 offset:40
    ds_read_b64_tr_b16 v[54:55], v14 offset:1320
    v_mfma_f32_16x16x32_bf16 v[100:103], v[72:75], v[44:47], v[100:103]
    ds_read_b64_tr_b16 v[56:57], v14 offset:80
    ds_read_b64_tr_b16 v[58:59], v14 offset:1360
    v_mfma_f32_16x16x32_bf16 v[104:107], v[76:79], v[40:43], v[104:107]
    ds_read_b64_tr_b16 v[60:61], v14 offset:120
    ds_read_b64_tr_b16 v[62:63], v14 offset:1400
    v_mfma_f32_16x16x32_bf16 v[108:111], v[76:79], v[44:47], v[108:111]
    ds_read_b64_tr_b16 v[64:65], v15 offset:0
    ds_read_b64_tr_b16 v[66:67], v15 offset:1280
    v_mfma_f32_16x16x32_bf16 v[112:115], v[80:83], v[40:43], v[112:115]
    s_add_u32 m0, s43, 143360
    s_cbranch_execz L_pfret
    s_add_u32 s57, s45, 1967360
    s_sub_u32 s56, s57, 2457600
    s_min_u32 s57, s57, s56
    buffer_load_dwordx4 v249, s[8:11], s57 offen offset:0 lds
    v_mfma_f32_16x16x32_bf16 v[116:119], v[80:83], v[44:47], v[116:119]
    buffer_load_dwordx4 v250, s[8:11], s57 offen offset:1024 lds
    v_mfma_f32_16x16x32_bf16 v[120:123], v[84:87], v[40:43], v[120:123]
    buffer_load_dwordx4 v251, s[8:11], s57 offen offset:2048 lds
    v_mfma_f32_16x16x32_bf16 v[124:127], v[84:87], v[44:47], v[124:127]
    buffer_load_dwordx4 v252, s[8:11], s57 offen offset:3072 lds
    s_waitcnt lgkmcnt(9)
    v_mfma_f32_16x16x32_bf16 v[88:91], v[48:51], v[216:219], v[88:91]
    ds_read_b128 v[40:43], v7 offset:20480
    ds_read_b64_tr_b16 v[68:69], v14 offset:10240
    s_waitcnt lgkmcnt(10)
    v_mfma_f32_16x16x32_bf16 v[92:95], v[48:51], v[220:223], v[92:95]
    ds_read_b64_tr_b16 v[70:71], v14 offset:11520
    ds_read_b128 v[44:47], v7 offset:22528
    s_waitcnt lgkmcnt(10)
    v_mfma_f32_16x16x32_bf16 v[96:99], v[52:55], v[216:219], v[96:99]
    ds_read_b64_tr_b16 v[72:73], v14 offset:10280
    ds_read_b64_tr_b16 v[74:75], v14 offset:11560
    v_mfma_f32_16x16x32_bf16 v[100:103], v[52:55], v[220:223], v[100:103]
    ds_read_b64_tr_b16 v[76:77], v14 offset:10320
    ds_read_b64_tr_b16 v[78:79], v14 offset:11600
    s_waitcnt lgkmcnt(12)
    v_mfma_f32_16x16x32_bf16 v[104:107], v[56:59], v[216:219], v[104:107]
    ds_read_b64_tr_b16 v[80:81], v14 offset:10360
    ds_read_b64_tr_b16 v[82:83], v14 offset:11640
    v_mfma_f32_16x16x32_bf16 v[108:111], v[56:59], v[220:223], v[108:111]
    ds_read_b64_tr_b16 v[84:85], v15 offset:10240
    ds_read_b64_tr_b16 v[86:87], v15 offset:11520
    s_waitcnt lgkmcnt(14)
    v_mfma_f32_16x16x32_bf16 v[112:115], v[60:63], v[216:219], v[112:115]
    s_nop 0
    s_cbranch_execz L_pfret
    s_add_u32 m0, s43, 144384
    s_add_u32 s57, s45, 1968384
    s_sub_u32 s56, s57, 2457600
    s_min_u32 s57, s57, s56
    buffer_load_dwordx4 v253, s[8:11], s57 offen offset:3072 lds
    v_mfma_f32_16x16x32_bf16 v[116:119], v[60:63], v[220:223], v[116:119]
    s_lshl_b32 s48, s37, 7
    v_and_b32 v39, 15, v0
    v_lshlrev_b32 v39, 2, v39
    buffer_load_dword v39, v39, s[24:27], s48 offen sc1
    s_waitcnt lgkmcnt(12)
    v_mfma_f32_16x16x32_bf16 v[120:123], v[64:67], v[216:219], v[120:123]
    v_mfma_f32_16x16x32_bf16 v[124:127], v[64:67], v[220:223], v[124:127]
    s_waitcnt vmcnt(8) lgkmcnt(0)
    s_barrier
    v_mfma_f32_16x16x32_bf16 v[88:91], v[68:71], v[40:43], v[88:91]
    ds_read_b128 v[224:227], v6 offset:36864
    ds_read_b64_tr_b16 v[48:49], v22 offset:24576
    v_mfma_f32_16x16x32_bf16 v[92:95], v[68:71], v[44:47], v[92:95]
    ds_read_b64_tr_b16 v[50:51], v22 offset:25856
    ds_read_b128 v[228:231], v6 offset:38912
    v_mfma_f32_16x16x32_bf16 v[96:99], v[72:75], v[40:43], v[96:99]
    ds_read_b64_tr_b16 v[52:53], v22 offset:24616
    ds_read_b64_tr_b16 v[54:55], v22 offset:25896
    v_mfma_f32_16x16x32_bf16 v[100:103], v[72:75], v[44:47], v[100:103]
    ds_read_b64_tr_b16 v[56:57], v22 offset:24656
    ds_read_b64_tr_b16 v[58:59], v22 offset:25936
    v_mfma_f32_16x16x32_bf16 v[104:107], v[76:79], v[40:43], v[104:107]
    ds_read_b64_tr_b16 v[60:61], v22 offset:24696
    ds_read_b64_tr_b16 v[62:63], v22 offset:25976
    v_mfma_f32_16x16x32_bf16 v[108:111], v[76:79], v[44:47], v[108:111]
    ds_read_b64_tr_b16 v[64:65], v23 offset:24576
    ds_read_b64_tr_b16 v[66:67], v23 offset:25856
    v_mfma_f32_16x16x32_bf16 v[112:115], v[80:83], v[40:43], v[112:115]
    s_add_u32 m0, s43, 0
    s_nop 0
    s_cbranch_execz L_pfret
    s_add_u32 s57, s45, 2213120
    s_sub_u32 s56, s57, 2457600
    s_min_u32 s57, s57, s56
    buffer_load_dwordx4 v249, s[8:11], s57 offen offset:0 lds
    v_mfma_f32_16x16x32_bf16 v[116:119], v[80:83], v[44:47], v[116:119]
    buffer_load_dwordx4 v250, s[8:11], s57 offen offset:1024 lds
    v_mfma_f32_16x16x32_bf16 v[120:123], v[84:87], v[40:43], v[120:123]
    buffer_load_dwordx4 v251, s[8:11], s57 offen offset:2048 lds
    v_mfma_f32_16x16x32_bf16 v[124:127], v[84:87], v[44:47], v[124:127]
    buffer_load_dwordx4 v252, s[8:11], s57 offen offset:3072 lds
    s_waitcnt lgkmcnt(9)
    v_mfma_f32_16x16x32_bf16 v[88:91], v[48:51], v[224:227], v[88:91]
    ds_read_b128 v[40:43], v7 offset:36864
    ds_read_b64_tr_b16 v[68:69], v22 offset:34816
    s_waitcnt lgkmcnt(10)
    v_mfma_f32_16x16x32_bf16 v[92:95], v[48:51], v[228:231], v[92:95]
    ds_read_b64_tr_b16 v[70:71], v22 offset:36096
    ds_read_b128 v[44:47], v7 offset:38912
    s_waitcnt lgkmcnt(10)
    v_mfma_f32_16x16x32_bf16 v[96:99], v[52:55], v[224:227], v[96:99]
    ds_read_b64_tr_b16 v[72:73], v22 offset:34856
    ds_read_b64_tr_b16 v[74:75], v22 offset:36136
    v_mfma_f32_16x16x32_bf16 v[100:103], v[52:55], v[228:231], v[100:103]
    ds_read_b64_tr_b16 v[76:77], v22 offset:34896
    ds_read_b64_tr_b16 v[78:79], v22 offset:36176
    s_waitcnt lgkmcnt(12)
    v_mfma_f32_16x16x32_bf16 v[104:107], v[56:59], v[224:227], v[104:107]
    ds_read_b64_tr_b16 v[80:81], v22 offset:34936
    ds_read_b64_tr_b16 v[82:83], v22 offset:36216
    v_mfma_f32_16x16x32_bf16 v[108:111], v[56:59], v[228:231], v[108:111]
    ds_read_b64_tr_b16 v[84:85], v23 offset:34816
    ds_read_b64_tr_b16 v[86:87], v23 offset:36096
    s_waitcnt lgkmcnt(14)
    v_mfma_f32_16x16x32_bf16 v[112:115], v[60:63], v[224:227], v[112:115]
    s_nop 0
    s_cbranch_execz L_pfret
    s_add_u32 m0, s43, 1024
    s_add_u32 s57, s45, 2214144
    s_sub_u32 s56, s57, 2457600
    s_min_u32 s57, s57, s56
    buffer_load_dwordx4 v253, s[8:11], s57 offen offset:3072 lds
    v_mfma_f32_16x16x32_bf16 v[116:119], v[60:63], v[228:231], v[116:119]
    s_mov_b32 s56, 0
    buffer_load_dword v152, v135, s[16:19], s56 offen offset:0
    s_waitcnt lgkmcnt(12)
    v_mfma_f32_16x16x32_bf16 v[120:123], v[64:67], v[224:227], v[120:123]
    s_mov_b32 s56, 327680
    buffer_load_dword v154, v135, s[16:19], s56 offen offset:0
    v_mfma_f32_16x16x32_bf16 v[124:127], v[64:67], v[228:231], v[124:127]
    s_mov_b32 s56, 655360
    buffer_load_dword v156, v135, s[16:19], s56 offen offset:0
    s_waitcnt vmcnt(9) lgkmcnt(0)
    s_barrier
    v_mfma_f32_16x16x32_bf16 v[88:91], v[68:71], v[40:43], v[88:91]
    ds_read_b128 v[232:235], v8 offset:4096
    ds_read_b64_tr_b16 v[48:49], v22 offset:45056
    v_mfma_f32_16x16x32_bf16 v[92:95], v[68:71], v[44:47], v[92:95]
    ds_read_b64_tr_b16 v[50:51], v22 offset:46336
    ds_read_b128 v[236:239], v8 offset:6144
    v_mfma_f32_16x16x32_bf16 v[96:99], v[72:75], v[40:43], v[96:99]
    ds_read_b64_tr_b16 v[52:53], v22 offset:45096
    ds_read_b64_tr_b16 v[54:55], v22 offset:46376
    v_mfma_f32_16x16x32_bf16 v[100:103], v[72:75], v[44:47], v[100:103]
    ds_read_b64_tr_b16 v[56:57], v22 offset:45136
    ds_read_b64_tr_b16 v[58:59], v22 offset:46416
    v_mfma_f32_16x16x32_bf16 v[104:107], v[76:79], v[40:43], v[104:107]
    ds_read_b64_tr_b16 v[60:61], v22 offset:45176
    ds_read_b64_tr_b16 v[62:63], v22 offset:46456
    v_mfma_f32_16x16x32_bf16 v[108:111], v[76:79], v[44:47], v[108:111]
    ds_read_b64_tr_b16 v[64:65], v23 offset:45056
    s_cbranch_execz L_pfret
    ds_read_b64_tr_b16 v[66:67], v23 offset:46336
    v_mfma_f32_16x16x32_bf16 v[112:115], v[80:83], v[40:43], v[112:115]
    s_mul_i32 s53, s39, 160
    s_and_b32 s54, s36, 1
    v_mul_u32_u24 v158, 205, v0
    v_lshrrev_b32 v158, 12, v158
    v_mul_u32_u24 v160, 20, v158
    v_sub_u32 v160, v0, v160
    v_mul_u32_u24 v161, 3840, v158
    v_lshl_add_u32 v249, v160, 4, v161
    v_mul_u32_u24 v160, 26, v160
    v_lshrrev_b32 v160, 8, v160
    v_mul_u32_u24 v161, 160, v160
    v_sub_u32 v249, v249, v161
    v_xor_b32 v160, s54, v160
    v_mul_u32_u24 v160, 122880, v160
    v_add3_u32 v249, v249, v160, s53
    s_add_u32 m0, s44, 122880
    s_add_u32 s57, s76, 0
    buffer_load_dwordx4 v249, s[8:11], s57 offen offset:0 lds
    v_mfma_f32_16x16x32_bf16 v[116:119], v[80:83], v[44:47], v[116:119]
    v_add_u32 v161, 64, v0
    v_mul_u32_u24 v158, 205, v161
    v_lshrrev_b32 v158, 12, v158
    v_mul_u32_u24 v160, 20, v158
    v_sub_u32 v160, v161, v160
    v_mul_u32_u24 v161, 3840, v158
    v_lshl_add_u32 v250, v160, 4, v161
    v_mul_u32_u24 v160, 26, v160
    v_lshrrev_b32 v160, 8, v160
    v_mul_u32_u24 v161, 160, v160
    v_sub_u32 v250, v250, v161
    v_xor_b32 v160, s54, v160
    v_mul_u32_u24 v160, 122880, v160
    v_add_u32 v160, -1024, v160
    v_add3_u32 v250, v250, v160, s53
    buffer_load_dwordx4 v250, s[8:11], s57 offen offset:1024 lds
    v_mfma_f32_16x16x32_bf16 v[120:123], v[84:87], v[40:43], v[120:123]
    v_add_u32 v161, 128, v0
    v_mul_u32_u24 v158, 205, v161
    s_cbranch_execz L_pfret
    v_lshrrev_b32 v158, 12, v158
    v_mul_u32_u24 v160, 20, v158
    v_sub_u32 v160, v161, v160
    v_mul_u32_u24 v161, 3840, v158
    v_lshl_add_u32 v251, v160, 4, v161
    v_mul_u32_u24 v160, 26, v160
    v_lshrrev_b32 v160, 8, v160
    v_mul_u32_u24 v161, 160, v160
    v_sub_u32 v251, v251, v161
    v_xor_b32 v160, s54, v160
    v_mul_u32_u24 v160, 122880, v160
    v_add_u32 v160, -2048, v160
    v_add3_u32 v251, v251, v160, s53
    s_mov_b64 exec, 0xffffffff
    buffer_load_dwordx4 v251, s[8:11], s57 offen offset:2048 lds
    s_mov_b64 exec, -1
    v_mfma_f32_16x16x32_bf16 v[124:127], v[84:87], v[44:47], v[124:127]
    s_waitcnt lgkmcnt(9)
    v_mfma_f32_16x16x32_bf16 v[88:91], v[48:51], v[232:235], v[88:91]
    ds_read_b128 v[40:43], v9 offset:4096
    ds_read_b64_tr_b16 v[68:69], v22 offset:55296
    s_waitcnt lgkmcnt(10)
    v_mfma_f32_16x16x32_bf16 v[92:95], v[48:51], v[236:239], v[92:95]
    ds_read_b64_tr_b16 v[70:71], v22 offset:56576
    ds_read_b128 v[44:47], v9 offset:6144
    s_waitcnt lgkmcnt(10)
    v_mfma_f32_16x16x32_bf16 v[96:99], v[52:55], v[232:235], v[96:99]
    ds_read_b64_tr_b16 v[72:73], v22 offset:55336
    ds_read_b64_tr_b16 v[74:75], v22 offset:56616
    v_mfma_f32_16x16x32_bf16 v[100:103], v[52:55], v[236:239], v[100:103]
    ds_read_b64_tr_b16 v[76:77], v22 offset:55376
    ds_read_b64_tr_b16 v[78:79], v22 offset:56656
    s_waitcnt lgkmcnt(12)
    v_mfma_f32_16x16x32_bf16 v[104:107], v[56:59], v[232:235], v[104:107]
    ds_read_b64_tr_b16 v[80:81], v22 offset:55416
    ds_read_b64_tr_b16 v[82:83], v22 offset:56696
    v_mfma_f32_16x16x32_bf16 v[108:111], v[56:59], v[236:239], v[108:111]
    s_nop 0
    s_cbranch_execz L_pfret
    ds_read_b64_tr_b16 v[84:85], v23 offset:55296
    ds_read_b64_tr_b16 v[86:87], v23 offset:56576
    s_waitcnt lgkmcnt(14)
    v_mfma_f32_16x16x32_bf16 v[112:115], v[60:63], v[232:235], v[112:115]
    v_mfma_f32_16x16x32_bf16 v[116:119], v[60:63], v[236:239], v[116:119]
    s_waitcnt lgkmcnt(12)
    v_mfma_f32_16x16x32_bf16 v[120:123], v[64:67], v[232:235], v[120:123]
    v_mfma_f32_16x16x32_bf16 v[124:127], v[64:67], v[236:239], v[124:127]
    s_waitcnt vmcnt(6)
    s_mov_b32 s48, 0x88888888
    v_and_b32 v254, s48, v39
    v_cmp_ne_u32 s[46:47], s48, v254
    s_nop 0
    s_cmp_eq_u64 s[46:47], 0
    s_cbranch_scc1 L_cnt_ok0
    s_mov_b32 s49, 100000
L_cnt_poll0:
    s_lshl_b32 s48, s37, 7
    v_and_b32 v39, 15, v0
    v_lshlrev_b32 v39, 2, v39
    buffer_load_dword v39, v39, s[24:27], s48 offen sc1
    s_waitcnt vmcnt(0)
    s_sub_u32 s49, s49, 1
    s_cbranch_scc1 L_cnt_ok0
    s_mov_b32 s48, 0x88888888
    v_and_b32 v254, s48, v39
    v_cmp_ne_u32 s[46:47], s48, v254
    s_nop 0
    s_cmp_eq_u64 s[46:47], 0
    s_cbranch_scc0 L_cnt_poll0
    s_nop 1
L_cnt_ok0:
    s_waitcnt lgkmcnt(0)
    s_barrier
    v_mfma_f32_16x16x32_bf16 v[88:91], v[68:71], v[40:43], v[88:91]
    ds_read_b128 v[240:243], v6 offset:20480
    ds_read_b64_tr_b16 v[48:49], v14 offset:0
    v_mfma_f32_16x16x32_bf16 v[92:95], v[68:71], v[44:47], v[92:95]
    ds_read_b64_tr_b16 v[50:51], v14 offset:1280
    ds_read_b128 v[244:247], v6 offset:22528
    v_mfma_f32_16x16x32_bf16 v[96:99], v[72:75], v[40:43], v[96:99]
    ds_read_b64_tr_b16 v[52:53], v14 offset:40
    ds_read_b64_tr_b16 v[54:55], v14 offset:1320
    s_nop 0
    s_cbranch_execz L_pfret
    v_mfma_f32_16x16x32_bf16 v[100:103], v[72:75], v[44:47], v[100:103]
    ds_read_b64_tr_b16 v[56:57], v14 offset:80
    ds_read_b64_tr_b16 v[58:59], v14 offset:1360
    v_mfma_f32_16x16x32_bf16 v[104:107], v[76:79], v[40:43], v[104:107]
    ds_read_b64_tr_b16 v[60:61], v14 offset:120
    ds_read_b64_tr_b16 v[62:63], v14 offset:1400
    v_mfma_f32_16x16x32_bf16 v[108:111], v[76:79], v[44:47], v[108:111]
    ds_read_b64_tr_b16 v[64:65], v15 offset:0
    ds_read_b64_tr_b16 v[66:67], v15 offset:1280
    v_mfma_f32_16x16x32_bf16 v[112:115], v[80:83], v[40:43], v[112:115]
    s_add_u32 m0, s44, 143360
    s_add_u32 s57, s76, 491520
    buffer_load_dwordx4 v249, s[8:11], s57 offen offset:0 lds
    v_mfma_f32_16x16x32_bf16 v[116:119], v[80:83], v[44:47], v[116:119]
    buffer_load_dwordx4 v250, s[8:11], s57 offen offset:1024 lds
    v_mfma_f32_16x16x32_bf16 v[120:123], v[84:87], v[40:43], v[120:123]
    s_mov_b64 exec, 0xffffffff
    buffer_load_dwordx4 v251, s[8:11], s57 offen offset:2048 lds
    s_mov_b64 exec, -1
    v_mfma_f32_16x16x32_bf16 v[124:127], v[84:87], v[44:47], v[124:127]
    s_add_u32 m0, s44, 36864
    s_add_u32 s57, s76, 983040
    s_sub_u32 s56, s57, 2457600
    s_min_u32 s57, s57, s56
    buffer_load_dwordx4 v249, s[8:11], s57 offen offset:0 lds
    s_waitcnt lgkmcnt(9)
    v_mfma_f32_16x16x32_bf16 v[88:91], v[48:51], v[240:243], v[88:91]
    ds_read_b128 v[40:43], v7 offset:20480
    ds_read_b64_tr_b16 v[68:69], v14 offset:10240
    s_waitcnt lgkmcnt(10)
    v_mfma_f32_16x16x32_bf16 v[92:95], v[48:51], v[244:247], v[92:95]
    ds_read_b64_tr_b16 v[70:71], v14 offset:11520
    ds_read_b128 v[44:47], v7 offset:22528
    s_waitcnt lgkmcnt(10)
    s_cbranch_execz L_pfret
    v_mfma_f32_16x16x32_bf16 v[96:99], v[52:55], v[240:243], v[96:99]
    ds_read_b64_tr_b16 v[72:73], v14 offset:10280
    ds_read_b64_tr_b16 v[74:75], v14 offset:11560
    v_mfma_f32_16x16x32_bf16 v[100:103], v[52:55], v[244:247], v[100:103]
    ds_read_b64_tr_b16 v[76:77], v14 offset:10320
    ds_read_b64_tr_b16 v[78:79], v14 offset:11600
    s_waitcnt lgkmcnt(12)
    v_mfma_f32_16x16x32_bf16 v[104:107], v[56:59], v[240:243], v[104:107]
    ds_read_b64_tr_b16 v[80:81], v14 offset:10360
    ds_read_b64_tr_b16 v[82:83], v14 offset:11640
    v_mfma_f32_16x16x32_bf16 v[108:111], v[56:59], v[244:247], v[108:111]
    ds_read_b64_tr_b16 v[84:85], v15 offset:10240
    ds_read_b64_tr_b16 v[86:87], v15 offset:11520
    s_waitcnt lgkmcnt(14)
    v_mfma_f32_16x16x32_bf16 v[112:115], v[60:63], v[240:243], v[112:115]
    buffer_load_dwordx4 v250, s[8:11], s57 offen offset:1024 lds
    v_mfma_f32_16x16x32_bf16 v[116:119], v[60:63], v[244:247], v[116:119]
    s_mov_b64 exec, 0xffffffff
    buffer_load_dwordx4 v251, s[8:11], s57 offen offset:2048 lds
    s_mov_b64 exec, -1
    s_waitcnt lgkmcnt(12)
    v_mfma_f32_16x16x32_bf16 v[120:123], v[64:67], v[240:243], v[120:123]
    s_add_u32 s47, s38, 1
    s_add_u32 s48, s38, 2
    s_mul_i32 s3, s3, 0x11111111
    v_readlane_b32 s46, v39, s38
    v_readlane_b32 s47, v39, s47
    v_readlane_b32 s48, v39, s48
    v_mfma_f32_16x16x32_bf16 v[124:127], v[64:67], v[244:247], v[124:127]
    s_lshl_b32 s49, s39, 2
    s_xor_b32 s47, s47, s3
    s_xor_b32 s48, s48, s3
    s_or_b32 s47, s47, s48
    s_lshr_b32 s47, s47, s49
    s_cmp_eq_u32 s46, s3
    s_cselect_b32 s3, 1, 0
    s_and_b32 s47, s47, 15
    s_cselect_b32 s47, 0, 2
    s_mul_i32 s47, s47, s3
    s_or_b32 s3, s3, s47
    s_cbranch_execz L_pfret
    s_waitcnt vmcnt(6) lgkmcnt(0)
    s_barrier
    v_mfma_f32_16x16x32_bf16 v[88:91], v[68:71], v[40:43], v[88:91]
    ds_read_b64_tr_b16 v[48:49], v22 offset:24576
    ds_read_b64_tr_b16 v[50:51], v22 offset:25856
    v_mfma_f32_16x16x32_bf16 v[92:95], v[68:71], v[44:47], v[92:95]
    ds_read_b64_tr_b16 v[52:53], v22 offset:24616
    ds_read_b64_tr_b16 v[54:55], v22 offset:25896
    v_mfma_f32_16x16x32_bf16 v[96:99], v[72:75], v[40:43], v[96:99]
    ds_read_b64_tr_b16 v[56:57], v22 offset:24656
    ds_read_b64_tr_b16 v[58:59], v22 offset:25936
    v_mfma_f32_16x16x32_bf16 v[100:103], v[72:75], v[44:47], v[100:103]
    ds_read_b64_tr_b16 v[60:61], v22 offset:24696
    ds_read_b64_tr_b16 v[62:63], v22 offset:25976
    v_mfma_f32_16x16x32_bf16 v[104:107], v[76:79], v[40:43], v[104:107]
    ds_read_b64_tr_b16 v[64:65], v23 offset:24576
    ds_read_b64_tr_b16 v[66:67], v23 offset:25856
    v_mfma_f32_16x16x32_bf16 v[108:111], v[76:79], v[44:47], v[108:111]
    v_mfma_f32_16x16x32_bf16 v[112:115], v[80:83], v[40:43], v[112:115]
    v_mfma_f32_16x16x32_bf16 v[116:119], v[80:83], v[44:47], v[116:119]
    v_mfma_f32_16x16x32_bf16 v[120:123], v[84:87], v[40:43], v[120:123]
    v_mfma_f32_16x16x32_bf16 v[124:127], v[84:87], v[44:47], v[124:127]
    s_cbranch_vccz L_ains0
L_aret0:
    s_waitcnt lgkmcnt(8)
    v_mfma_f32_16x16x32_bf16 v[128:131], v[48:51], v[168:171], 0
    ds_read_b64_tr_b16 v[68:69], v22 offset:34816
    ds_read_b64_tr_b16 v[70:71], v22 offset:36096
    v_mfma_f32_16x16x32_bf16 v[132:135], v[48:51], v[172:175], 0
    ds_read_b64_tr_b16 v[72:73], v22 offset:34856
    ds_read_b64_tr_b16 v[74:75], v22 offset:36136
    v_mov_b64 v[40:41], -1
    v_mov_b64 v[42:43], -1
    s_waitcnt lgkmcnt(10)
    v_mfma_f32_16x16x32_bf16 v[136:139], v[52:55], v[168:171], 0
    ds_read_b64_tr_b16 v[76:77], v22 offset:34896
    s_cbranch_execz L_pfret
    ds_read_b64_tr_b16 v[78:79], v22 offset:36176
    v_cvt_pk_bf16_f32 v88, v88, v89
    v_cvt_pk_bf16_f32 v89, v90, v91
    v_mfma_f32_16x16x32_bf16 v[140:143], v[52:55], v[172:175], 0
    ds_read_b64_tr_b16 v[80:81], v22 offset:34936
    ds_read_b64_tr_b16 v[82:83], v22 offset:36216
    v_cvt_pk_bf16_f32 v90, v92, v93
    v_cvt_pk_bf16_f32 v91, v94, v95
    s_waitcnt lgkmcnt(12)
    v_mfma_f32_16x16x32_bf16 v[144:147], v[56:59], v[168:171], 0
    ds_read_b64_tr_b16 v[84:85], v23 offset:34816
    ds_read_b64_tr_b16 v[86:87], v23 offset:36096
    v_permlane16_swap_b32 v88, v90
    v_permlane16_swap_b32 v89, v91
    v_mfma_f32_16x16x32_bf16 v[148:151], v[56:59], v[172:175], 0
    s_add_u32 m0, s44, 0
    s_add_u32 s57, s76, 1474560
    s_sub_u32 s56, s57, 2457600
    s_min_u32 s57, s57, s56
    buffer_load_dwordx4 v249, s[8:11], s57 offen offset:0 lds
    s_cbranch_vccz L_pa00
    buffer_store_dwordx4 v[88:91], v1, s[32:35], s65 offen offset:0 sc1
L_pa00:
    s_cbranch_vccnz L_pb00
    s_bitcmp1_b32 s36, 0
    s_cbranch_scc1 L_pk0
    buffer_store_dwordx4 v[120:123], v44, s[12:15], s48 offen sc1
    s_branch L_pb00
L_pk0:
    buffer_store_dwordx2 v[120:121], v44, s[12:15], s48 offen offset:1344 sc1
L_pb00:
    s_waitcnt lgkmcnt(12)
    v_mfma_f32_16x16x32_bf16 v[152:155], v[60:63], v[168:171], 0
    buffer_load_dwordx4 v250, s[8:11], s57 offen offset:1024 lds
    ds_write_b128 v28, v[88:91] offset:0
    v_cvt_pk_bf16_f32 v96, v96, v97
    v_mfma_f32_16x16x32_bf16 v[156:159], v[60:63], v[172:175], 0
    s_mov_b64 exec, 0xffffffff
    buffer_load_dwordx4 v251, s[8:11], s57 offen offset:2048 lds
    s_mov_b64 exec, -1
    s_nop 0
    s_cbranch_execz L_pfret
    v_cvt_pk_bf16_f32 v97, v98, v99
    v_cvt_pk_bf16_f32 v98, v100, v101
    s_waitcnt lgkmcnt(11)
    v_mfma_f32_16x16x32_bf16 v[160:163], v[64:67], v[168:171], 0
    s_add_u32 m0, s44, 57344
    s_add_u32 s57, s76, 1966080
    s_sub_u32 s56, s57, 2457600
    s_min_u32 s57, s57, s56
    buffer_load_dwordx4 v249, s[8:11], s57 offen offset:0 lds
    v_cvt_pk_bf16_f32 v99, v102, v103
    v_permlane16_swap_b32 v96, v98
    v_mfma_f32_16x16x32_bf16 v[164:167], v[64:67], v[172:175], 0
    buffer_load_dwordx4 v250, s[8:11], s57 offen offset:1024 lds
    v_permlane16_swap_b32 v97, v99
    s_cbranch_vccz L_pa01
    buffer_store_dwordx4 v[96:99], v1, s[32:35], s65 offen offset:1024 sc1
L_pa01:
    s_cbranch_vccnz L_pb01
    buffer_store_dwordx4 v[124:127], v45, s[12:15], s48 offen offset:16 sc1
L_pb01:
    s_mov_b64 exec, 0xffffffff
    buffer_load_dwordx4 v251, s[8:11], s57 offen offset:2048 lds
    s_mov_b64 exec, -1
    s_waitcnt vmcnt(11) lgkmcnt(0)
    s_barrier
    v_mfma_f32_16x16x32_bf16 v[128:131], v[68:71], v[176:179], v[128:131]
    ds_read_b64_tr_b16 v[48:49], v22 offset:45056
    ds_read_b64_tr_b16 v[50:51], v22 offset:46336
    v_mfma_f32_16x16x32_bf16 v[132:135], v[68:71], v[180:183], v[132:135]
    ds_read_b64_tr_b16 v[52:53], v22 offset:45096
    ds_read_b64_tr_b16 v[54:55], v22 offset:46376
    ds_write_b128 v28, v[96:99] offset:1024
    v_cvt_pk_bf16_f32 v104, v104, v105
    v_mfma_f32_16x16x32_bf16 v[136:139], v[72:75], v[176:179], v[136:139]
    ds_read_b64_tr_b16 v[56:57], v22 offset:45136
    ds_read_b64_tr_b16 v[58:59], v22 offset:46416
    v_cvt_pk_bf16_f32 v105, v106, v107
    v_cvt_pk_bf16_f32 v106, v108, v109
    s_cbranch_execz L_pfret
    v_mfma_f32_16x16x32_bf16 v[140:143], v[72:75], v[180:183], v[140:143]
    ds_read_b64_tr_b16 v[60:61], v22 offset:45176
    ds_read_b64_tr_b16 v[62:63], v22 offset:46456
    v_cvt_pk_bf16_f32 v107, v110, v111
    v_permlane16_swap_b32 v104, v106
    v_mfma_f32_16x16x32_bf16 v[144:147], v[76:79], v[176:179], v[144:147]
    ds_read_b64_tr_b16 v[64:65], v23 offset:45056
    ds_read_b64_tr_b16 v[66:67], v23 offset:46336
    v_permlane16_swap_b32 v105, v107
    s_cbranch_vccz L_pa02
    buffer_store_dwordx4 v[104:107], v1, s[32:35], s65 offen offset:2048 sc1
L_pa02:
    s_cbranch_vccnz L_pb02
    s_add_u32 m0, s71, 81920
    s_nop 0
    buffer_load_dwordx4 v30, s[16:19], s45 offen offset:0 lds
L_pb02:
    v_mfma_f32_16x16x32_bf16 v[148:151], v[76:79], v[180:183], v[148:151]
    ds_write_b128 v28, v[104:107] offset:2048
    v_cvt_pk_bf16_f32 v112, v112, v113
    v_mfma_f32_16x16x32_bf16 v[152:155], v[80:83], v[176:179], v[152:155]
    v_cvt_pk_bf16_f32 v113, v114, v115
    v_cvt_pk_bf16_f32 v114, v116, v117
    v_mfma_f32_16x16x32_bf16 v[156:159], v[80:83], v[180:183], v[156:159]
    v_cvt_pk_bf16_f32 v115, v118, v119
    v_permlane16_swap_b32 v112, v114
    v_mfma_f32_16x16x32_bf16 v[160:163], v[84:87], v[176:179], v[160:163]
    v_permlane16_swap_b32 v113, v115
    s_cbranch_vccz L_pa03
    buffer_store_dwordx4 v[112:115], v1, s[32:35], s65 offen offset:3072 sc1
L_pa03:
    s_cbranch_vccnz L_pb03
    s_add_u32 m0, s71, 81920
    s_nop 0
    buffer_load_dwordx4 v31, s[16:19], s45 offen offset:1024 lds
L_pb03:
    v_mfma_f32_16x16x32_bf16 v[164:167], v[84:87], v[180:183], v[164:167]
    ds_write_b128 v28, v[112:115] offset:3072
    v_cvt_pk_bf16_f32 v120, v120, v121
    s_waitcnt lgkmcnt(11)
    v_mfma_f32_16x16x32_bf16 v[128:131], v[48:51], v[184:187], v[128:131]
    s_cbranch_execz L_pfret
    ds_read_b64_tr_b16 v[68:69], v22 offset:55296
    ds_read_b64_tr_b16 v[70:71], v22 offset:56576
    v_mfma_f32_16x16x32_bf16 v[132:135], v[48:51], v[188:191], v[132:135]
    ds_read_b64_tr_b16 v[72:73], v22 offset:55336
    ds_read_b64_tr_b16 v[74:75], v22 offset:56616
    v_cvt_pk_bf16_f32 v121, v122, v123
    v_cvt_pk_bf16_f32 v122, v124, v125
    s_waitcnt lgkmcnt(13)
    v_mfma_f32_16x16x32_bf16 v[136:139], v[52:55], v[184:187], v[136:139]
    ds_read_b64_tr_b16 v[76:77], v22 offset:55376
    ds_read_b64_tr_b16 v[78:79], v22 offset:56656
    v_cvt_pk_bf16_f32 v123, v126, v127
    v_permlane16_swap_b32 v120, v122
    v_mfma_f32_16x16x32_bf16 v[140:143], v[52:55], v[188:191], v[140:143]
    ds_read_b64_tr_b16 v[80:81], v22 offset:55416
    ds_read_b64_tr_b16 v[82:83], v22 offset:56696
    v_permlane16_swap_b32 v121, v123
    s_add_u32 s55, s65, 4096
    s_waitcnt lgkmcnt(14)
    v_mfma_f32_16x16x32_bf16 v[144:147], v[56:59], v[184:187], v[144:147]
    ds_read_b64_tr_b16 v[84:85], v23 offset:55296
    ds_read_b64_tr_b16 v[86:87], v23 offset:56576
    s_cbranch_vccz L_pa04
    buffer_store_dwordx4 v[120:123], v1, s[32:35], s55 offen sc1
L_pa04:
    s_cbranch_vccnz L_pb04
    s_add_u32 m0, s71, 81920
    s_nop 0
    buffer_load_dwordx4 v32, s[16:19], s45 offen offset:2048 lds
L_pb04:
    v_mfma_f32_16x16x32_bf16 v[148:151], v[56:59], v[188:191], v[148:151]
    ds_write_b128 v28, v[120:123] offset:4096
    s_mul_i32 s43, s72, 5
    s_add_u32 s43, s43, 19
    s_sub_u32 s43, s43, s36
    s_sub_u32 s52, s43, 20
    s_cselect_b32 s43, s43, s52
    s_mul_i32 s43, s43, 40960
    s_waitcnt lgkmcnt(15)
    v_mfma_f32_16x16x32_bf16 v[152:155], v[60:63], v[184:187], v[152:155]
    s_cbranch_execz L_pfret
    s_mul_i32 s45, s72, 5
    s_add_u32 s45, s45, 4
    s_add_u32 s45, s45, s36
    s_sub_u32 s52, s45, 20
    s_cselect_b32 s45, s45, s52
    s_mul_i32 s45, s45, 40960
    v_mov_b32 v252, v30
    v_mfma_f32_16x16x32_bf16 v[156:159], v[60:63], v[188:191], v[156:159]
    v_mov_b32 v253, v31
    s_mov_b32 s50, 1065369472
    s_waitcnt lgkmcnt(13)
    v_mfma_f32_16x16x32_bf16 v[160:163], v[64:67], v[184:187], v[160:163]
    s_mov_b32 s51, 1065369472
    v_mov_b64 v[2:3], s[50:51]
    v_mfma_f32_16x16x32_bf16 v[164:167], v[64:67], v[188:191], v[164:167]
    v_mov_b64 v[4:5], s[50:51]
    v_mov_b64 v[6:7], s[50:51]
    s_waitcnt vmcnt(11) lgkmcnt(0)
    s_barrier
    v_mfma_f32_16x16x32_bf16 v[128:131], v[68:71], v[192:195], v[128:131]
    ds_read_b64_tr_b16 v[48:49], v14 offset:36864
    ds_read_b64_tr_b16 v[50:51], v14 offset:38144
    v_mfma_f32_16x16x32_bf16 v[132:135], v[68:71], v[196:199], v[132:135]
    ds_read_b64_tr_b16 v[52:53], v14 offset:36904
    ds_read_b64_tr_b16 v[54:55], v14 offset:38184
    v_mov_b64 v[8:9], s[50:51]
    v_mov_b64 v[92:93], s[50:51]
    v_mfma_f32_16x16x32_bf16 v[136:139], v[72:75], v[192:195], v[136:139]
    ds_read_b64_tr_b16 v[56:57], v14 offset:36944
    ds_read_b64_tr_b16 v[58:59], v14 offset:38224
    v_mov_b64 v[94:95], s[50:51]
    v_mov_b64 v[100:101], s[50:51]
    v_mfma_f32_16x16x32_bf16 v[140:143], v[72:75], v[196:199], v[140:143]
    ds_read_b64_tr_b16 v[60:61], v14 offset:36984
    ds_read_b64_tr_b16 v[62:63], v14 offset:38264
    v_mov_b64 v[102:103], s[50:51]
    s_movk_i32 s51, 0x3f80
    v_mfma_f32_16x16x32_bf16 v[144:147], v[76:79], v[192:195], v[144:147]
    ds_read_b64_tr_b16 v[64:65], v15 offset:36864
    ds_read_b64_tr_b16 v[66:67], v15 offset:38144
    v_mov_b64 v[40:41], s[50:51]
    v_mov_b64 v[42:43], s[50:51]
    s_cbranch_execz L_pfret
    v_mfma_f32_16x16x32_bf16 v[148:151], v[76:79], v[196:199], v[148:151]
    v_mov_b64 v[44:45], s[50:51]
    v_mov_b64 v[46:47], s[50:51]
    v_mfma_f32_16x16x32_bf16 v[152:155], v[80:83], v[192:195], v[152:155]
    v_mov_b64 v[108:109], 0
    v_mov_b64 v[110:111], 0
    v_mfma_f32_16x16x32_bf16 v[156:159], v[80:83], v[196:199], v[156:159]
    v_lshrrev_b32 v116, 5, v0
    v_and_b32 v117, 31, v0
    v_mfma_f32_16x16x32_bf16 v[160:163], v[84:87], v[192:195], v[160:163]
    v_lshlrev_b32 v116, 2, v116
    v_sub_u32 v116, v117, v116
    v_mfma_f32_16x16x32_bf16 v[164:167], v[84:87], v[196:199], v[164:167]
    v_subrev_u32 v168, 0, v116
    v_and_b32 v168, s100, v168
    s_waitcnt lgkmcnt(8)
    v_mfma_f32_16x16x32_bf16 v[128:131], v[48:51], v[200:203], v[128:131]
    ds_read_b64_tr_b16 v[68:69], v14 offset:47104
    ds_read_b64_tr_b16 v[70:71], v14 offset:48384
    v_mfma_f32_16x16x32_bf16 v[132:135], v[48:51], v[204:207], v[132:135]
    ds_read_b64_tr_b16 v[72:73], v14 offset:47144
    ds_read_b64_tr_b16 v[74:75], v14 offset:48424
    v_subrev_u32 v169, 1, v116
    v_and_b32 v169, s100, v169
    s_waitcnt lgkmcnt(10)
    v_mfma_f32_16x16x32_bf16 v[136:139], v[52:55], v[200:203], v[136:139]
    ds_read_b64_tr_b16 v[76:77], v14 offset:47184
    ds_read_b64_tr_b16 v[78:79], v14 offset:48464
    v_subrev_u32 v170, 2, v116
    v_and_b32 v170, s100, v170
    v_mfma_f32_16x16x32_bf16 v[140:143], v[52:55], v[204:207], v[140:143]
    ds_read_b64_tr_b16 v[80:81], v14 offset:47224
    ds_read_b64_tr_b16 v[82:83], v14 offset:48504
    v_subrev_u32 v171, 3, v116
    v_and_b32 v171, s100, v171
    s_waitcnt lgkmcnt(12)
    v_mfma_f32_16x16x32_bf16 v[144:147], v[56:59], v[200:203], v[144:147]
    ds_read_b64_tr_b16 v[84:85], v15 offset:47104
    ds_read_b64_tr_b16 v[86:87], v15 offset:48384
    v_subrev_u32 v172, 8, v116
    v_and_b32 v172, s100, v172
    v_mfma_f32_16x16x32_bf16 v[148:151], v[56:59], v[204:207], v[148:151]
    s_cbranch_execz L_pfret
    v_subrev_u32 v173, 9, v116
    v_and_b32 v173, s100, v173
    s_waitcnt lgkmcnt(12)
    v_mfma_f32_16x16x32_bf16 v[152:155], v[60:63], v[200:203], v[152:155]
    v_subrev_u32 v174, 10, v116
    v_and_b32 v174, s100, v174
    v_mfma_f32_16x16x32_bf16 v[156:159], v[60:63], v[204:207], v[156:159]
    v_subrev_u32 v175, 11, v116
    v_and_b32 v175, s100, v175
    s_waitcnt lgkmcnt(10)
    v_mfma_f32_16x16x32_bf16 v[160:163], v[64:67], v[200:203], v[160:163]
    v_subrev_u32 v176, 16, v116
    v_and_b32 v176, s100, v176
    v_mfma_f32_16x16x32_bf16 v[164:167], v[64:67], v[204:207], v[164:167]
    v_subrev_u32 v177, 17, v116
    v_and_b32 v177, s100, v177
    s_waitcnt vmcnt(7) lgkmcnt(0)
    s_barrier
    v_mfma_f32_16x16x32_bf16 v[128:131], v[68:71], v[208:211], v[128:131]
    ds_read_b64_tr_b16 v[48:49], v14 offset:0
    ds_read_b64_tr_b16 v[50:51], v14 offset:1280
    v_mfma_f32_16x16x32_bf16 v[132:135], v[68:71], v[212:215], v[132:135]
    ds_read_b64_tr_b16 v[52:53], v14 offset:40
    ds_read_b64_tr_b16 v[54:55], v14 offset:1320
    v_subrev_u32 v178, 18, v116
    v_and_b32 v178, s100, v178
    v_mfma_f32_16x16x32_bf16 v[136:139], v[72:75], v[208:211], v[136:139]
    ds_read_b64_tr_b16 v[56:57], v14 offset:80
    ds_read_b64_tr_b16 v[58:59], v14 offset:1360
    v_subrev_u32 v179, 19, v116
    v_and_b32 v179, s100, v179
    v_mfma_f32_16x16x32_bf16 v[140:143], v[72:75], v[212:215], v[140:143]
    ds_read_b64_tr_b16 v[60:61], v14 offset:120
    ds_read_b64_tr_b16 v[62:63], v14 offset:1400
    v_subrev_u32 v180, 24, v116
    v_and_b32 v180, s100, v180
    v_mfma_f32_16x16x32_bf16 v[144:147], v[76:79], v[208:211], v[144:147]
    ds_read_b64_tr_b16 v[64:65], v15 offset:0
    ds_read_b64_tr_b16 v[66:67], v15 offset:1280
    v_subrev_u32 v181, 25, v116
    v_and_b32 v181, s100, v181
    v_mfma_f32_16x16x32_bf16 v[148:151], v[76:79], v[212:215], v[148:151]
    v_subrev_u32 v182, 26, v116
    s_cbranch_execz L_pfret
    v_and_b32 v182, s100, v182
    v_mfma_f32_16x16x32_bf16 v[152:155], v[80:83], v[208:211], v[152:155]
    v_subrev_u32 v183, 27, v116
    v_and_b32 v183, s100, v183
    v_mfma_f32_16x16x32_bf16 v[156:159], v[80:83], v[212:215], v[156:159]
    v_xor_b32 v184, s100, v168
    v_xor_b32 v185, s100, v169
    v_mfma_f32_16x16x32_bf16 v[160:163], v[84:87], v[208:211], v[160:163]
    v_xor_b32 v186, s100, v170
    v_xor_b32 v187, s100, v171
    v_mfma_f32_16x16x32_bf16 v[164:167], v[84:87], v[212:215], v[164:167]
    v_xor_b32 v188, s100, v172
    v_xor_b32 v189, s100, v173
    s_cbranch_vccz L_w2f0
    s_waitcnt vmcnt(0)
L_w2f0:
    s_waitcnt vmcnt(3)
    s_mov_b64 exec, 1
    s_bitcmp1_b32 s3, 1
    s_cbranch_scc0 L_fc0
    buffer_store_dword v26, off, s[32:35], s75 offset:512
    s_branch L_fd0
L_fc0:
    buffer_store_dword v26, off, s[32:35], s75 offset:512 sc1
L_fd0:
    s_mov_b64 exec, -1
    s_waitcnt lgkmcnt(8)
    v_mfma_f32_16x16x32_bf16 v[128:131], v[48:51], v[216:219], v[128:131]
    ds_read_b64_tr_b16 v[68:69], v14 offset:10240
    ds_read_b64_tr_b16 v[70:71], v14 offset:11520
    v_mfma_f32_16x16x32_bf16 v[132:135], v[48:51], v[220:223], v[132:135]
    ds_read_b64_tr_b16 v[72:73], v14 offset:10280
    ds_read_b64_tr_b16 v[74:75], v14 offset:11560
    v_xor_b32 v190, s100, v174
    v_xor_b32 v191, s100, v175
    s_waitcnt lgkmcnt(10)
    v_mfma_f32_16x16x32_bf16 v[136:139], v[52:55], v[216:219], v[136:139]
    ds_read_b64_tr_b16 v[76:77], v14 offset:10320
    ds_read_b64_tr_b16 v[78:79], v14 offset:11600
    v_xor_b32 v192, s100, v176
    v_xor_b32 v193, s100, v177
    v_mfma_f32_16x16x32_bf16 v[140:143], v[52:55], v[220:223], v[140:143]
    ds_read_b64_tr_b16 v[80:81], v14 offset:10360
    ds_read_b64_tr_b16 v[82:83], v14 offset:11640
    v_xor_b32 v194, s100, v178
    v_xor_b32 v195, s100, v179
    s_waitcnt lgkmcnt(12)
    s_nop 0
    s_cbranch_execz L_pfret
    v_mfma_f32_16x16x32_bf16 v[144:147], v[56:59], v[216:219], v[144:147]
    ds_read_b64_tr_b16 v[84:85], v15 offset:10240
    ds_read_b64_tr_b16 v[86:87], v15 offset:11520
    v_xor_b32 v196, s100, v180
    v_xor_b32 v197, s100, v181
    v_mfma_f32_16x16x32_bf16 v[148:151], v[56:59], v[220:223], v[148:151]
    v_xor_b32 v198, s100, v182
    v_xor_b32 v199, s100, v183
    s_waitcnt lgkmcnt(12)
    v_mfma_f32_16x16x32_bf16 v[152:155], v[60:63], v[216:219], v[152:155]
    s_cbranch_vccnz L_pe00
    s_add_u32 s56, s0, 0
    buffer_load_dwordx4 v[104:107], v39, s[12:15], s56 offen sc1
    s_add_u32 s56, s0, 8192
    buffer_load_dwordx4 v[112:115], v39, s[12:15], s56 offen sc1
L_pe00:
    s_mul_i32 s52, s39, 1016
    s_sub_u32 s76, s64, s52
    s_lshl_b32 s52, s40, 6
    s_add_u32 s76, s76, s52
    s_lshl_b32 s52, s41, 2
    s_add_u32 s76, s76, s52
    v_mfma_f32_16x16x32_bf16 v[156:159], v[60:63], v[220:223], v[156:159]
    s_waitcnt lgkmcnt(10)
    v_mfma_f32_16x16x32_bf16 v[160:163], v[64:67], v[216:219], v[160:163]
    s_cbranch_vccnz L_pe01
    s_add_u32 s56, s0, 16384
    buffer_load_dwordx4 v[120:123], v39, s[12:15], s56 offen sc1
    s_add_u32 s56, s0, 24576
    buffer_load_dwordx4 v[124:127], v39, s[12:15], s56 offen sc1
L_pe01:
    v_mfma_f32_16x16x32_bf16 v[164:167], v[64:67], v[220:223], v[164:167]
    buffer_load_dwordx2 v[254:255], off, s[12:15], s69 sc1
    s_waitcnt lgkmcnt(0)
    s_barrier
    v_mfma_f32_16x16x32_bf16 v[128:131], v[68:71], v[224:227], v[128:131]
    ds_read_b64_tr_b16 v[48:49], v14 offset:57344
    ds_read_b64_tr_b16 v[50:51], v14 offset:58624
    v_mfma_f32_16x16x32_bf16 v[132:135], v[68:71], v[228:231], v[132:135]
    ds_read_b64_tr_b16 v[52:53], v14 offset:57384
    ds_read_b64_tr_b16 v[54:55], v14 offset:58664
    s_nop 0
    s_cbranch_execz L_pfret
    v_mfma_f32_16x16x32_bf16 v[136:139], v[72:75], v[224:227], v[136:139]
    ds_read_b64_tr_b16 v[56:57], v14 offset:57424
    ds_read_b64_tr_b16 v[58:59], v14 offset:58704
    v_mfma_f32_16x16x32_bf16 v[140:143], v[72:75], v[228:231], v[140:143]
    ds_read_b64_tr_b16 v[60:61], v14 offset:57464
    ds_read_b64_tr_b16 v[62:63], v14 offset:58744
    v_mfma_f32_16x16x32_bf16 v[144:147], v[76:79], v[224:227], v[144:147]
    ds_read_b64_tr_b16 v[64:65], v15 offset:57344
    ds_read_b64_tr_b16 v[66:67], v15 offset:58624
    v_mfma_f32_16x16x32_bf16 v[148:151], v[76:79], v[228:231], v[148:151]
    v_mfma_f32_16x16x32_bf16 v[152:155], v[80:83], v[224:227], v[152:155]
    s_cbranch_vccnz L_pe02
    s_add_u32 s56, s0, 32768
    buffer_load_dwordx4 v[200:203], v39, s[12:15], s56 offen sc1
    s_add_u32 s56, s0, 40960
    buffer_load_dwordx4 v[44:47], v39, s[12:15], s56 offen sc1
L_pe02:
    v_mfma_f32_16x16x32_bf16 v[156:159], v[80:83], v[228:231], v[156:159]
    v_mfma_f32_16x16x32_bf16 v[160:163], v[84:87], v[224:227], v[160:163]
    s_cbranch_vccnz L_pe03
    s_add_u32 s56, s0, 49152
    buffer_load_dwordx4 v[108:111], v39, s[12:15], s56 offen sc1
    s_add_u32 s56, s0, 57344
    buffer_load_dwordx4 v[116:119], v39, s[12:15], s56 offen sc1
L_pe03:
    v_mfma_f32_16x16x32_bf16 v[164:167], v[84:87], v[228:231], v[164:167]
    s_waitcnt lgkmcnt(8)
    v_mfma_f32_16x16x32_bf16 v[128:131], v[48:51], v[232:235], v[128:131]
    ds_read_b64_tr_b16 v[68:69], v14 offset:20480
    ds_read_b64_tr_b16 v[70:71], v14 offset:21760
    v_mfma_f32_16x16x32_bf16 v[132:135], v[48:51], v[236:239], v[132:135]
    ds_read_b64_tr_b16 v[72:73], v14 offset:20520
    ds_read_b64_tr_b16 v[74:75], v14 offset:21800
    s_waitcnt lgkmcnt(10)
    v_mfma_f32_16x16x32_bf16 v[136:139], v[52:55], v[232:235], v[136:139]
    s_nop 0
    s_cbranch_execz L_pfret
    ds_read_b64_tr_b16 v[76:77], v14 offset:20560
    ds_read_b64_tr_b16 v[78:79], v14 offset:21840
    v_mfma_f32_16x16x32_bf16 v[140:143], v[52:55], v[236:239], v[140:143]
    ds_read_b64_tr_b16 v[80:81], v14 offset:20600
    ds_read_b64_tr_b16 v[82:83], v14 offset:21880
    s_waitcnt lgkmcnt(12)
    v_mfma_f32_16x16x32_bf16 v[144:147], v[56:59], v[232:235], v[144:147]
    ds_read_b64_tr_b16 v[84:85], v15 offset:20480
    ds_read_b64_tr_b16 v[86:87], v15 offset:21760
    v_mfma_f32_16x16x32_bf16 v[148:151], v[56:59], v[236:239], v[148:151]
    s_waitcnt lgkmcnt(12)
    v_mfma_f32_16x16x32_bf16 v[152:155], v[60:63], v[232:235], v[152:155]
    s_cbranch_vccnz L_pe04
    s_add_u32 s56, s0, 65536
    buffer_load_dwordx4 v[168:171], v39, s[12:15], s56 offen sc1
    s_add_u32 s56, s0, 73728
    buffer_load_dwordx4 v[172:175], v39, s[12:15], s56 offen sc1
L_pe04:
    v_mfma_f32_16x16x32_bf16 v[156:159], v[60:63], v[236:239], v[156:159]
    s_waitcnt lgkmcnt(10)
    v_mfma_f32_16x16x32_bf16 v[160:163], v[64:67], v[232:235], v[160:163]
    s_cbranch_vccnz L_pe05
    s_add_u32 s56, s0, 81920
    buffer_load_dwordx4 v[176:179], v39, s[12:15], s56 offen sc1
    s_add_u32 s56, s0, 90112
    buffer_load_dwordx4 v[180:183], v39, s[12:15], s56 offen sc1
L_pe05:
    v_mfma_f32_16x16x32_bf16 v[164:167], v[64:67], v[236:239], v[164:167]
    s_waitcnt lgkmcnt(0)
    s_barrier
    v_mfma_f32_16x16x32_bf16 v[160:163], v[84:87], v[240:243], v[160:163]
    v_mfma_f32_16x16x32_bf16 v[164:167], v[84:87], v[244:247], v[164:167]
    v_mfma_f32_16x16x32_bf16 v[144:147], v[76:79], v[240:243], v[144:147]
    v_mfma_f32_16x16x32_bf16 v[148:151], v[76:79], v[244:247], v[148:151]
    v_mfma_f32_16x16x32_bf16 v[152:155], v[80:83], v[240:243], v[152:155]
    s_nop 4
    v_permlane32_swap_b32 v160, v164
    v_permlane32_swap_b32 v161, v165
    s_nop 0
    s_cbranch_execz L_pfret
    v_mfma_f32_16x16x32_bf16 v[156:159], v[80:83], v[244:247], v[156:159]
    v_permlane32_swap_b32 v162, v166
    v_permlane32_swap_b32 v163, v167
    v_mfma_f32_16x16x32_bf16 v[128:131], v[68:71], v[240:243], v[128:131]
    s_cbranch_vccnz L_pe06
    s_add_u32 s56, s0, 98304
    buffer_load_dwordx4 v[184:187], v39, s[12:15], s56 offen sc1
    s_add_u32 s56, s0, 106496
    buffer_load_dwordx4 v[188:191], v39, s[12:15], s56 offen sc1
L_pe06:
    ds_write_b128 v26, v[144:147]
    ds_write_b128 v26, v[148:151] offset:1024
    v_mfma_f32_16x16x32_bf16 v[132:135], v[68:71], v[244:247], v[132:135]
    ds_write_b128 v26, v[164:167] offset:4096
    v_mfma_f32_16x16x32_bf16 v[136:139], v[72:75], v[240:243], v[136:139]
    s_cbranch_vccnz L_pe07
    s_add_u32 s56, s0, 114688
    buffer_load_dwordx4 v[192:195], v39, s[12:15], s56 offen sc1
    s_add_u32 s56, s0, 122880
    buffer_load_dwordx4 v[196:199], v39, s[12:15], s56 offen sc1
L_pe07:
    ds_write_b128 v26, v[152:155] offset:2048
    v_mfma_f32_16x16x32_bf16 v[140:143], v[72:75], v[244:247], v[140:143]
    ds_write_b128 v26, v[156:159] offset:3072
    s_branch L_g_post
L_g_vpro:
    s_mul_i32 s44, s40, 2560
    s_mul_i32 s76, s40, 30720
    s_add_u32 s76, s76, s0
    s_lshl_b32 s43, s40, 12
    v_lshrrev_b32 v48, 3, v0
    v_and_b32 v50, 7, v0
    v_xor_b32 v50, v50, v49
    s_lshl_b32 s46, s38, 7
    s_lshl_b32 s47, s40, 5
    s_add_u32 s46, s46, s47
    v_add_u32 v48, s46, v48
    v_mul_u32_u24 v48, 1280, v48
    v_lshl_add_u32 v2, v50, 4, v48
    v_xor_b32 v3, 64, v2
    v_add_u32 v3, 9216, v3
    v_add_u32 v4, 18432, v2
    s_cbranch_execz L_pfret
    v_add_u32 v5, 18432, v3
    s_add_u32 m0, s43, 20480
    s_add_u32 s57, s1, 0
    buffer_load_dwordx4 v2, s[4:7], s57 offen offset:0 lds
    buffer_load_dwordx4 v3, s[4:7], s57 offen offset:1024 lds
    buffer_load_dwordx4 v4, s[4:7], s57 offen offset:2048 lds
    buffer_load_dwordx4 v5, s[4:7], s57 offen offset:3072 lds
    s_add_u32 s56, s0, 491520
    buffer_load_dword v139, v133, s[8:11], s56 offen offset:1280
    s_add_u32 s56, s1, 256
    buffer_load_dword v138, v132, s[4:7], s56 offen offset:0
    s_xor_b32 s40, s40, 3
    v_and_b32 v48, 15, v0
    v_bfe_u32 v50, v0, 1, 3
    v_xor_b32 v50, v50, v49
    s_lshl_b32 s46, s40, 12
    v_lshlrev_b32 v51, 7, v48
    v_lshl_add_u32 v51, v50, 4, v51
    v_add_u32 v6, s46, v51
    v_xor_b32 v7, 64, v6
    v_bfe_u32 v50, v0, 2, 2
    v_bfe_u32 v51, v0, 4, 1
    v_xor_b32 v51, 1, v51
    v_lshl_add_u32 v50, v49, 3, v50
    v_lshl_add_u32 v50, v50, 1, v51
    v_and_b32 v53, 3, v0
    v_mad_u32_u24 v54, v53, 40, 32
    v_lshlrev_b32 v53, 3, v53
    s_movk_i32 s46, 160
    v_mad_u32_u24 v14, v50, s46, v53
    v_mad_u32_u24 v15, v50, s46, v54
    s_andn2_b32 s46, s37, s39
    s_cbranch_scc0 L_g_own1
    s_add_u32 m0, s43, 36864
    s_add_u32 s57, s1, 128
    buffer_load_dwordx4 v2, s[4:7], s57 offen offset:0 lds
    buffer_load_dwordx4 v3, s[4:7], s57 offen offset:1024 lds
    buffer_load_dwordx4 v4, s[4:7], s57 offen offset:2048 lds
    s_nop 0
    s_cbranch_execz L_pfret
    buffer_load_dwordx4 v5, s[4:7], s57 offen offset:3072 lds
    s_waitcnt vmcnt(6)
    s_barrier
    ds_read_b128 v[40:43], v6 offset:20480
    ds_read_b64_tr_b16 v[48:49], v14 offset:0
    ds_read_b64_tr_b16 v[50:51], v14 offset:1280
    ds_read_b128 v[44:47], v6 offset:22528
    ds_read_b64_tr_b16 v[52:53], v14 offset:40
    ds_read_b64_tr_b16 v[54:55], v14 offset:1320
    ds_read_b64_tr_b16 v[56:57], v14 offset:80
    ds_read_b64_tr_b16 v[58:59], v14 offset:1360
    ds_read_b64_tr_b16 v[60:61], v14 offset:120
    ds_read_b64_tr_b16 v[62:63], v14 offset:1400
    ds_read_b64_tr_b16 v[64:65], v15 offset:0
    ds_read_b64_tr_b16 v[66:67], v15 offset:1280
    s_waitcnt lgkmcnt(9)
    v_mfma_f32_16x16x32_bf16 v[88:91], v[48:51], v[40:43], 0
    ds_read_b128 v[168:171], v7 offset:20480
    ds_read_b64_tr_b16 v[68:69], v14 offset:10240
    s_waitcnt lgkmcnt(10)
    v_mfma_f32_16x16x32_bf16 v[92:95], v[48:51], v[44:47], 0
    ds_read_b64_tr_b16 v[70:71], v14 offset:11520
    ds_read_b128 v[172:175], v7 offset:22528
    v_add_u32 v22, 98304, v14
    v_add_u32 v23, 98304, v15
    v_add_u32 v8, 49152, v6
    s_waitcnt lgkmcnt(10)
    v_mfma_f32_16x16x32_bf16 v[96:99], v[52:55], v[40:43], 0
    ds_read_b64_tr_b16 v[72:73], v14 offset:10280
    ds_read_b64_tr_b16 v[74:75], v14 offset:11560
    v_add_u32 v9, 49152, v7
    s_getreg_b32 s3, hwreg(HW_REG_XCC_ID, 0, 3)
    s_or_b32 s3, s3, 8
    v_mfma_f32_16x16x32_bf16 v[100:103], v[52:55], v[44:47], 0
    ds_read_b64_tr_b16 v[76:77], v14 offset:10320
    s_cbranch_execz L_pfret
    ds_read_b64_tr_b16 v[78:79], v14 offset:11600
    v_lshlrev_b32 v1, 4, v0
    v_and_b32 v158, 15, v0
    v_lshrrev_b32 v159, 4, v0
    s_waitcnt lgkmcnt(12)
    v_mfma_f32_16x16x32_bf16 v[104:107], v[56:59], v[40:43], 0
    ds_read_b64_tr_b16 v[80:81], v14 offset:10360
    ds_read_b64_tr_b16 v[82:83], v14 offset:11640
    s_mov_b32 s24, s52
    s_and_b32 s25, s53, 0xffff
    s_mov_b32 s26, 256
    v_mfma_f32_16x16x32_bf16 v[108:111], v[56:59], v[44:47], 0
    ds_read_b64_tr_b16 v[84:85], v15 offset:10240
    ds_read_b64_tr_b16 v[86:87], v15 offset:11520
    s_mov_b32 s27, 0x00020000
    s_mov_b32 s32, s54
    s_and_b32 s33, s55, 0xffff
    s_waitcnt lgkmcnt(14)
    v_mfma_f32_16x16x32_bf16 v[112:115], v[60:63], v[40:43], 0
    s_add_u32 m0, s43, 53248
    s_add_u32 s57, s1, 256
    buffer_load_dwordx4 v2, s[4:7], s57 offen offset:0 lds
    s_lshl_b32 s34, s37, 28
    s_mov_b32 s35, 0x00020000
    s_mul_i32 s46, s40, 10240
    v_mfma_f32_16x16x32_bf16 v[116:119], v[60:63], v[44:47], 0
    buffer_load_dwordx4 v3, s[4:7], s57 offen offset:1024 lds
    v_add_u32 v160, s46, v1
    s_lshl_b32 s47, s41, 11
    v_add_u32 v10, s47, v160
    s_waitcnt lgkmcnt(12)
    v_mfma_f32_16x16x32_bf16 v[120:123], v[64:67], v[40:43], 0
    buffer_load_dwordx4 v4, s[4:7], s57 offen offset:2048 lds
    v_add_u32 v11, 40960, v10
    v_add_u32 v12, 4096, v160
    v_add_u32 v13, 45056, v160
    v_mfma_f32_16x16x32_bf16 v[124:127], v[64:67], v[44:47], 0
    s_nop 0
    s_cbranch_execz L_pfret
    buffer_load_dwordx4 v5, s[4:7], s57 offen offset:3072 lds
    s_mul_i32 s48, s41, 5120
    s_add_u32 s48, s48, 81920
    v_add_u32 v28, s48, v160
    s_add_u32 s56, s0, 983040
    s_sub_u32 s57, s56, 2457600
    s_min_u32 s56, s56, s57
    buffer_load_dword v141, v133, s[8:11], s56 offen offset:1280
    s_add_u32 s56, s1, 512
    s_sub_u32 s57, s56, 1280
    s_min_u32 s56, s56, s57
    buffer_load_dword v140, v132, s[4:7], s56 offen offset:0
    s_lshl_b32 s56, s39, 4
    s_add_u32 s56, s56, s38
    s_lshl_b32 s56, s56, 3
    s_add_u32 s56, s56, s36
    s_lshl_b32 s56, s56, 10
    s_add_u32 s56, s56, 12582912
    v_mov_b64 v[240:241], -1
    v_mov_b64 v[242:243], -1
    v_lshlrev_b32 v244, 4, v0
    v_lshl_add_u32 v244, s37, 30, v244
    buffer_store_dwordx4 v[240:243], v244, s[12:15], s56 offen sc1
    s_waitcnt vmcnt(7) lgkmcnt(0)
    s_barrier
    v_mfma_f32_16x16x32_bf16 v[88:91], v[68:71], v[168:171], v[88:91]
    ds_read_b128 v[40:43], v6 offset:36864
    ds_read_b64_tr_b16 v[48:49], v22 offset:24576
    v_mfma_f32_16x16x32_bf16 v[92:95], v[68:71], v[172:175], v[92:95]
    ds_read_b64_tr_b16 v[50:51], v22 offset:25856
    ds_read_b128 v[44:47], v6 offset:38912
    v_and_b32 v161, 31, v0
    v_lshrrev_b32 v162, 5, v0
    v_lshlrev_b32 v163, 4, v161
    v_mfma_f32_16x16x32_bf16 v[96:99], v[72:75], v[168:171], v[96:99]
    ds_read_b64_tr_b16 v[52:53], v22 offset:24616
    ds_read_b64_tr_b16 v[54:55], v22 offset:25896
    v_lshl_add_u32 v163, v162, 8, v163
    s_add_u32 s46, s46, 5120
    v_add_u32 v163, s46, v163
    s_cbranch_execz L_pfret
    v_mfma_f32_16x16x32_bf16 v[100:103], v[72:75], v[172:175], v[100:103]
    ds_read_b64_tr_b16 v[56:57], v22 offset:24656
    ds_read_b64_tr_b16 v[58:59], v22 offset:25936
    v_cmp_gt_u32 vcc, 16, v161
    s_lshl_b32 s48, s41, 7
    s_add_u32 s46, s47, 0
    v_mfma_f32_16x16x32_bf16 v[104:107], v[76:79], v[168:171], v[104:107]
    ds_read_b64_tr_b16 v[60:61], v22 offset:24696
    ds_read_b64_tr_b16 v[62:63], v22 offset:25976
    s_add_u32 s49, s48, 3840
    v_mov_b32 v164, s49
    v_mov_b32 v165, s46
    v_mfma_f32_16x16x32_bf16 v[108:111], v[76:79], v[172:175], v[108:111]
    ds_read_b64_tr_b16 v[64:65], v23 offset:24576
    ds_read_b64_tr_b16 v[66:67], v23 offset:25856
    v_cndmask_b32 v164, v164, v165, vcc
    v_add_u32 v18, v163, v164
    v_add_u32 v19, 40960, v18
    v_mfma_f32_16x16x32_bf16 v[112:115], v[80:83], v[168:171], v[112:115]
    s_add_u32 m0, s43, 20480
    s_add_u32 s57, s1, 384
    buffer_load_dwordx4 v2, s[4:7], s57 offen offset:0 lds
    s_add_u32 s46, s47, 1024
    s_add_u32 s49, s48, 3904
    v_mov_b32 v164, s49
    v_mfma_f32_16x16x32_bf16 v[116:119], v[80:83], v[172:175], v[116:119]
    buffer_load_dwordx4 v3, s[4:7], s57 offen offset:1024 lds
    v_mov_b32 v165, s46
    v_cndmask_b32 v164, v164, v165, vcc
    v_add_u32 v20, v163, v164
    v_mfma_f32_16x16x32_bf16 v[120:123], v[84:87], v[168:171], v[120:123]
    buffer_load_dwordx4 v4, s[4:7], s57 offen offset:2048 lds
    v_add_u32 v21, 40960, v20
    s_mul_i32 s46, s36, 5120
    s_add_u32 s47, s46, 122880
    v_mfma_f32_16x16x32_bf16 v[124:127], v[84:87], v[172:175], v[124:127]
    buffer_load_dwordx4 v5, s[4:7], s57 offen offset:3072 lds
    s_cbranch_execz L_pfret
    v_add_u32 v26, s47, v1
    s_sub_u32 s47, 158720, s46
    v_add_u32 v27, s47, v1
    s_waitcnt lgkmcnt(9)
    v_mfma_f32_16x16x32_bf16 v[88:91], v[48:51], v[40:43], v[88:91]
    ds_read_b128 v[176:179], v7 offset:36864
    ds_read_b64_tr_b16 v[68:69], v22 offset:34816
    s_waitcnt lgkmcnt(10)
    v_mfma_f32_16x16x32_bf16 v[92:95], v[48:51], v[44:47], v[92:95]
    ds_read_b64_tr_b16 v[70:71], v22 offset:36096
    ds_read_b128 v[180:183], v7 offset:38912
    v_bfe_u32 v164, v0, 4, 1
    v_mul_u32_u24 v165, 20480, v164
    v_lshl_add_u32 v165, v158, 4, v165
    s_waitcnt lgkmcnt(10)
    v_mfma_f32_16x16x32_bf16 v[96:99], v[52:55], v[40:43], v[96:99]
    ds_read_b64_tr_b16 v[72:73], v22 offset:34856
    ds_read_b64_tr_b16 v[74:75], v22 offset:36136
    v_lshl_add_u32 v29, v162, 8, v165
    s_sub_u32 s46, s42, s39
    s_lshl_b32 s47, s40, 1
    v_mfma_f32_16x16x32_bf16 v[100:103], v[52:55], v[44:47], v[100:103]
    ds_read_b64_tr_b16 v[76:77], v22 offset:34896
    ds_read_b64_tr_b16 v[78:79], v22 offset:36176
    s_add_u32 s46, s46, s47
    s_mul_i32 s46, s46, 20480
    s_add_u32 s46, s46, 6291456
    s_waitcnt lgkmcnt(12)
    v_mfma_f32_16x16x32_bf16 v[104:107], v[56:59], v[40:43], v[104:107]
    ds_read_b64_tr_b16 v[80:81], v22 offset:34936
    ds_read_b64_tr_b16 v[82:83], v22 offset:36216
    s_lshl_b32 s47, s40, 5
    s_add_u32 s47, s47, s41
    s_lshl_b32 s47, s47, 2
    v_mfma_f32_16x16x32_bf16 v[108:111], v[56:59], v[44:47], v[108:111]
    ds_read_b64_tr_b16 v[84:85], v23 offset:34816
    ds_read_b64_tr_b16 v[86:87], v23 offset:36096
    s_add_u32 s75, s64, s47
    s_cbranch_execz L_pfret
    s_lshr_b32 s72, s39, 1
    s_mul_i32 s48, s72, 5120
    s_waitcnt lgkmcnt(14)
    v_mfma_f32_16x16x32_bf16 v[112:115], v[60:63], v[40:43], v[112:115]
    s_add_u32 s56, s0, 1474560
    s_sub_u32 s57, s56, 2457600
    s_min_u32 s56, s56, s57
    buffer_load_dword v143, v133, s[8:11], s56 offen offset:1280
    s_add_u32 s46, s46, s48
    s_and_b32 s47, s39, 1
    s_lshl_b32 s47, s47, 1
    v_mfma_f32_16x16x32_bf16 v[116:119], v[60:63], v[44:47], v[116:119]
    s_add_u32 s56, s1, 768
    s_sub_u32 s57, s56, 1280
    s_min_u32 s56, s56, s57
    buffer_load_dword v142, v132, s[4:7], s56 offen offset:0
    s_add_u32 s47, s47, s41
    s_lshl_b32 s48, s47, 10
    s_add_u32 s73, s46, s48
    s_waitcnt lgkmcnt(12)
    v_mfma_f32_16x16x32_bf16 v[120:123], v[64:67], v[40:43], v[120:123]
    s_lshl_b32 s48, s47, 8
    s_add_u32 s74, s46, s48
    s_add_u32 s74, s74, 4096
    v_mfma_f32_16x16x32_bf16 v[124:127], v[64:67], v[44:47], v[124:127]
    s_mul_i32 s47, s39, 160
    v_mul_u32_u24 v166, 205, v0
    v_lshrrev_b32 v166, 11, v166
    s_waitcnt vmcnt(9) lgkmcnt(0)
    s_barrier
    v_mfma_f32_16x16x32_bf16 v[88:91], v[68:71], v[176:179], v[88:91]
    ds_read_b128 v[40:43], v8 offset:4096
    ds_read_b64_tr_b16 v[48:49], v22 offset:45056
    v_mfma_f32_16x16x32_bf16 v[92:95], v[68:71], v[180:183], v[92:95]
    ds_read_b64_tr_b16 v[50:51], v22 offset:46336
    ds_read_b128 v[44:47], v8 offset:6144
    v_mul_u32_u24 v166, 1120, v166
    v_add3_u32 v30, v166, v1, s47
    v_add_u32 v165, 64, v0
    v_mfma_f32_16x16x32_bf16 v[96:99], v[72:75], v[176:179], v[96:99]
    s_cbranch_execz L_pfret
    ds_read_b64_tr_b16 v[52:53], v22 offset:45096
    ds_read_b64_tr_b16 v[54:55], v22 offset:46376
    v_mul_u32_u24 v166, 205, v165
    v_lshrrev_b32 v166, 11, v166
    v_mul_u32_u24 v166, 1120, v166
    v_mfma_f32_16x16x32_bf16 v[100:103], v[72:75], v[180:183], v[100:103]
    ds_read_b64_tr_b16 v[56:57], v22 offset:45136
    ds_read_b64_tr_b16 v[58:59], v22 offset:46416
    v_add3_u32 v31, v166, v1, s47
    v_add_u32 v165, 128, v0
    v_mul_u32_u24 v166, 205, v165
    v_mfma_f32_16x16x32_bf16 v[104:107], v[76:79], v[176:179], v[104:107]
    ds_read_b64_tr_b16 v[60:61], v22 offset:45176
    ds_read_b64_tr_b16 v[62:63], v22 offset:46456
    v_lshrrev_b32 v166, 11, v166
    v_mul_u32_u24 v166, 1120, v166
    v_add3_u32 v32, v166, v1, s47
    v_mfma_f32_16x16x32_bf16 v[108:111], v[76:79], v[180:183], v[108:111]
    ds_read_b64_tr_b16 v[64:65], v23 offset:45056
    ds_read_b64_tr_b16 v[66:67], v23 offset:46336
    v_add_u32 v165, 192, v0
    v_mul_u32_u24 v166, 205, v165
    v_lshrrev_b32 v166, 11, v166
    v_mfma_f32_16x16x32_bf16 v[112:115], v[80:83], v[176:179], v[112:115]
    s_add_u32 m0, s43, 36864
    s_add_u32 s57, s1, 512
    s_sub_u32 s56, s57, 1280
    s_min_u32 s57, s57, s56
    buffer_load_dwordx4 v2, s[4:7], s57 offen offset:0 lds
    v_mul_u32_u24 v166, 1120, v166
    v_add3_u32 v33, v166, v1, s47
    v_add_u32 v165, 256, v0
    v_mfma_f32_16x16x32_bf16 v[116:119], v[80:83], v[180:183], v[116:119]
    s_nop 0
    s_cbranch_execz L_pfret
    buffer_load_dwordx4 v3, s[4:7], s57 offen offset:1024 lds
    v_mul_u32_u24 v166, 205, v165
    v_lshrrev_b32 v166, 11, v166
    v_mul_u32_u24 v166, 1120, v166
    v_mfma_f32_16x16x32_bf16 v[120:123], v[84:87], v[176:179], v[120:123]
    buffer_load_dwordx4 v4, s[4:7], s57 offen offset:2048 lds
    v_add3_u32 v34, v166, v1, s47
    v_add_u32 v34, 1024, v34
    s_mul_i32 s71, s36, 5120
    v_mfma_f32_16x16x32_bf16 v[124:127], v[84:87], v[180:183], v[124:127]
    buffer_load_dwordx4 v5, s[4:7], s57 offen offset:3072 lds
    s_and_b32 s46, s36, 3
    s_mul_i32 s101, s46, 5120
    s_add_u32 s101, s101, 61440
    s_waitcnt lgkmcnt(9)
    v_mfma_f32_16x16x32_bf16 v[88:91], v[48:51], v[40:43], v[88:91]
    ds_read_b128 v[184:187], v9 offset:4096
    ds_read_b64_tr_b16 v[68:69], v22 offset:55296
    s_waitcnt lgkmcnt(10)
    v_mfma_f32_16x16x32_bf16 v[92:95], v[48:51], v[44:47], v[92:95]
    ds_read_b64_tr_b16 v[70:71], v22 offset:56576
    ds_read_b128 v[188:191], v9 offset:6144
    s_mul_i32 s47, s72, 5
    s_add_u32 s46, s46, s47
    s_mul_i32 s77, s46, 40960
    s_waitcnt lgkmcnt(10)
    v_mfma_f32_16x16x32_bf16 v[96:99], v[52:55], v[40:43], v[96:99]
    ds_read_b64_tr_b16 v[72:73], v22 offset:55336
    ds_read_b64_tr_b16 v[74:75], v22 offset:56616
    s_cmp_eq_u32 s41, 0
    s_cselect_b32 s58, -1, 0
    s_cselect_b32 s59, 0, -1
    s_not_b64 s[60:61], s[58:59]
    s_mov_b32 s62, 0x000fffff
    v_mfma_f32_16x16x32_bf16 v[100:103], v[52:55], v[44:47], v[100:103]
    ds_read_b64_tr_b16 v[76:77], v22 offset:55376
    ds_read_b64_tr_b16 v[78:79], v22 offset:56656
    s_cbranch_execz L_pfret
    s_mov_b32 s63, 0x000fffff
    v_bfe_u32 v165, v0, 2, 2
    v_and_b32 v166, 3, v0
    s_waitcnt lgkmcnt(12)
    v_mfma_f32_16x16x32_bf16 v[104:107], v[56:59], v[40:43], v[104:107]
    ds_read_b64_tr_b16 v[80:81], v22 offset:55416
    ds_read_b64_tr_b16 v[82:83], v22 offset:56696
    v_lshl_add_u32 v167, v164, 2, v165
    v_mad_u32_u24 v167, v162, 20, v167
    v_mul_u32_u24 v167, 160, v167
    v_mfma_f32_16x16x32_bf16 v[108:111], v[56:59], v[44:47], v[108:111]
    ds_read_b64_tr_b16 v[84:85], v23 offset:55296
    ds_read_b64_tr_b16 v[86:87], v23 offset:56576
    v_lshl_add_u32 v167, v166, 3, v167
    v_add_u32 v35, 61440, v167
    v_add_u32 v36, 112640, v167
    s_waitcnt lgkmcnt(14)
    v_mfma_f32_16x16x32_bf16 v[112:115], v[60:63], v[40:43], v[112:115]
    s_add_u32 s56, s0, 1966080
    s_sub_u32 s57, s56, 2457600
    s_min_u32 s56, s56, s57
    buffer_load_dword v145, v133, s[8:11], s56 offen offset:1280
    v_mad_u32_u24 v167, v159, 40, v165
    v_mul_u32_u24 v167, 160, v167
    v_lshl_add_u32 v167, v166, 3, v167
    v_mfma_f32_16x16x32_bf16 v[116:119], v[60:63], v[44:47], v[116:119]
    s_add_u32 s56, s1, 1024
    s_sub_u32 s57, s56, 1280
    s_min_u32 s56, s56, s57
    buffer_load_dword v144, v132, s[4:7], s56 offen offset:0
    v_add_u32 v37, 64000, v167
    v_add_u32 v38, 115200, v167
    s_lshl_b32 s46, s38, 2
    s_waitcnt lgkmcnt(12)
    v_mfma_f32_16x16x32_bf16 v[120:123], v[64:67], v[40:43], v[120:123]
    s_cbranch_execz L_pfret
    s_add_u32 s47, s46, s40
    s_min_u32 s67, s47, 8
    s_add_u32 s46, s46, s36
    v_mfma_f32_16x16x32_bf16 v[124:127], v[64:67], v[44:47], v[124:127]
    s_cmp_lt_u32 s46, 8
    s_cselect_b32 s70, 1, 0
    s_cmp_eq_u32 s37, 0
    s_cselect_b32 s70, 1, s70
    s_mov_b32 s98, 1051011932
    s_waitcnt vmcnt(8) lgkmcnt(0)
    s_barrier
    v_mfma_f32_16x16x32_bf16 v[88:91], v[68:71], v[184:187], v[88:91]
    ds_read_b128 v[40:43], v6 offset:20480
    ds_read_b64_tr_b16 v[48:49], v14 offset:0
    v_mfma_f32_16x16x32_bf16 v[92:95], v[68:71], v[188:191], v[92:95]
    ds_read_b64_tr_b16 v[50:51], v14 offset:1280
    ds_read_b128 v[44:47], v6 offset:22528
    s_mov_b32 s99, s98
    s_sub_u32 s46, s46, 8
    s_mul_i32 s46, s46, 10240
    v_mfma_f32_16x16x32_bf16 v[96:99], v[72:75], v[184:187], v[96:99]
    ds_read_b64_tr_b16 v[52:53], v14 offset:40
    ds_read_b64_tr_b16 v[54:55], v14 offset:1320
    s_mul_i32 s47, s39, 655360
    s_add_u32 s68, s46, s47
    s_lshl_b32 s46, s41, 13
    v_mfma_f32_16x16x32_bf16 v[100:103], v[72:75], v[188:191], v[100:103]
    ds_read_b64_tr_b16 v[56:57], v14 offset:80
    ds_read_b64_tr_b16 v[58:59], v14 offset:1360
    s_and_b32 s47, s36, 3
    s_lshl_b32 s47, s47, 7
    s_add_u32 s46, s46, s47
    v_mfma_f32_16x16x32_bf16 v[104:107], v[76:79], v[184:187], v[104:107]
    ds_read_b64_tr_b16 v[60:61], v14 offset:120
    ds_read_b64_tr_b16 v[62:63], v14 offset:1400
    s_add_u32 s46, s46, s64
    s_sub_u32 s69, s46, 15872
    s_mov_b32 s100, 0xf0000000
    v_mfma_f32_16x16x32_bf16 v[108:111], v[76:79], v[188:191], v[108:111]
    ds_read_b64_tr_b16 v[64:65], v15 offset:0
    s_cbranch_execz L_pfret
    ds_read_b64_tr_b16 v[66:67], v15 offset:1280
    s_mov_b32 s18, 819200
    s_mov_b32 s19, 0x00020000
    s_mov_b32 s22, 5242880
    v_mfma_f32_16x16x32_bf16 v[112:115], v[80:83], v[184:187], v[112:115]
    s_add_u32 m0, s43, 53248
    s_add_u32 s57, s1, 640
    s_sub_u32 s56, s57, 1280
    s_min_u32 s57, s57, s56
    buffer_load_dwordx4 v2, s[4:7], s57 offen offset:0 lds
    s_mov_b32 s23, 0x00020000
    s_mov_b32 s30, 25600
    s_mov_b32 s31, 0x00020000
    v_mfma_f32_16x16x32_bf16 v[116:119], v[80:83], v[188:191], v[116:119]
    buffer_load_dwordx4 v3, s[4:7], s57 offen offset:1024 lds
    s_and_b32 s17, s17, 0xffff
    s_and_b32 s21, s21, 0xffff
    s_and_b32 s29, s29, 0xffff
    v_mfma_f32_16x16x32_bf16 v[120:123], v[84:87], v[184:187], v[120:123]
    buffer_load_dwordx4 v4, s[4:7], s57 offen offset:2048 lds
    s_xor_b32 s75, s75, 0x404
    s_xor_b32 s46, s39, 1
    s_lshl_b32 s46, s46, 4
    v_mfma_f32_16x16x32_bf16 v[124:127], v[84:87], v[188:191], v[124:127]
    buffer_load_dwordx4 v5, s[4:7], s57 offen offset:3072 lds
    s_add_u32 s46, s46, s38
    s_lshl_b32 s46, s46, 2
    s_add_u32 s46, s46, s40
    s_waitcnt lgkmcnt(9)
    v_mfma_f32_16x16x32_bf16 v[88:91], v[48:51], v[40:43], v[88:91]
    ds_read_b128 v[192:195], v7 offset:20480
    ds_read_b64_tr_b16 v[68:69], v14 offset:10240
    s_waitcnt lgkmcnt(10)
    v_mfma_f32_16x16x32_bf16 v[92:95], v[48:51], v[44:47], v[92:95]
    ds_read_b64_tr_b16 v[70:71], v14 offset:11520
    s_nop 0
    s_cbranch_execz L_pfret
    ds_read_b128 v[196:199], v7 offset:22528
    s_lshl_b32 s46, s46, 1
    s_add_u32 s46, s46, s41
    s_xor_b32 s46, s46, 1
    s_waitcnt lgkmcnt(10)
    v_mfma_f32_16x16x32_bf16 v[96:99], v[52:55], v[40:43], v[96:99]
    ds_read_b64_tr_b16 v[72:73], v14 offset:10280
    ds_read_b64_tr_b16 v[74:75], v14 offset:11560
    s_mul_i32 s46, s46, 5120
    s_mul_i32 s47, s37, 20971520
    s_sub_u32 s46, s46, s47
    v_mfma_f32_16x16x32_bf16 v[100:103], v[52:55], v[44:47], v[100:103]
    ds_read_b64_tr_b16 v[76:77], v14 offset:10320
    ds_read_b64_tr_b16 v[78:79], v14 offset:11600
    s_add_u32 s65, s46, 20971520
    s_mul_i32 s49, s39, 160
    s_and_b32 s48, s36, 1
    s_waitcnt lgkmcnt(12)
    v_mfma_f32_16x16x32_bf16 v[104:107], v[56:59], v[40:43], v[104:107]
    ds_read_b64_tr_b16 v[80:81], v14 offset:10360
    ds_read_b64_tr_b16 v[82:83], v14 offset:11640
    v_mul_u32_u24 v158, 205, v0
    v_lshrrev_b32 v158, 12, v158
    v_mul_u32_u24 v160, 20, v158
    v_mfma_f32_16x16x32_bf16 v[108:111], v[56:59], v[44:47], v[108:111]
    ds_read_b64_tr_b16 v[84:85], v15 offset:10240
    ds_read_b64_tr_b16 v[86:87], v15 offset:11520
    v_sub_u32 v160, v0, v160
    v_mul_u32_u24 v161, 3840, v158
    v_lshl_add_u32 v249, v160, 4, v161
    s_waitcnt lgkmcnt(14)
    v_mfma_f32_16x16x32_bf16 v[112:115], v[60:63], v[40:43], v[112:115]
    s_and_b32 s56, s2, 0xf8
    s_add_u32 s56, s56, s36
    s_mul_i32 s56, s56, 3840
    s_add_u32 s56, s56, s0
    s_add_u32 s56, s56, 0
    s_sub_u32 s57, s56, 2457600
    s_min_u32 s56, s56, s57
    s_cbranch_execz L_pfret
    buffer_load_dword v146, v134, s[8:11], s56 offen offset:0
    v_mul_u32_u24 v160, 26, v160
    v_lshrrev_b32 v160, 8, v160
    v_mul_u32_u24 v161, 160, v160
    v_mfma_f32_16x16x32_bf16 v[116:119], v[60:63], v[44:47], v[116:119]
    v_sub_u32 v249, v249, v161
    v_xor_b32 v160, s48, v160
    v_mul_u32_u24 v160, 122880, v160
    s_waitcnt lgkmcnt(12)
    v_mfma_f32_16x16x32_bf16 v[120:123], v[64:67], v[40:43], v[120:123]
    v_add3_u32 v249, v249, v160, s49
    v_add_u32 v161, 64, v0
    v_mul_u32_u24 v158, 205, v161
    v_mfma_f32_16x16x32_bf16 v[124:127], v[64:67], v[44:47], v[124:127]
    v_lshrrev_b32 v158, 12, v158
    v_mul_u32_u24 v160, 20, v158
    v_sub_u32 v160, v161, v160
    s_waitcnt vmcnt(7) lgkmcnt(0)
    s_barrier
    v_mfma_f32_16x16x32_bf16 v[88:91], v[68:71], v[192:195], v[88:91]
    ds_read_b128 v[40:43], v6 offset:36864
    ds_read_b64_tr_b16 v[48:49], v22 offset:24576
    v_mfma_f32_16x16x32_bf16 v[92:95], v[68:71], v[196:199], v[92:95]
    ds_read_b64_tr_b16 v[50:51], v22 offset:25856
    ds_read_b128 v[44:47], v6 offset:38912
    v_mul_u32_u24 v161, 3840, v158
    v_lshl_add_u32 v250, v160, 4, v161
    v_mul_u32_u24 v160, 26, v160
    v_mfma_f32_16x16x32_bf16 v[96:99], v[72:75], v[192:195], v[96:99]
    ds_read_b64_tr_b16 v[52:53], v22 offset:24616
    ds_read_b64_tr_b16 v[54:55], v22 offset:25896
    v_lshrrev_b32 v160, 8, v160
    v_mul_u32_u24 v161, 160, v160
    v_sub_u32 v250, v250, v161
    v_mfma_f32_16x16x32_bf16 v[100:103], v[72:75], v[196:199], v[100:103]
    ds_read_b64_tr_b16 v[56:57], v22 offset:24656
    ds_read_b64_tr_b16 v[58:59], v22 offset:25936
    v_xor_b32 v160, s48, v160
    v_mul_u32_u24 v160, 122880, v160
    s_cbranch_execz L_pfret
    v_add_u32 v160, -1024, v160
    v_mfma_f32_16x16x32_bf16 v[104:107], v[76:79], v[192:195], v[104:107]
    ds_read_b64_tr_b16 v[60:61], v22 offset:24696
    ds_read_b64_tr_b16 v[62:63], v22 offset:25976
    v_add3_u32 v250, v250, v160, s49
    v_add_u32 v161, 128, v0
    v_mul_u32_u24 v158, 205, v161
    v_mfma_f32_16x16x32_bf16 v[108:111], v[76:79], v[196:199], v[108:111]
    ds_read_b64_tr_b16 v[64:65], v23 offset:24576
    ds_read_b64_tr_b16 v[66:67], v23 offset:25856
    v_lshrrev_b32 v158, 12, v158
    v_mul_u32_u24 v160, 20, v158
    v_sub_u32 v160, v161, v160
    v_mfma_f32_16x16x32_bf16 v[112:115], v[80:83], v[192:195], v[112:115]
    s_add_u32 m0, s43, 20480
    s_add_u32 s57, s1, 768
    s_sub_u32 s56, s57, 1280
    s_min_u32 s57, s57, s56
    buffer_load_dwordx4 v2, s[4:7], s57 offen offset:0 lds
    v_mul_u32_u24 v161, 3840, v158
    v_lshl_add_u32 v251, v160, 4, v161
    v_mul_u32_u24 v160, 26, v160
    v_mfma_f32_16x16x32_bf16 v[116:119], v[80:83], v[196:199], v[116:119]
    buffer_load_dwordx4 v3, s[4:7], s57 offen offset:1024 lds
    v_lshrrev_b32 v160, 8, v160
    v_mul_u32_u24 v161, 160, v160
    v_sub_u32 v251, v251, v161
    v_mfma_f32_16x16x32_bf16 v[120:123], v[84:87], v[192:195], v[120:123]
    buffer_load_dwordx4 v4, s[4:7], s57 offen offset:2048 lds
    v_xor_b32 v160, s48, v160
    v_mul_u32_u24 v160, 122880, v160
    v_add_u32 v160, -2048, v160
    v_mfma_f32_16x16x32_bf16 v[124:127], v[84:87], v[196:199], v[124:127]
    buffer_load_dwordx4 v5, s[4:7], s57 offen offset:3072 lds
    v_add3_u32 v251, v251, v160, s49
    s_lshl_b32 s52, s39, 4
    s_cbranch_execz L_pfret
    s_add_u32 s52, s52, s38
    s_waitcnt lgkmcnt(9)
    v_mfma_f32_16x16x32_bf16 v[88:91], v[48:51], v[40:43], v[88:91]
    ds_read_b128 v[200:203], v7 offset:36864
    ds_read_b64_tr_b16 v[68:69], v22 offset:34816
    s_waitcnt lgkmcnt(10)
    v_mfma_f32_16x16x32_bf16 v[92:95], v[48:51], v[44:47], v[92:95]
    ds_read_b64_tr_b16 v[70:71], v22 offset:36096
    ds_read_b128 v[204:207], v7 offset:38912
    s_lshl_b32 s52, s52, 3
    s_add_u32 s52, s52, s36
    s_lshl_b32 s52, s52, 10
    s_waitcnt lgkmcnt(10)
    v_mfma_f32_16x16x32_bf16 v[96:99], v[52:55], v[40:43], v[96:99]
    ds_read_b64_tr_b16 v[72:73], v22 offset:34856
    ds_read_b64_tr_b16 v[74:75], v22 offset:36136
    s_add_u32 s52, s52, 12582912
    s_cmp_lg_u32 s37, 0
    s_cselect_b64 vcc, -1, 0
    v_mfma_f32_16x16x32_bf16 v[100:103], v[52:55], v[44:47], v[100:103]
    ds_read_b64_tr_b16 v[76:77], v22 offset:34896
    ds_read_b64_tr_b16 v[78:79], v22 offset:36176
    s_waitcnt lgkmcnt(12)
    v_mfma_f32_16x16x32_bf16 v[104:107], v[56:59], v[40:43], v[104:107]
    ds_read_b64_tr_b16 v[80:81], v22 offset:34936
    ds_read_b64_tr_b16 v[82:83], v22 offset:36216
    v_mfma_f32_16x16x32_bf16 v[108:111], v[56:59], v[44:47], v[108:111]
    ds_read_b64_tr_b16 v[84:85], v23 offset:34816
    ds_read_b64_tr_b16 v[86:87], v23 offset:36096
    s_waitcnt lgkmcnt(14)
    v_mfma_f32_16x16x32_bf16 v[112:115], v[60:63], v[40:43], v[112:115]
    s_and_b32 s56, s2, 0xf8
    s_add_u32 s56, s56, s36
    s_mul_i32 s56, s56, 3840
    s_add_u32 s56, s56, s0
    s_add_u32 s56, s56, 983040
    s_sub_u32 s57, s56, 2457600
    s_min_u32 s56, s56, s57
    s_nop 0
    s_cbranch_execz L_pfret
    buffer_load_dword v148, v134, s[8:11], s56 offen offset:0
    v_mfma_f32_16x16x32_bf16 v[116:119], v[60:63], v[44:47], v[116:119]
    s_waitcnt lgkmcnt(12)
    v_mfma_f32_16x16x32_bf16 v[120:123], v[64:67], v[40:43], v[120:123]
    v_mfma_f32_16x16x32_bf16 v[124:127], v[64:67], v[44:47], v[124:127]
    s_waitcnt vmcnt(6) lgkmcnt(0)
    s_barrier
    v_mfma_f32_16x16x32_bf16 v[88:91], v[68:71], v[200:203], v[88:91]
    ds_read_b128 v[40:43], v8 offset:4096
    ds_read_b64_tr_b16 v[48:49], v22 offset:45056
    v_mfma_f32_16x16x32_bf16 v[92:95], v[68:71], v[204:207], v[92:95]
    ds_read_b64_tr_b16 v[50:51], v22 offset:46336
    ds_read_b128 v[44:47], v8 offset:6144
    v_mfma_f32_16x16x32_bf16 v[96:99], v[72:75], v[200:203], v[96:99]
    ds_read_b64_tr_b16 v[52:53], v22 offset:45096
    ds_read_b64_tr_b16 v[54:55], v22 offset:46376
    v_mfma_f32_16x16x32_bf16 v[100:103], v[72:75], v[204:207], v[100:103]
    ds_read_b64_tr_b16 v[56:57], v22 offset:45136
    ds_read_b64_tr_b16 v[58:59], v22 offset:46416
    v_mfma_f32_16x16x32_bf16 v[104:107], v[76:79], v[200:203], v[104:107]
    ds_read_b64_tr_b16 v[60:61], v22 offset:45176
    ds_read_b64_tr_b16 v[62:63], v22 offset:46456
    v_mfma_f32_16x16x32_bf16 v[108:111], v[76:79], v[204:207], v[108:111]
    ds_read_b64_tr_b16 v[64:65], v23 offset:45056
    ds_read_b64_tr_b16 v[66:67], v23 offset:46336
    v_mfma_f32_16x16x32_bf16 v[112:115], v[80:83], v[200:203], v[112:115]
    s_add_u32 m0, s43, 36864
    s_add_u32 s57, s1, 896
    s_sub_u32 s56, s57, 1280
    s_min_u32 s57, s57, s56
    buffer_load_dwordx4 v2, s[4:7], s57 offen offset:0 lds
    v_mfma_f32_16x16x32_bf16 v[116:119], v[80:83], v[204:207], v[116:119]
    buffer_load_dwordx4 v3, s[4:7], s57 offen offset:1024 lds
    s_nop 0
    s_cbranch_execz L_pfret
    v_mfma_f32_16x16x32_bf16 v[120:123], v[84:87], v[200:203], v[120:123]
    buffer_load_dwordx4 v4, s[4:7], s57 offen offset:2048 lds
    v_mfma_f32_16x16x32_bf16 v[124:127], v[84:87], v[204:207], v[124:127]
    buffer_load_dwordx4 v5, s[4:7], s57 offen offset:3072 lds
    s_waitcnt lgkmcnt(9)
    v_mfma_f32_16x16x32_bf16 v[88:91], v[48:51], v[40:43], v[88:91]
    ds_read_b128 v[208:211], v9 offset:4096
    ds_read_b64_tr_b16 v[68:69], v22 offset:55296
    s_waitcnt lgkmcnt(10)
    v_mfma_f32_16x16x32_bf16 v[92:95], v[48:51], v[44:47], v[92:95]
    ds_read_b64_tr_b16 v[70:71], v22 offset:56576
    ds_read_b128 v[212:215], v9 offset:6144
    s_waitcnt lgkmcnt(10)
    v_mfma_f32_16x16x32_bf16 v[96:99], v[52:55], v[40:43], v[96:99]
    ds_read_b64_tr_b16 v[72:73], v22 offset:55336
    ds_read_b64_tr_b16 v[74:75], v22 offset:56616
    v_mfma_f32_16x16x32_bf16 v[100:103], v[52:55], v[44:47], v[100:103]
    ds_read_b64_tr_b16 v[76:77], v22 offset:55376
    ds_read_b64_tr_b16 v[78:79], v22 offset:56656
    s_waitcnt lgkmcnt(12)
    v_mfma_f32_16x16x32_bf16 v[104:107], v[56:59], v[40:43], v[104:107]
    ds_read_b64_tr_b16 v[80:81], v22 offset:55416
    ds_read_b64_tr_b16 v[82:83], v22 offset:56696
    v_mfma_f32_16x16x32_bf16 v[108:111], v[56:59], v[44:47], v[108:111]
    ds_read_b64_tr_b16 v[84:85], v23 offset:55296
    ds_read_b64_tr_b16 v[86:87], v23 offset:56576
    s_waitcnt lgkmcnt(14)
    v_mfma_f32_16x16x32_bf16 v[112:115], v[60:63], v[40:43], v[112:115]
    s_and_b32 s56, s2, 0xf8
    s_add_u32 s56, s56, s36
    s_mul_i32 s56, s56, 3840
    s_add_u32 s56, s56, s0
    s_add_u32 s56, s56, 1966080
    s_sub_u32 s57, s56, 2457600
    s_min_u32 s56, s56, s57
    s_nop 0
    s_cbranch_execz L_pfret
    buffer_load_dword v150, v134, s[8:11], s56 offen offset:0
    v_mfma_f32_16x16x32_bf16 v[116:119], v[60:63], v[44:47], v[116:119]
    s_waitcnt lgkmcnt(12)
    v_mfma_f32_16x16x32_bf16 v[120:123], v[64:67], v[40:43], v[120:123]
    v_mfma_f32_16x16x32_bf16 v[124:127], v[64:67], v[44:47], v[124:127]
    s_waitcnt vmcnt(6) lgkmcnt(0)
    s_barrier
    v_mfma_f32_16x16x32_bf16 v[88:91], v[68:71], v[208:211], v[88:91]
    ds_read_b128 v[40:43], v6 offset:20480
    ds_read_b64_tr_b16 v[48:49], v14 offset:0
    v_mfma_f32_16x16x32_bf16 v[92:95], v[68:71], v[212:215], v[92:95]
    ds_read_b64_tr_b16 v[50:51], v14 offset:1280
    ds_read_b128 v[44:47], v6 offset:22528
    v_mfma_f32_16x16x32_bf16 v[96:99], v[72:75], v[208:211], v[96:99]
    ds_read_b64_tr_b16 v[52:53], v14 offset:40
    ds_read_b64_tr_b16 v[54:55], v14 offset:1320
    v_mfma_f32_16x16x32_bf16 v[100:103], v[72:75], v[212:215], v[100:103]
    ds_read_b64_tr_b16 v[56:57], v14 offset:80
    ds_read_b64_tr_b16 v[58:59], v14 offset:1360
    v_mfma_f32_16x16x32_bf16 v[104:107], v[76:79], v[208:211], v[104:107]
    ds_read_b64_tr_b16 v[60:61], v14 offset:120
    ds_read_b64_tr_b16 v[62:63], v14 offset:1400
    v_mfma_f32_16x16x32_bf16 v[108:111], v[76:79], v[212:215], v[108:111]
    ds_read_b64_tr_b16 v[64:65], v15 offset:0
    ds_read_b64_tr_b16 v[66:67], v15 offset:1280
    v_mfma_f32_16x16x32_bf16 v[112:115], v[80:83], v[208:211], v[112:115]
    s_add_u32 m0, s43, 53248
    s_add_u32 s57, s1, 1024
    s_sub_u32 s56, s57, 1280
    s_min_u32 s57, s57, s56
    buffer_load_dwordx4 v2, s[4:7], s57 offen offset:0 lds
    v_mfma_f32_16x16x32_bf16 v[116:119], v[80:83], v[212:215], v[116:119]
    buffer_load_dwordx4 v3, s[4:7], s57 offen offset:1024 lds
    s_nop 0
    s_cbranch_execz L_pfret
    v_mfma_f32_16x16x32_bf16 v[120:123], v[84:87], v[208:211], v[120:123]
    buffer_load_dwordx4 v4, s[4:7], s57 offen offset:2048 lds
    v_mfma_f32_16x16x32_bf16 v[124:127], v[84:87], v[212:215], v[124:127]
    buffer_load_dwordx4 v5, s[4:7], s57 offen offset:3072 lds
    s_waitcnt lgkmcnt(9)
    v_mfma_f32_16x16x32_bf16 v[88:91], v[48:51], v[40:43], v[88:91]
    ds_read_b128 v[216:219], v7 offset:20480
    ds_read_b64_tr_b16 v[68:69], v14 offset:10240
    s_waitcnt lgkmcnt(10)
    v_mfma_f32_16x16x32_bf16 v[92:95], v[48:51], v[44:47], v[92:95]
    ds_read_b64_tr_b16 v[70:71], v14 offset:11520
    ds_read_b128 v[220:223], v7 offset:22528
    s_waitcnt lgkmcnt(10)
    v_mfma_f32_16x16x32_bf16 v[96:99], v[52:55], v[40:43], v[96:99]
    ds_read_b64_tr_b16 v[72:73], v14 offset:10280
    ds_read_b64_tr_b16 v[74:75], v14 offset:11560
    v_mfma_f32_16x16x32_bf16 v[100:103], v[52:55], v[44:47], v[100:103]
    ds_read_b64_tr_b16 v[76:77], v14 offset:10320
    ds_read_b64_tr_b16 v[78:79], v14 offset:11600
    s_waitcnt lgkmcnt(12)
    v_mfma_f32_16x16x32_bf16 v[104:107], v[56:59], v[40:43], v[104:107]
    ds_read_b64_tr_b16 v[80:81], v14 offset:10360
    ds_read_b64_tr_b16 v[82:83], v14 offset:11640
    v_mfma_f32_16x16x32_bf16 v[108:111], v[56:59], v[44:47], v[108:111]
    ds_read_b64_tr_b16 v[84:85], v15 offset:10240
    ds_read_b64_tr_b16 v[86:87], v15 offset:11520
    s_waitcnt lgkmcnt(14)
    v_mfma_f32_16x16x32_bf16 v[112:115], v[60:63], v[40:43], v[112:115]
    s_lshl_b32 s48, s37, 7
    v_and_b32 v39, 15, v0
    v_lshlrev_b32 v39, 2, v39
    buffer_load_dword v39, v39, s[24:27], s48 offen sc1
    v_mfma_f32_16x16x32_bf16 v[116:119], v[60:63], v[44:47], v[116:119]
    s_waitcnt lgkmcnt(12)
    v_mfma_f32_16x16x32_bf16 v[120:123], v[64:67], v[40:43], v[120:123]
    v_mfma_f32_16x16x32_bf16 v[124:127], v[64:67], v[44:47], v[124:127]
    s_cbranch_execz L_pfret
    s_waitcnt vmcnt(6) lgkmcnt(0)
    s_barrier
    v_mfma_f32_16x16x32_bf16 v[88:91], v[68:71], v[216:219], v[88:91]
    ds_read_b128 v[40:43], v6 offset:36864
    ds_read_b64_tr_b16 v[48:49], v22 offset:24576
    v_mfma_f32_16x16x32_bf16 v[92:95], v[68:71], v[220:223], v[92:95]
    ds_read_b64_tr_b16 v[50:51], v22 offset:25856
    ds_read_b128 v[44:47], v6 offset:38912
    v_mfma_f32_16x16x32_bf16 v[96:99], v[72:75], v[216:219], v[96:99]
    ds_read_b64_tr_b16 v[52:53], v22 offset:24616
    ds_read_b64_tr_b16 v[54:55], v22 offset:25896
    v_mfma_f32_16x16x32_bf16 v[100:103], v[72:75], v[220:223], v[100:103]
    ds_read_b64_tr_b16 v[56:57], v22 offset:24656
    ds_read_b64_tr_b16 v[58:59], v22 offset:25936
    v_mfma_f32_16x16x32_bf16 v[104:107], v[76:79], v[216:219], v[104:107]
    ds_read_b64_tr_b16 v[60:61], v22 offset:24696
    ds_read_b64_tr_b16 v[62:63], v22 offset:25976
    v_mfma_f32_16x16x32_bf16 v[108:111], v[76:79], v[220:223], v[108:111]
    ds_read_b64_tr_b16 v[64:65], v23 offset:24576
    ds_read_b64_tr_b16 v[66:67], v23 offset:25856
    v_mfma_f32_16x16x32_bf16 v[112:115], v[80:83], v[216:219], v[112:115]
    s_add_u32 m0, s43, 20480
    s_add_u32 s57, s1, 1152
    s_sub_u32 s56, s57, 1280
    s_min_u32 s57, s57, s56
    buffer_load_dwordx4 v2, s[4:7], s57 offen offset:0 lds
    v_mfma_f32_16x16x32_bf16 v[116:119], v[80:83], v[220:223], v[116:119]
    buffer_load_dwordx4 v3, s[4:7], s57 offen offset:1024 lds
    v_mfma_f32_16x16x32_bf16 v[120:123], v[84:87], v[216:219], v[120:123]
    buffer_load_dwordx4 v4, s[4:7], s57 offen offset:2048 lds
    v_mfma_f32_16x16x32_bf16 v[124:127], v[84:87], v[220:223], v[124:127]
    buffer_load_dwordx4 v5, s[4:7], s57 offen offset:3072 lds
    s_waitcnt lgkmcnt(9)
    s_nop 0
    s_cbranch_execz L_pfret
    v_mfma_f32_16x16x32_bf16 v[88:91], v[48:51], v[40:43], v[88:91]
    ds_read_b128 v[224:227], v7 offset:36864
    ds_read_b64_tr_b16 v[68:69], v22 offset:34816
    s_waitcnt lgkmcnt(10)
    v_mfma_f32_16x16x32_bf16 v[92:95], v[48:51], v[44:47], v[92:95]
    ds_read_b64_tr_b16 v[70:71], v22 offset:36096
    ds_read_b128 v[228:231], v7 offset:38912
    s_waitcnt lgkmcnt(10)
    v_mfma_f32_16x16x32_bf16 v[96:99], v[52:55], v[40:43], v[96:99]
    ds_read_b64_tr_b16 v[72:73], v22 offset:34856
    ds_read_b64_tr_b16 v[74:75], v22 offset:36136
    v_mfma_f32_16x16x32_bf16 v[100:103], v[52:55], v[44:47], v[100:103]
    ds_read_b64_tr_b16 v[76:77], v22 offset:34896
    ds_read_b64_tr_b16 v[78:79], v22 offset:36176
    s_waitcnt lgkmcnt(12)
    v_mfma_f32_16x16x32_bf16 v[104:107], v[56:59], v[40:43], v[104:107]
    ds_read_b64_tr_b16 v[80:81], v22 offset:34936
    ds_read_b64_tr_b16 v[82:83], v22 offset:36216
    v_mfma_f32_16x16x32_bf16 v[108:111], v[56:59], v[44:47], v[108:111]
    ds_read_b64_tr_b16 v[84:85], v23 offset:34816
    ds_read_b64_tr_b16 v[86:87], v23 offset:36096
    s_waitcnt lgkmcnt(14)
    v_mfma_f32_16x16x32_bf16 v[112:115], v[60:63], v[40:43], v[112:115]
    s_mov_b32 s56, 0
    buffer_load_dword v152, v135, s[16:19], s56 offen offset:0
    v_mfma_f32_16x16x32_bf16 v[116:119], v[60:63], v[44:47], v[116:119]
    s_mov_b32 s56, 327680
    buffer_load_dword v154, v135, s[16:19], s56 offen offset:0
    s_waitcnt lgkmcnt(12)
    v_mfma_f32_16x16x32_bf16 v[120:123], v[64:67], v[40:43], v[120:123]
    s_mov_b32 s56, 655360
    buffer_load_dword v156, v135, s[16:19], s56 offen offset:0
    v_mfma_f32_16x16x32_bf16 v[124:127], v[64:67], v[44:47], v[124:127]
    s_waitcnt vmcnt(8) lgkmcnt(0)
    s_barrier
    s_nop 0
    s_cbranch_execz L_pfret
    v_mfma_f32_16x16x32_bf16 v[88:91], v[68:71], v[224:227], v[88:91]
    ds_read_b128 v[40:43], v8 offset:4096
    ds_read_b64_tr_b16 v[48:49], v22 offset:45056
    v_mfma_f32_16x16x32_bf16 v[92:95], v[68:71], v[228:231], v[92:95]
    ds_read_b64_tr_b16 v[50:51], v22 offset:46336
    ds_read_b128 v[44:47], v8 offset:6144
    v_mfma_f32_16x16x32_bf16 v[96:99], v[72:75], v[224:227], v[96:99]
    ds_read_b64_tr_b16 v[52:53], v22 offset:45096
    ds_read_b64_tr_b16 v[54:55], v22 offset:46376
    v_mfma_f32_16x16x32_bf16 v[100:103], v[72:75], v[228:231], v[100:103]
    ds_read_b64_tr_b16 v[56:57], v22 offset:45136
    ds_read_b64_tr_b16 v[58:59], v22 offset:46416
    v_mfma_f32_16x16x32_bf16 v[104:107], v[76:79], v[224:227], v[104:107]
    ds_read_b64_tr_b16 v[60:61], v22 offset:45176
    ds_read_b64_tr_b16 v[62:63], v22 offset:46456
    v_mfma_f32_16x16x32_bf16 v[108:111], v[76:79], v[228:231], v[108:111]
    ds_read_b64_tr_b16 v[64:65], v23 offset:45056
    ds_read_b64_tr_b16 v[66:67], v23 offset:46336
    v_mfma_f32_16x16x32_bf16 v[112:115], v[80:83], v[224:227], v[112:115]
    s_add_u32 m0, s44, 133120
    s_add_u32 s57, s76, 245760
    buffer_load_dwordx4 v249, s[8:11], s57 offen offset:0 lds
    v_mfma_f32_16x16x32_bf16 v[116:119], v[80:83], v[228:231], v[116:119]
    buffer_load_dwordx4 v250, s[8:11], s57 offen offset:1024 lds
    v_mfma_f32_16x16x32_bf16 v[120:123], v[84:87], v[224:227], v[120:123]
    s_mov_b64 exec, 0xffffffff
    buffer_load_dwordx4 v251, s[8:11], s57 offen offset:2048 lds
    s_mov_b64 exec, -1
    v_mfma_f32_16x16x32_bf16 v[124:127], v[84:87], v[228:231], v[124:127]
    s_waitcnt lgkmcnt(9)
    v_mfma_f32_16x16x32_bf16 v[88:91], v[48:51], v[40:43], v[88:91]
    ds_read_b128 v[232:235], v9 offset:4096
    s_nop 0
    s_cbranch_execz L_pfret
    ds_read_b64_tr_b16 v[68:69], v22 offset:55296
    s_waitcnt lgkmcnt(10)
    v_mfma_f32_16x16x32_bf16 v[92:95], v[48:51], v[44:47], v[92:95]
    ds_read_b64_tr_b16 v[70:71], v22 offset:56576
    ds_read_b128 v[236:239], v9 offset:6144
    s_waitcnt lgkmcnt(10)
    v_mfma_f32_16x16x32_bf16 v[96:99], v[52:55], v[40:43], v[96:99]
    ds_read_b64_tr_b16 v[72:73], v22 offset:55336
    ds_read_b64_tr_b16 v[74:75], v22 offset:56616
    v_mfma_f32_16x16x32_bf16 v[100:103], v[52:55], v[44:47], v[100:103]
    ds_read_b64_tr_b16 v[76:77], v22 offset:55376
    ds_read_b64_tr_b16 v[78:79], v22 offset:56656
    s_waitcnt lgkmcnt(12)
    v_mfma_f32_16x16x32_bf16 v[104:107], v[56:59], v[40:43], v[104:107]
    ds_read_b64_tr_b16 v[80:81], v22 offset:55416
    ds_read_b64_tr_b16 v[82:83], v22 offset:56696
    v_mfma_f32_16x16x32_bf16 v[108:111], v[56:59], v[44:47], v[108:111]
    ds_read_b64_tr_b16 v[84:85], v23 offset:55296
    ds_read_b64_tr_b16 v[86:87], v23 offset:56576
    s_waitcnt lgkmcnt(14)
    v_mfma_f32_16x16x32_bf16 v[112:115], v[60:63], v[40:43], v[112:115]
    v_mfma_f32_16x16x32_bf16 v[116:119], v[60:63], v[44:47], v[116:119]
    s_waitcnt lgkmcnt(12)
    v_mfma_f32_16x16x32_bf16 v[120:123], v[64:67], v[40:43], v[120:123]
    v_mfma_f32_16x16x32_bf16 v[124:127], v[64:67], v[44:47], v[124:127]
    s_waitcnt vmcnt(6)
    s_mov_b32 s48, 0x88888888
    v_and_b32 v254, s48, v39
    v_cmp_ne_u32 s[46:47], s48, v254
    s_nop 0
    s_cmp_eq_u64 s[46:47], 0
    s_cbranch_scc1 L_cnt_ok1f
    s_mov_b32 s49, 100000
L_cnt_poll1f:
    s_lshl_b32 s48, s37, 7
    v_and_b32 v39, 15, v0
    v_lshlrev_b32 v39, 2, v39
    buffer_load_dword v39, v39, s[24:27], s48 offen sc1
    s_waitcnt vmcnt(0)
    s_sub_u32 s49, s49, 1
    s_cbranch_execz L_pfret
    s_cbranch_scc1 L_cnt_ok1f
    s_mov_b32 s48, 0x88888888
    v_and_b32 v254, s48, v39
    v_cmp_ne_u32 s[46:47], s48, v254
    s_nop 0
    s_cmp_eq_u64 s[46:47], 0
    s_cbranch_scc0 L_cnt_poll1f
    s_nop 1
L_cnt_ok1f:
    s_waitcnt lgkmcnt(0)
    s_barrier
    v_mfma_f32_16x16x32_bf16 v[88:91], v[68:71], v[232:235], v[88:91]
    ds_read_b128 v[40:43], v6 offset:20480
    ds_read_b64_tr_b16 v[48:49], v14 offset:0
    v_mfma_f32_16x16x32_bf16 v[92:95], v[68:71], v[236:239], v[92:95]
    ds_read_b64_tr_b16 v[50:51], v14 offset:1280
    ds_read_b128 v[44:47], v6 offset:22528
    v_mfma_f32_16x16x32_bf16 v[96:99], v[72:75], v[232:235], v[96:99]
    ds_read_b64_tr_b16 v[52:53], v14 offset:40
    ds_read_b64_tr_b16 v[54:55], v14 offset:1320
    v_mfma_f32_16x16x32_bf16 v[100:103], v[72:75], v[236:239], v[100:103]
    ds_read_b64_tr_b16 v[56:57], v14 offset:80
    ds_read_b64_tr_b16 v[58:59], v14 offset:1360
    v_mfma_f32_16x16x32_bf16 v[104:107], v[76:79], v[232:235], v[104:107]
    ds_read_b64_tr_b16 v[60:61], v14 offset:120
    ds_read_b64_tr_b16 v[62:63], v14 offset:1400
    v_mfma_f32_16x16x32_bf16 v[108:111], v[76:79], v[236:239], v[108:111]
    ds_read_b64_tr_b16 v[64:65], v15 offset:0
    ds_read_b64_tr_b16 v[66:67], v15 offset:1280
    v_mfma_f32_16x16x32_bf16 v[112:115], v[80:83], v[232:235], v[112:115]
    s_add_u32 m0, s44, 153600
    s_add_u32 s57, s76, 737280
    buffer_load_dwordx4 v249, s[8:11], s57 offen offset:0 lds
    v_mfma_f32_16x16x32_bf16 v[116:119], v[80:83], v[236:239], v[116:119]
    buffer_load_dwordx4 v250, s[8:11], s57 offen offset:1024 lds
    v_mfma_f32_16x16x32_bf16 v[120:123], v[84:87], v[232:235], v[120:123]
    s_nop 0
    s_cbranch_execz L_pfret
    s_mov_b64 exec, 0xffffffff
    buffer_load_dwordx4 v251, s[8:11], s57 offen offset:2048 lds
    s_mov_b64 exec, -1
    v_mfma_f32_16x16x32_bf16 v[124:127], v[84:87], v[236:239], v[124:127]
    s_add_u32 m0, s44, 47104
    s_add_u32 s57, s76, 1228800
    s_sub_u32 s56, s57, 2457600
    s_min_u32 s57, s57, s56
    buffer_load_dwordx4 v249, s[8:11], s57 offen offset:0 lds
    s_waitcnt lgkmcnt(9)
    v_mfma_f32_16x16x32_bf16 v[88:91], v[48:51], v[40:43], v[88:91]
    ds_read_b128 v[240:243], v7 offset:20480
    ds_read_b64_tr_b16 v[68:69], v14 offset:10240
    s_waitcnt lgkmcnt(10)
    v_mfma_f32_16x16x32_bf16 v[92:95], v[48:51], v[44:47], v[92:95]
    ds_read_b64_tr_b16 v[70:71], v14 offset:11520
    ds_read_b128 v[244:247], v7 offset:22528
    s_waitcnt lgkmcnt(10)
    v_mfma_f32_16x16x32_bf16 v[96:99], v[52:55], v[40:43], v[96:99]
    ds_read_b64_tr_b16 v[72:73], v14 offset:10280
    ds_read_b64_tr_b16 v[74:75], v14 offset:11560
    v_mfma_f32_16x16x32_bf16 v[100:103], v[52:55], v[44:47], v[100:103]
    ds_read_b64_tr_b16 v[76:77], v14 offset:10320
    ds_read_b64_tr_b16 v[78:79], v14 offset:11600
    s_waitcnt lgkmcnt(12)
    v_mfma_f32_16x16x32_bf16 v[104:107], v[56:59], v[40:43], v[104:107]
    ds_read_b64_tr_b16 v[80:81], v14 offset:10360
    ds_read_b64_tr_b16 v[82:83], v14 offset:11640
    v_mfma_f32_16x16x32_bf16 v[108:111], v[56:59], v[44:47], v[108:111]
    ds_read_b64_tr_b16 v[84:85], v15 offset:10240
    ds_read_b64_tr_b16 v[86:87], v15 offset:11520
    s_waitcnt lgkmcnt(14)
    v_mfma_f32_16x16x32_bf16 v[112:115], v[60:63], v[40:43], v[112:115]
    buffer_load_dwordx4 v250, s[8:11], s57 offen offset:1024 lds
    v_mfma_f32_16x16x32_bf16 v[116:119], v[60:63], v[44:47], v[116:119]
    s_cbranch_execz L_pfret
    s_mov_b64 exec, 0xffffffff
    buffer_load_dwordx4 v251, s[8:11], s57 offen offset:2048 lds
    s_mov_b64 exec, -1
    s_waitcnt lgkmcnt(12)
    v_mfma_f32_16x16x32_bf16 v[120:123], v[64:67], v[40:43], v[120:123]
    s_add_u32 s47, s38, 1
    s_add_u32 s48, s38, 2
    s_mul_i32 s3, s3, 0x11111111
    v_readlane_b32 s46, v39, s38
    v_readlane_b32 s47, v39, s47
    v_readlane_b32 s48, v39, s48
    v_mfma_f32_16x16x32_bf16 v[124:127], v[64:67], v[44:47], v[124:127]
    s_lshl_b32 s49, s39, 2
    s_xor_b32 s49, s49, 4
    s_xor_b32 s47, s47, s3
    s_xor_b32 s48, s48, s3
    s_or_b32 s47, s47, s48
    s_lshr_b32 s47, s47, s49
    s_cmp_eq_u32 s46, s3
    s_cselect_b32 s3, 1, 0
    s_mul_i32 s47, s47, s37
    s_and_b32 s47, s47, 15
    s_cselect_b32 s47, 0, 2
    s_mul_i32 s47, s47, s3
    s_or_b32 s3, s3, s47
    s_waitcnt vmcnt(6) lgkmcnt(0)
    s_barrier
    v_mfma_f32_16x16x32_bf16 v[88:91], v[68:71], v[240:243], v[88:91]
    ds_read_b64_tr_b16 v[48:49], v22 offset:24576
    ds_read_b64_tr_b16 v[50:51], v22 offset:25856
    v_mfma_f32_16x16x32_bf16 v[92:95], v[68:71], v[244:247], v[92:95]
    ds_read_b64_tr_b16 v[52:53], v22 offset:24616
    ds_read_b64_tr_b16 v[54:55], v22 offset:25896
    v_mfma_f32_16x16x32_bf16 v[96:99], v[72:75], v[240:243], v[96:99]
    ds_read_b64_tr_b16 v[56:57], v22 offset:24656
    ds_read_b64_tr_b16 v[58:59], v22 offset:25936
    v_mfma_f32_16x16x32_bf16 v[100:103], v[72:75], v[244:247], v[100:103]
    ds_read_b64_tr_b16 v[60:61], v22 offset:24696
    ds_read_b64_tr_b16 v[62:63], v22 offset:25976
    v_mfma_f32_16x16x32_bf16 v[104:107], v[76:79], v[240:243], v[104:107]
    ds_read_b64_tr_b16 v[64:65], v23 offset:24576
    s_cbranch_execz L_pfret
    ds_read_b64_tr_b16 v[66:67], v23 offset:25856
    v_mfma_f32_16x16x32_bf16 v[108:111], v[76:79], v[244:247], v[108:111]
    v_mfma_f32_16x16x32_bf16 v[112:115], v[80:83], v[240:243], v[112:115]
    v_mfma_f32_16x16x32_bf16 v[116:119], v[80:83], v[244:247], v[116:119]
    v_mfma_f32_16x16x32_bf16 v[120:123], v[84:87], v[240:243], v[120:123]
    v_mfma_f32_16x16x32_bf16 v[124:127], v[84:87], v[244:247], v[124:127]
    s_waitcnt lgkmcnt(8)
    v_mfma_f32_16x16x32_bf16 v[144:147], v[48:51], v[168:171], 0
    ds_read_b64_tr_b16 v[68:69], v22 offset:34816
    ds_read_b64_tr_b16 v[70:71], v22 offset:36096
    v_mfma_f32_16x16x32_bf16 v[148:151], v[48:51], v[172:175], 0
    ds_read_b64_tr_b16 v[72:73], v22 offset:34856
    ds_read_b64_tr_b16 v[74:75], v22 offset:36136
    v_mov_b64 v[40:41], -1
    v_mov_b64 v[42:43], -1
    v_cvt_pk_bf16_f32 v88, v88, v89
    v_cvt_pk_bf16_f32 v89, v90, v91
    s_waitcnt lgkmcnt(10)
    v_mfma_f32_16x16x32_bf16 v[152:155], v[52:55], v[168:171], 0
    ds_read_b64_tr_b16 v[76:77], v22 offset:34896
    ds_read_b64_tr_b16 v[78:79], v22 offset:36176
    v_cvt_pk_bf16_f32 v90, v92, v93
    v_cvt_pk_bf16_f32 v91, v94, v95
    s_nop 0
    v_permlane16_swap_b32 v88, v90
    v_permlane16_swap_b32 v89, v91
    v_mfma_f32_16x16x32_bf16 v[156:159], v[52:55], v[172:175], 0
    ds_read_b64_tr_b16 v[80:81], v22 offset:34936
    ds_read_b64_tr_b16 v[82:83], v22 offset:36216
    s_bitcmp1_b32 s3, 1
    s_cbranch_scc0 L_pc1f0
    buffer_store_dwordx4 v[88:91], v1, s[12:15], s65 offen offset:0 sc1
    s_branch L_pa1f0
L_pc1f0:
    buffer_store_dwordx4 v[88:91], v1, s[12:15], s65 offen offset:0 sc1
L_pa1f0:
    s_waitcnt lgkmcnt(12)
    v_mfma_f32_16x16x32_bf16 v[128:131], v[56:59], v[168:171], 0
    ds_read_b64_tr_b16 v[84:85], v23 offset:34816
    s_cbranch_execz L_pfret
    ds_read_b64_tr_b16 v[86:87], v23 offset:36096
    v_cvt_pk_bf16_f32 v96, v96, v97
    v_cvt_pk_bf16_f32 v97, v98, v99
    v_cvt_pk_bf16_f32 v98, v100, v101
    v_cvt_pk_bf16_f32 v99, v102, v103
    v_mfma_f32_16x16x32_bf16 v[132:135], v[56:59], v[172:175], 0
    s_add_u32 m0, s44, 10240
    s_add_u32 s57, s76, 1720320
    s_sub_u32 s56, s57, 2457600
    s_min_u32 s57, s57, s56
    buffer_load_dwordx4 v249, s[8:11], s57 offen offset:0 lds
    v_permlane16_swap_b32 v96, v98
    v_permlane16_swap_b32 v97, v99
    s_bitcmp1_b32 s3, 1
    s_cbranch_scc0 L_pc1f1
    buffer_store_dwordx4 v[96:99], v1, s[12:15], s65 offen offset:1024 sc1
    s_branch L_pa1f1
L_pc1f1:
    buffer_store_dwordx4 v[96:99], v1, s[12:15], s65 offen offset:1024 sc1
L_pa1f1:
    s_waitcnt lgkmcnt(12)
    v_mfma_f32_16x16x32_bf16 v[136:139], v[60:63], v[168:171], 0
    buffer_load_dwordx4 v250, s[8:11], s57 offen offset:1024 lds
    v_cvt_pk_bf16_f32 v104, v104, v105
    v_cvt_pk_bf16_f32 v105, v106, v107
    v_cvt_pk_bf16_f32 v106, v108, v109
    v_cvt_pk_bf16_f32 v107, v110, v111
    v_mfma_f32_16x16x32_bf16 v[140:143], v[60:63], v[172:175], 0
    s_mov_b64 exec, 0xffffffff
    buffer_load_dwordx4 v251, s[8:11], s57 offen offset:2048 lds
    s_mov_b64 exec, -1
    v_permlane16_swap_b32 v104, v106
    v_permlane16_swap_b32 v105, v107
    s_waitcnt lgkmcnt(10)
    v_mfma_f32_16x16x32_bf16 v[164:167], v[64:67], v[168:171], 0
    s_add_u32 m0, s44, 20480
    s_add_u32 s57, s76, 2211840
    s_sub_u32 s56, s57, 2457600
    s_min_u32 s57, s57, s56
    s_nop 0
    s_cbranch_execz L_pfret
    buffer_load_dwordx4 v249, s[8:11], s57 offen offset:0 lds
    v_mfma_f32_16x16x32_bf16 v[160:163], v[64:67], v[172:175], 0
    buffer_load_dwordx4 v250, s[8:11], s57 offen offset:1024 lds
    s_mov_b64 exec, 0xffffffff
    buffer_load_dwordx4 v251, s[8:11], s57 offen offset:2048 lds
    s_mov_b64 exec, -1
    s_waitcnt vmcnt(11) lgkmcnt(0)
    s_barrier
    v_mfma_f32_16x16x32_bf16 v[144:147], v[68:71], v[176:179], v[144:147]
    ds_read_b64_tr_b16 v[48:49], v22 offset:45056
    ds_read_b64_tr_b16 v[50:51], v22 offset:46336
    v_mfma_f32_16x16x32_bf16 v[148:151], v[68:71], v[180:183], v[148:151]
    ds_read_b64_tr_b16 v[52:53], v22 offset:45096
    ds_read_b64_tr_b16 v[54:55], v22 offset:46376
    s_bitcmp1_b32 s3, 1
    s_cbranch_scc0 L_pc1f2
    buffer_store_dwordx4 v[104:107], v1, s[12:15], s65 offen offset:2048 sc1
    s_branch L_pa1f2
L_pc1f2:
    buffer_store_dwordx4 v[104:107], v1, s[12:15], s65 offen offset:2048 sc1
L_pa1f2:
    v_mfma_f32_16x16x32_bf16 v[152:155], v[72:75], v[176:179], v[152:155]
    ds_read_b64_tr_b16 v[56:57], v22 offset:45136
    ds_read_b64_tr_b16 v[58:59], v22 offset:46416
    v_cvt_pk_bf16_f32 v112, v112, v113
    v_cvt_pk_bf16_f32 v113, v114, v115
    v_cvt_pk_bf16_f32 v114, v116, v117
    v_cvt_pk_bf16_f32 v115, v118, v119
    v_mfma_f32_16x16x32_bf16 v[156:159], v[72:75], v[180:183], v[156:159]
    ds_read_b64_tr_b16 v[60:61], v22 offset:45176
    ds_read_b64_tr_b16 v[62:63], v22 offset:46456
    v_permlane16_swap_b32 v112, v114
    v_permlane16_swap_b32 v113, v115
    s_bitcmp1_b32 s3, 1
    s_cbranch_scc0 L_pc1f3
    buffer_store_dwordx4 v[112:115], v1, s[12:15], s65 offen offset:3072 sc1
    s_branch L_pa1f3
L_pc1f3:
    buffer_store_dwordx4 v[112:115], v1, s[12:15], s65 offen offset:3072 sc1
L_pa1f3:
    v_mfma_f32_16x16x32_bf16 v[128:131], v[76:79], v[176:179], v[128:131]
    s_cbranch_execz L_pfret
    ds_read_b64_tr_b16 v[64:65], v23 offset:45056
    ds_read_b64_tr_b16 v[66:67], v23 offset:46336
    v_cvt_pk_bf16_f32 v120, v120, v121
    v_cvt_pk_bf16_f32 v121, v122, v123
    v_cvt_pk_bf16_f32 v122, v124, v125
    v_cvt_pk_bf16_f32 v123, v126, v127
    v_mfma_f32_16x16x32_bf16 v[132:135], v[76:79], v[180:183], v[132:135]
    v_permlane16_swap_b32 v120, v122
    v_permlane16_swap_b32 v121, v123
    s_add_u32 s55, s65, 4096
    s_bitcmp1_b32 s3, 1
    s_cbranch_scc0 L_pc1f4
    buffer_store_dwordx4 v[120:123], v1, s[12:15], s55 offen sc1
    s_branch L_pa1f4
L_pc1f4:
    buffer_store_dwordx4 v[120:123], v1, s[12:15], s55 offen sc1
L_pa1f4:
    v_mfma_f32_16x16x32_bf16 v[136:139], v[80:83], v[176:179], v[136:139]
    s_mul_i32 s43, s72, 5
    s_add_u32 s43, s43, 19
    s_sub_u32 s43, s43, s36
    s_sub_u32 s52, s43, 20
    s_cselect_b32 s43, s43, s52
    s_mul_i32 s43, s43, 40960
    s_mul_i32 s45, s72, 5
    s_add_u32 s45, s45, 4
    s_add_u32 s45, s45, s36
    s_sub_u32 s52, s45, 20
    s_cselect_b32 s45, s45, s52
    s_mul_i32 s45, s45, 40960
    v_mfma_f32_16x16x32_bf16 v[140:143], v[80:83], v[180:183], v[140:143]
    v_add_u32 v252, 3072, v33
    v_add_u32 v253, 2048, v34
    v_mfma_f32_16x16x32_bf16 v[164:167], v[84:87], v[176:179], v[164:167]
    s_mov_b32 s50, 1065369472
    s_mov_b32 s51, 1065369472
    v_mfma_f32_16x16x32_bf16 v[160:163], v[84:87], v[180:183], v[160:163]
    v_mov_b64 v[2:3], s[50:51]
    v_mov_b64 v[4:5], s[50:51]
    s_waitcnt lgkmcnt(8)
    v_mfma_f32_16x16x32_bf16 v[144:147], v[48:51], v[184:187], v[144:147]
    ds_read_b64_tr_b16 v[68:69], v22 offset:55296
    s_nop 0
    s_cbranch_execz L_pfret
    ds_read_b64_tr_b16 v[70:71], v22 offset:56576
    v_mfma_f32_16x16x32_bf16 v[148:151], v[48:51], v[188:191], v[148:151]
    ds_read_b64_tr_b16 v[72:73], v22 offset:55336
    ds_read_b64_tr_b16 v[74:75], v22 offset:56616
    v_mov_b64 v[6:7], s[50:51]
    v_mov_b64 v[8:9], s[50:51]
    s_waitcnt lgkmcnt(10)
    v_mfma_f32_16x16x32_bf16 v[152:155], v[52:55], v[184:187], v[152:155]
    ds_read_b64_tr_b16 v[76:77], v22 offset:55376
    ds_read_b64_tr_b16 v[78:79], v22 offset:56656
    v_mov_b64 v[92:93], s[50:51]
    v_mov_b64 v[94:95], s[50:51]
    v_mfma_f32_16x16x32_bf16 v[156:159], v[52:55], v[188:191], v[156:159]
    ds_read_b64_tr_b16 v[80:81], v22 offset:55416
    ds_read_b64_tr_b16 v[82:83], v22 offset:56696
    v_mov_b64 v[100:101], s[50:51]
    v_mov_b64 v[102:103], s[50:51]
    s_waitcnt lgkmcnt(12)
    v_mfma_f32_16x16x32_bf16 v[128:131], v[56:59], v[184:187], v[128:131]
    ds_read_b64_tr_b16 v[84:85], v23 offset:55296
    ds_read_b64_tr_b16 v[86:87], v23 offset:56576
    s_movk_i32 s51, 0x3f80
    v_mov_b64 v[40:41], s[50:51]
    v_mfma_f32_16x16x32_bf16 v[132:135], v[56:59], v[188:191], v[132:135]
    v_mov_b64 v[42:43], s[50:51]
    v_mov_b64 v[44:45], s[50:51]
    s_waitcnt lgkmcnt(12)
    v_mfma_f32_16x16x32_bf16 v[136:139], v[60:63], v[184:187], v[136:139]
    v_mov_b64 v[46:47], s[50:51]
    v_mov_b64 v[108:109], 0
    v_mfma_f32_16x16x32_bf16 v[140:143], v[60:63], v[188:191], v[140:143]
    v_mov_b64 v[110:111], 0
    v_lshrrev_b32 v116, 5, v0
    s_waitcnt lgkmcnt(10)
    v_mfma_f32_16x16x32_bf16 v[164:167], v[64:67], v[184:187], v[164:167]
    v_and_b32 v117, 31, v0
    v_lshlrev_b32 v116, 2, v116
    v_mfma_f32_16x16x32_bf16 v[160:163], v[64:67], v[188:191], v[160:163]
    v_sub_u32 v116, v117, v116
    v_subrev_u32 v168, 0, v116
    s_waitcnt vmcnt(11) lgkmcnt(0)
    s_barrier
    v_mfma_f32_16x16x32_bf16 v[144:147], v[68:71], v[192:195], v[144:147]
    s_nop 0
    s_cbranch_execz L_pfret
    ds_read_b64_tr_b16 v[48:49], v14 offset:36864
    ds_read_b64_tr_b16 v[50:51], v14 offset:38144
    v_mfma_f32_16x16x32_bf16 v[148:151], v[68:71], v[196:199], v[148:151]
    ds_read_b64_tr_b16 v[52:53], v14 offset:36904
    ds_read_b64_tr_b16 v[54:55], v14 offset:38184
    v_and_b32 v168, s100, v168
    v_subrev_u32 v169, 1, v116
    v_mfma_f32_16x16x32_bf16 v[152:155], v[72:75], v[192:195], v[152:155]
    ds_read_b64_tr_b16 v[56:57], v14 offset:36944
    ds_read_b64_tr_b16 v[58:59], v14 offset:38224
    v_and_b32 v169, s100, v169
    v_subrev_u32 v170, 2, v116
    v_mfma_f32_16x16x32_bf16 v[156:159], v[72:75], v[196:199], v[156:159]
    ds_read_b64_tr_b16 v[60:61], v14 offset:36984
    ds_read_b64_tr_b16 v[62:63], v14 offset:38264
    v_and_b32 v170, s100, v170
    v_subrev_u32 v171, 3, v116
    v_mfma_f32_16x16x32_bf16 v[128:131], v[76:79], v[192:195], v[128:131]
    ds_read_b64_tr_b16 v[64:65], v15 offset:36864
    ds_read_b64_tr_b16 v[66:67], v15 offset:38144
    v_and_b32 v171, s100, v171
    v_subrev_u32 v172, 8, v116
    v_mfma_f32_16x16x32_bf16 v[132:135], v[76:79], v[196:199], v[132:135]
    v_and_b32 v172, s100, v172
    v_subrev_u32 v173, 9, v116
    v_mfma_f32_16x16x32_bf16 v[136:139], v[80:83], v[192:195], v[136:139]
    v_and_b32 v173, s100, v173
    v_subrev_u32 v174, 10, v116
    v_mfma_f32_16x16x32_bf16 v[140:143], v[80:83], v[196:199], v[140:143]
    v_and_b32 v174, s100, v174
    v_subrev_u32 v175, 11, v116
    v_mfma_f32_16x16x32_bf16 v[164:167], v[84:87], v[192:195], v[164:167]
    v_and_b32 v175, s100, v175
    v_subrev_u32 v176, 16, v116
    v_mfma_f32_16x16x32_bf16 v[160:163], v[84:87], v[196:199], v[160:163]
    v_and_b32 v176, s100, v176
    v_subrev_u32 v177, 17, v116
    s_waitcnt lgkmcnt(8)
    v_mfma_f32_16x16x32_bf16 v[144:147], v[48:51], v[200:203], v[144:147]
    ds_read_b64_tr_b16 v[68:69], v14 offset:47104
    ds_read_b64_tr_b16 v[70:71], v14 offset:48384
    s_cbranch_execz L_pfret
    v_mfma_f32_16x16x32_bf16 v[148:151], v[48:51], v[204:207], v[148:151]
    ds_read_b64_tr_b16 v[72:73], v14 offset:47144
    ds_read_b64_tr_b16 v[74:75], v14 offset:48424
    v_and_b32 v177, s100, v177
    v_subrev_u32 v178, 18, v116
    s_waitcnt lgkmcnt(10)
    v_mfma_f32_16x16x32_bf16 v[152:155], v[52:55], v[200:203], v[152:155]
    ds_read_b64_tr_b16 v[76:77], v14 offset:47184
    ds_read_b64_tr_b16 v[78:79], v14 offset:48464
    v_and_b32 v178, s100, v178
    v_subrev_u32 v179, 19, v116
    v_mfma_f32_16x16x32_bf16 v[156:159], v[52:55], v[204:207], v[156:159]
    ds_read_b64_tr_b16 v[80:81], v14 offset:47224
    ds_read_b64_tr_b16 v[82:83], v14 offset:48504
    v_and_b32 v179, s100, v179
    v_subrev_u32 v180, 24, v116
    s_waitcnt lgkmcnt(12)
    v_mfma_f32_16x16x32_bf16 v[128:131], v[56:59], v[200:203], v[128:131]
    ds_read_b64_tr_b16 v[84:85], v15 offset:47104
    ds_read_b64_tr_b16 v[86:87], v15 offset:48384
    v_and_b32 v180, s100, v180
    v_subrev_u32 v181, 25, v116
    v_mfma_f32_16x16x32_bf16 v[132:135], v[56:59], v[204:207], v[132:135]
    v_and_b32 v181, s100, v181
    v_subrev_u32 v182, 26, v116
    s_waitcnt lgkmcnt(12)
    v_mfma_f32_16x16x32_bf16 v[136:139], v[60:63], v[200:203], v[136:139]
    v_and_b32 v182, s100, v182
    v_subrev_u32 v183, 27, v116
    v_mfma_f32_16x16x32_bf16 v[140:143], v[60:63], v[204:207], v[140:143]
    v_and_b32 v183, s100, v183
    v_xor_b32 v184, s100, v168
    s_waitcnt lgkmcnt(10)
    v_mfma_f32_16x16x32_bf16 v[164:167], v[64:67], v[200:203], v[164:167]
    v_xor_b32 v185, s100, v169
    v_xor_b32 v186, s100, v170
    v_mfma_f32_16x16x32_bf16 v[160:163], v[64:67], v[204:207], v[160:163]
    v_xor_b32 v187, s100, v171
    v_xor_b32 v188, s100, v172
    s_waitcnt vmcnt(0)
    s_mov_b64 exec, 1
    s_bitcmp1_b32 s3, 1
    s_cbranch_scc0 L_fc1f
    buffer_store_dword v26, off, s[12:15], s75 offset:512
    s_branch L_fd1f
L_fc1f:
    s_cbranch_execz L_pfret
    buffer_store_dword v26, off, s[12:15], s75 offset:512 sc1
L_fd1f:
    s_mov_b64 exec, -1
    s_waitcnt lgkmcnt(0)
    s_barrier
    v_mfma_f32_16x16x32_bf16 v[144:147], v[68:71], v[208:211], v[144:147]
    ds_read_b64_tr_b16 v[48:49], v14 offset:0
    ds_read_b64_tr_b16 v[50:51], v14 offset:1280
    v_mfma_f32_16x16x32_bf16 v[148:151], v[68:71], v[212:215], v[148:151]
    ds_read_b64_tr_b16 v[52:53], v14 offset:40
    ds_read_b64_tr_b16 v[54:55], v14 offset:1320
    v_xor_b32 v189, s100, v173
    v_xor_b32 v190, s100, v174
    v_mfma_f32_16x16x32_bf16 v[152:155], v[72:75], v[208:211], v[152:155]
    ds_read_b64_tr_b16 v[56:57], v14 offset:80
    ds_read_b64_tr_b16 v[58:59], v14 offset:1360
    v_xor_b32 v191, s100, v175
    v_xor_b32 v192, s100, v176
    v_mfma_f32_16x16x32_bf16 v[156:159], v[72:75], v[212:215], v[156:159]
    ds_read_b64_tr_b16 v[60:61], v14 offset:120
    ds_read_b64_tr_b16 v[62:63], v14 offset:1400
    v_xor_b32 v193, s100, v177
    v_xor_b32 v194, s100, v178
    v_mfma_f32_16x16x32_bf16 v[128:131], v[76:79], v[208:211], v[128:131]
    ds_read_b64_tr_b16 v[64:65], v15 offset:0
    ds_read_b64_tr_b16 v[66:67], v15 offset:1280
    v_xor_b32 v195, s100, v179
    v_xor_b32 v196, s100, v180
    v_mfma_f32_16x16x32_bf16 v[132:135], v[76:79], v[212:215], v[132:135]
    v_xor_b32 v197, s100, v181
    v_xor_b32 v198, s100, v182
    v_mfma_f32_16x16x32_bf16 v[136:139], v[80:83], v[208:211], v[136:139]
    v_xor_b32 v199, s100, v183
    v_mfma_f32_16x16x32_bf16 v[140:143], v[80:83], v[212:215], v[140:143]
    v_mfma_f32_16x16x32_bf16 v[164:167], v[84:87], v[208:211], v[164:167]
    v_mfma_f32_16x16x32_bf16 v[160:163], v[84:87], v[212:215], v[160:163]
    s_waitcnt lgkmcnt(8)
    v_mfma_f32_16x16x32_bf16 v[144:147], v[48:51], v[216:219], v[144:147]
    ds_read_b64_tr_b16 v[68:69], v14 offset:10240
    ds_read_b64_tr_b16 v[70:71], v14 offset:11520
    s_cbranch_execz L_pfret
    v_mfma_f32_16x16x32_bf16 v[148:151], v[48:51], v[220:223], v[148:151]
    ds_read_b64_tr_b16 v[72:73], v14 offset:10280
    ds_read_b64_tr_b16 v[74:75], v14 offset:11560
    s_mul_i32 s52, s39, 1016
    s_sub_u32 s76, s64, s52
    s_lshl_b32 s52, s40, 6
    s_add_u32 s76, s76, s52
    s_lshl_b32 s52, s41, 2
    s_add_u32 s76, s76, s52
    s_waitcnt lgkmcnt(10)
    v_mfma_f32_16x16x32_bf16 v[152:155], v[52:55], v[216:219], v[152:155]
    ds_read_b64_tr_b16 v[76:77], v14 offset:10320
    ds_read_b64_tr_b16 v[78:79], v14 offset:11600
    v_mfma_f32_16x16x32_bf16 v[156:159], v[52:55], v[220:223], v[156:159]
    ds_read_b64_tr_b16 v[80:81], v14 offset:10360
    ds_read_b64_tr_b16 v[82:83], v14 offset:11640
    s_waitcnt lgkmcnt(12)
    v_mfma_f32_16x16x32_bf16 v[128:131], v[56:59], v[216:219], v[128:131]
    ds_read_b64_tr_b16 v[84:85], v15 offset:10240
    ds_read_b64_tr_b16 v[86:87], v15 offset:11520
    v_mfma_f32_16x16x32_bf16 v[132:135], v[56:59], v[220:223], v[132:135]
    s_waitcnt lgkmcnt(12)
    v_mfma_f32_16x16x32_bf16 v[136:139], v[60:63], v[216:219], v[136:139]
    v_mfma_f32_16x16x32_bf16 v[140:143], v[60:63], v[220:223], v[140:143]
    s_waitcnt lgkmcnt(10)
    v_mfma_f32_16x16x32_bf16 v[164:167], v[64:67], v[216:219], v[164:167]
    v_mfma_f32_16x16x32_bf16 v[160:163], v[64:67], v[220:223], v[160:163]
    buffer_load_dwordx2 v[254:255], off, s[12:15], s69 sc1
    s_xor_b32 s54, s75, 0x404
    buffer_load_dword v124, off, s[12:15], s54 offset:512 sc1
    s_lshl_b32 s46, s39, 4
    s_add_u32 s46, s46, s38
    s_lshl_b32 s46, s46, 2
    s_add_u32 s46, s46, s40
    s_lshl_b32 s46, s46, 1
    s_add_u32 s46, s46, s41
    s_mul_i32 s46, s46, 5120
    s_mul_i32 s47, s37, 20971520
    s_sub_u32 s46, s46, s47
    s_nop 0
    s_cbranch_execz L_pfret
    s_add_u32 s48, s46, 20971520
    s_lshl_b32 s49, s40, 1
    s_add_u32 s49, s49, s41
    s_mul_i32 s49, s49, 5120
    s_add_u32 s49, s49, 81920
    s_mov_b32 s53, 100000
    s_waitcnt lgkmcnt(0)
    s_barrier
    v_mfma_f32_16x16x32_bf16 v[144:147], v[68:71], v[224:227], v[144:147]
    ds_read_b64_tr_b16 v[48:49], v14 offset:57344
    ds_read_b64_tr_b16 v[50:51], v14 offset:58624
    v_mfma_f32_16x16x32_bf16 v[148:151], v[68:71], v[228:231], v[148:151]
    ds_read_b64_tr_b16 v[52:53], v14 offset:57384
    ds_read_b64_tr_b16 v[54:55], v14 offset:58664
    v_mfma_f32_16x16x32_bf16 v[152:155], v[72:75], v[224:227], v[152:155]
    ds_read_b64_tr_b16 v[56:57], v14 offset:57424
    ds_read_b64_tr_b16 v[58:59], v14 offset:58704
    v_mfma_f32_16x16x32_bf16 v[156:159], v[72:75], v[228:231], v[156:159]
    ds_read_b64_tr_b16 v[60:61], v14 offset:57464
    ds_read_b64_tr_b16 v[62:63], v14 offset:58744
    v_mfma_f32_16x16x32_bf16 v[128:131], v[76:79], v[224:227], v[128:131]
    ds_read_b64_tr_b16 v[64:65], v15 offset:57344
    ds_read_b64_tr_b16 v[66:67], v15 offset:58624
    v_mfma_f32_16x16x32_bf16 v[132:135], v[76:79], v[228:231], v[132:135]
    v_mfma_f32_16x16x32_bf16 v[136:139], v[80:83], v[224:227], v[136:139]
    v_mfma_f32_16x16x32_bf16 v[140:143], v[80:83], v[228:231], v[140:143]
    v_mfma_f32_16x16x32_bf16 v[164:167], v[84:87], v[224:227], v[164:167]
    v_mfma_f32_16x16x32_bf16 v[160:163], v[84:87], v[228:231], v[160:163]
    s_waitcnt vmcnt(0)
L_it1f28l:
    v_readfirstlane_b32 s46, v124
    s_nop 0
    s_cmp_eq_u32 s46, 0
    s_cbranch_scc1 L_it1f28r
    s_add_u32 m0, s49, 0
    s_add_u32 s47, s48, 0
    buffer_load_dwordx4 v1, s[12:15], s47 offen offset:0 lds
    buffer_load_dwordx4 v1, s[12:15], s47 offen offset:1024 lds
    s_cbranch_execz L_pfret
    buffer_load_dwordx4 v1, s[12:15], s47 offen offset:2048 lds
    buffer_load_dwordx4 v1, s[12:15], s47 offen offset:3072 lds
    s_add_u32 m0, s49, 4096
    s_add_u32 s47, s48, 4096
    buffer_load_dwordx4 v1, s[12:15], s47 offen offset:0 lds
    s_mov_b32 s53, 0
    s_branch L_it1f28
L_it1f28r:
    buffer_load_dword v124, off, s[12:15], s54 offset:512 sc1
L_it1f28:
    s_waitcnt lgkmcnt(8)
    v_mfma_f32_16x16x32_bf16 v[144:147], v[48:51], v[232:235], v[144:147]
    ds_read_b64_tr_b16 v[68:69], v14 offset:20480
    ds_read_b64_tr_b16 v[70:71], v14 offset:21760
    v_mfma_f32_16x16x32_bf16 v[148:151], v[48:51], v[236:239], v[148:151]
    ds_read_b64_tr_b16 v[72:73], v14 offset:20520
    ds_read_b64_tr_b16 v[74:75], v14 offset:21800
    s_waitcnt lgkmcnt(10)
    v_mfma_f32_16x16x32_bf16 v[152:155], v[52:55], v[232:235], v[152:155]
    ds_read_b64_tr_b16 v[76:77], v14 offset:20560
    ds_read_b64_tr_b16 v[78:79], v14 offset:21840
    v_mfma_f32_16x16x32_bf16 v[156:159], v[52:55], v[236:239], v[156:159]
    ds_read_b64_tr_b16 v[80:81], v14 offset:20600
    ds_read_b64_tr_b16 v[82:83], v14 offset:21880
    s_waitcnt lgkmcnt(12)
    v_mfma_f32_16x16x32_bf16 v[128:131], v[56:59], v[232:235], v[128:131]
    ds_read_b64_tr_b16 v[84:85], v15 offset:20480
    ds_read_b64_tr_b16 v[86:87], v15 offset:21760
    v_mfma_f32_16x16x32_bf16 v[132:135], v[56:59], v[236:239], v[132:135]
    s_waitcnt lgkmcnt(12)
    v_mfma_f32_16x16x32_bf16 v[136:139], v[60:63], v[232:235], v[136:139]
    v_mfma_f32_16x16x32_bf16 v[140:143], v[60:63], v[236:239], v[140:143]
    s_waitcnt lgkmcnt(10)
    v_mfma_f32_16x16x32_bf16 v[164:167], v[64:67], v[232:235], v[164:167]
    v_mfma_f32_16x16x32_bf16 v[160:163], v[64:67], v[236:239], v[160:163]
    s_cmp_eq_u32 s53, 0
    s_cbranch_scc1 L_it1f29
L_it1f29l:
    s_waitcnt vmcnt(0)
    v_readfirstlane_b32 s46, v124
    s_cbranch_execz L_pfret
    s_nop 0
    s_cmp_eq_u32 s46, 0
    s_cbranch_scc1 L_it1f29r
    s_add_u32 m0, s49, 0
    s_add_u32 s47, s48, 0
    buffer_load_dwordx4 v1, s[12:15], s47 offen offset:0 lds
    buffer_load_dwordx4 v1, s[12:15], s47 offen offset:1024 lds
    buffer_load_dwordx4 v1, s[12:15], s47 offen offset:2048 lds
    buffer_load_dwordx4 v1, s[12:15], s47 offen offset:3072 lds
    s_add_u32 m0, s49, 4096
    s_add_u32 s47, s48, 4096
    buffer_load_dwordx4 v1, s[12:15], s47 offen offset:0 lds
    s_mov_b32 s53, 0
    s_branch L_it1f29
L_it1f29r:
    buffer_load_dword v124, off, s[12:15], s54 offset:512 sc1
L_it1f29:
    s_waitcnt lgkmcnt(0)
    s_barrier
    v_mfma_f32_16x16x32_bf16 v[164:167], v[84:87], v[240:243], v[164:167]
    v_mfma_f32_16x16x32_bf16 v[160:163], v[84:87], v[244:247], v[160:163]
    v_mfma_f32_16x16x32_bf16 v[144:147], v[68:71], v[240:243], v[144:147]
    v_mfma_f32_16x16x32_bf16 v[148:151], v[68:71], v[244:247], v[148:151]
    v_mfma_f32_16x16x32_bf16 v[152:155], v[72:75], v[240:243], v[152:155]
    s_nop 4
    v_permlane32_swap_b32 v164, v160
    v_permlane32_swap_b32 v165, v161
    v_mfma_f32_16x16x32_bf16 v[156:159], v[72:75], v[244:247], v[156:159]
    v_permlane32_swap_b32 v166, v162
    v_permlane32_swap_b32 v167, v163
    v_mfma_f32_16x16x32_bf16 v[128:131], v[76:79], v[240:243], v[128:131]
    ds_write_b128 v26, v[144:147]
    ds_write_b128 v26, v[148:151] offset:1024
    v_mfma_f32_16x16x32_bf16 v[132:135], v[76:79], v[244:247], v[132:135]
    ds_write_b128 v26, v[164:167] offset:4096
    v_mfma_f32_16x16x32_bf16 v[136:139], v[80:83], v[240:243], v[136:139]
    ds_write_b128 v26, v[152:155] offset:2048
    v_mfma_f32_16x16x32_bf16 v[140:143], v[80:83], v[244:247], v[140:143]
    ds_write_b128 v26, v[156:159] offset:3072
    s_cmp_eq_u32 s53, 0
    s_cbranch_scc1 L_it1fz
L_it1fzl:
    s_waitcnt vmcnt(0)
    s_cbranch_execz L_pfret
    v_readfirstlane_b32 s46, v124
    s_sub_u32 s53, s53, 1
    s_cmp_eq_u32 s53, 0
    s_cselect_b32 s46, 1, s46
    s_cmp_eq_u32 s46, 0
    s_cbranch_scc1 L_it1fzr
    s_add_u32 m0, s49, 0
    s_add_u32 s47, s48, 0
    buffer_load_dwordx4 v1, s[12:15], s47 offen offset:0 lds
    buffer_load_dwordx4 v1, s[12:15], s47 offen offset:1024 lds
    buffer_load_dwordx4 v1, s[12:15], s47 offen offset:2048 lds
    buffer_load_dwordx4 v1, s[12:15], s47 offen offset:3072 lds
    s_add_u32 m0, s49, 4096
    s_add_u32 s47, s48, 4096
    buffer_load_dwordx4 v1, s[12:15], s47 offen offset:0 lds
    s_mov_b32 s53, 0
    s_branch L_it1fz
L_it1fzr:
    buffer_load_dword v124, off, s[12:15], s54 offset:512 sc1
    s_branch L_it1fzl
L_it1fz:
    s_waitcnt vmcnt(0)
    s_nop 3
    s_branch L_g_post
L_g_own1:
    s_add_u32 m0, s43, 36864
    s_add_u32 s57, s1, 128
    buffer_load_dwordx4 v2, s[4:7], s57 offen offset:0 lds
    buffer_load_dwordx4 v3, s[4:7], s57 offen offset:1024 lds
    buffer_load_dwordx4 v4, s[4:7], s57 offen offset:2048 lds
    buffer_load_dwordx4 v5, s[4:7], s57 offen offset:3072 lds
    s_waitcnt vmcnt(6)
    s_barrier
    ds_read_b128 v[40:43], v6 offset:20480
    ds_read_b64_tr_b16 v[48:49], v14 offset:0
    ds_read_b64_tr_b16 v[50:51], v14 offset:1280
    ds_read_b128 v[44:47], v6 offset:22528
    ds_read_b64_tr_b16 v[52:53], v14 offset:40
    ds_read_b64_tr_b16 v[54:55], v14 offset:1320
    ds_read_b64_tr_b16 v[56:57], v14 offset:80
    ds_read_b64_tr_b16 v[58:59], v14 offset:1360
    ds_read_b64_tr_b16 v[60:61], v14 offset:120
    s_nop 0
    s_cbranch_execz L_pfret
    ds_read_b64_tr_b16 v[62:63], v14 offset:1400
    ds_read_b64_tr_b16 v[64:65], v15 offset:0
    ds_read_b64_tr_b16 v[66:67], v15 offset:1280
    s_waitcnt lgkmcnt(9)
    v_mfma_f32_16x16x32_bf16 v[88:91], v[40:43], v[48:51], 0
    ds_read_b128 v[168:171], v7 offset:20480
    ds_read_b64_tr_b16 v[68:69], v14 offset:10240
    s_waitcnt lgkmcnt(10)
    v_mfma_f32_16x16x32_bf16 v[92:95], v[44:47], v[48:51], 0
    ds_read_b64_tr_b16 v[70:71], v14 offset:11520
    ds_read_b128 v[172:175], v7 offset:22528
    v_add_u32 v22, 98304, v14
    v_add_u32 v23, 98304, v15
    v_add_u32 v8, 49152, v6
    s_waitcnt lgkmcnt(10)
    v_mfma_f32_16x16x32_bf16 v[96:99], v[40:43], v[52:55], 0
    ds_read_b64_tr_b16 v[72:73], v14 offset:10280
    ds_read_b64_tr_b16 v[74:75], v14 offset:11560
    v_add_u32 v9, 49152, v7
    s_getreg_b32 s3, hwreg(HW_REG_XCC_ID, 0, 3)
    s_or_b32 s3, s3, 8
    v_mfma_f32_16x16x32_bf16 v[100:103], v[44:47], v[52:55], 0
    ds_read_b64_tr_b16 v[76:77], v14 offset:10320
    ds_read_b64_tr_b16 v[78:79], v14 offset:11600
    v_lshlrev_b32 v1, 4, v0
    v_and_b32 v158, 15, v0
    v_lshrrev_b32 v159, 4, v0
    s_waitcnt lgkmcnt(12)
    v_mfma_f32_16x16x32_bf16 v[104:107], v[40:43], v[56:59], 0
    ds_read_b64_tr_b16 v[80:81], v14 offset:10360
    ds_read_b64_tr_b16 v[82:83], v14 offset:11640
    s_mov_b32 s24, s52
    s_and_b32 s25, s53, 0xffff
    s_mov_b32 s26, 256
    v_mfma_f32_16x16x32_bf16 v[108:111], v[44:47], v[56:59], 0
    ds_read_b64_tr_b16 v[84:85], v15 offset:10240
    s_nop 0
    s_cbranch_execz L_pfret
    ds_read_b64_tr_b16 v[86:87], v15 offset:11520
    s_mov_b32 s27, 0x00020000
    s_mov_b32 s32, s54
    s_and_b32 s33, s55, 0xffff
    s_waitcnt lgkmcnt(14)
    v_mfma_f32_16x16x32_bf16 v[112:115], v[40:43], v[60:63], 0
    s_add_u32 m0, s43, 53248
    s_add_u32 s57, s1, 256
    buffer_load_dwordx4 v2, s[4:7], s57 offen offset:0 lds
    s_lshl_b32 s34, s37, 28
    s_mov_b32 s35, 0x00020000
    s_mul_i32 s46, s40, 10240
    v_mfma_f32_16x16x32_bf16 v[116:119], v[44:47], v[60:63], 0
    buffer_load_dwordx4 v3, s[4:7], s57 offen offset:1024 lds
    v_add_u32 v160, s46, v1
    s_lshl_b32 s47, s41, 11
    v_add_u32 v10, s47, v160
    s_waitcnt lgkmcnt(12)
    v_mfma_f32_16x16x32_bf16 v[120:123], v[40:43], v[64:67], 0
    buffer_load_dwordx4 v4, s[4:7], s57 offen offset:2048 lds
    v_add_u32 v11, 40960, v10
    v_add_u32 v12, 4096, v160
    v_add_u32 v13, 45056, v160
    v_mfma_f32_16x16x32_bf16 v[124:127], v[44:47], v[64:67], 0
    buffer_load_dwordx4 v5, s[4:7], s57 offen offset:3072 lds
    s_mul_i32 s48, s41, 5120
    s_add_u32 s48, s48, 81920
    v_add_u32 v28, s48, v160
    s_add_u32 s56, s0, 983040
    s_sub_u32 s57, s56, 2457600
    s_min_u32 s56, s56, s57
    buffer_load_dword v141, v133, s[8:11], s56 offen offset:1280
    s_add_u32 s56, s1, 512
    s_sub_u32 s57, s56, 1280
    s_min_u32 s56, s56, s57
    buffer_load_dword v140, v132, s[4:7], s56 offen offset:0
    s_lshl_b32 s56, s39, 4
    s_cbranch_execz L_pfret
    s_add_u32 s56, s56, s38
    s_lshl_b32 s56, s56, 3
    s_add_u32 s56, s56, s36
    s_lshl_b32 s56, s56, 10
    s_add_u32 s56, s56, 12582912
    v_mov_b64 v[240:241], -1
    v_mov_b64 v[242:243], -1
    v_lshlrev_b32 v244, 4, v0
    v_lshl_add_u32 v244, s37, 30, v244
    buffer_store_dwordx4 v[240:243], v244, s[12:15], s56 offen sc1
    s_waitcnt vmcnt(7) lgkmcnt(0)
    s_barrier
    v_mfma_f32_16x16x32_bf16 v[88:91], v[168:171], v[68:71], v[88:91]
    ds_read_b128 v[40:43], v6 offset:36864
    ds_read_b64_tr_b16 v[48:49], v22 offset:24576
    v_mfma_f32_16x16x32_bf16 v[92:95], v[172:175], v[68:71], v[92:95]
    ds_read_b64_tr_b16 v[50:51], v22 offset:25856
    ds_read_b128 v[44:47], v6 offset:38912
    v_and_b32 v161, 31, v0
    v_lshrrev_b32 v162, 5, v0
    v_lshlrev_b32 v163, 4, v161
    v_mfma_f32_16x16x32_bf16 v[96:99], v[168:171], v[72:75], v[96:99]
    ds_read_b64_tr_b16 v[52:53], v22 offset:24616
    ds_read_b64_tr_b16 v[54:55], v22 offset:25896
    v_lshl_add_u32 v163, v162, 8, v163
    s_add_u32 s46, s46, 5120
    v_add_u32 v163, s46, v163
    v_mfma_f32_16x16x32_bf16 v[100:103], v[172:175], v[72:75], v[100:103]
    ds_read_b64_tr_b16 v[56:57], v22 offset:24656
    ds_read_b64_tr_b16 v[58:59], v22 offset:25936
    v_cmp_gt_u32 vcc, 16, v161
    s_lshl_b32 s48, s41, 7
    s_add_u32 s46, s47, 0
    v_mfma_f32_16x16x32_bf16 v[104:107], v[168:171], v[76:79], v[104:107]
    ds_read_b64_tr_b16 v[60:61], v22 offset:24696
    ds_read_b64_tr_b16 v[62:63], v22 offset:25976
    s_add_u32 s49, s48, 3840
    v_mov_b32 v164, s49
    v_mov_b32 v165, s46
    v_mfma_f32_16x16x32_bf16 v[108:111], v[172:175], v[76:79], v[108:111]
    s_nop 0
    s_cbranch_execz L_pfret
    ds_read_b64_tr_b16 v[64:65], v23 offset:24576
    ds_read_b64_tr_b16 v[66:67], v23 offset:25856
    v_cndmask_b32 v164, v164, v165, vcc
    v_add_u32 v18, v163, v164
    v_add_u32 v19, 40960, v18
    v_mfma_f32_16x16x32_bf16 v[112:115], v[168:171], v[80:83], v[112:115]
    s_add_u32 m0, s43, 20480
    s_add_u32 s57, s1, 384
    buffer_load_dwordx4 v2, s[4:7], s57 offen offset:0 lds
    s_add_u32 s46, s47, 1024
    s_add_u32 s49, s48, 3904
    v_mov_b32 v164, s49
    v_mfma_f32_16x16x32_bf16 v[116:119], v[172:175], v[80:83], v[116:119]
    buffer_load_dwordx4 v3, s[4:7], s57 offen offset:1024 lds
    v_mov_b32 v165, s46
    v_cndmask_b32 v164, v164, v165, vcc
    v_add_u32 v20, v163, v164
    v_mfma_f32_16x16x32_bf16 v[120:123], v[168:171], v[84:87], v[120:123]
    buffer_load_dwordx4 v4, s[4:7], s57 offen offset:2048 lds
    v_add_u32 v21, 40960, v20
    s_mul_i32 s46, s36, 5120
    s_add_u32 s47, s46, 122880
    v_mfma_f32_16x16x32_bf16 v[124:127], v[172:175], v[84:87], v[124:127]
    buffer_load_dwordx4 v5, s[4:7], s57 offen offset:3072 lds
    v_add_u32 v26, s47, v1
    s_sub_u32 s47, 158720, s46
    v_add_u32 v27, s47, v1
    s_waitcnt lgkmcnt(9)
    v_mfma_f32_16x16x32_bf16 v[88:91], v[40:43], v[48:51], v[88:91]
    ds_read_b128 v[176:179], v7 offset:36864
    ds_read_b64_tr_b16 v[68:69], v22 offset:34816
    s_waitcnt lgkmcnt(10)
    v_mfma_f32_16x16x32_bf16 v[92:95], v[44:47], v[48:51], v[92:95]
    ds_read_b64_tr_b16 v[70:71], v22 offset:36096
    ds_read_b128 v[180:183], v7 offset:38912
    v_bfe_u32 v164, v0, 4, 1
    s_nop 0
    s_cbranch_execz L_pfret
    v_mul_u32_u24 v165, 20480, v164
    v_lshl_add_u32 v165, v158, 4, v165
    s_waitcnt lgkmcnt(10)
    v_mfma_f32_16x16x32_bf16 v[96:99], v[40:43], v[52:55], v[96:99]
    ds_read_b64_tr_b16 v[72:73], v22 offset:34856
    ds_read_b64_tr_b16 v[74:75], v22 offset:36136
    v_lshl_add_u32 v29, v162, 8, v165
    s_sub_u32 s46, s42, s39
    s_lshl_b32 s47, s40, 1
    v_mfma_f32_16x16x32_bf16 v[100:103], v[44:47], v[52:55], v[100:103]
    ds_read_b64_tr_b16 v[76:77], v22 offset:34896
    ds_read_b64_tr_b16 v[78:79], v22 offset:36176
    s_add_u32 s46, s46, s47
    s_mul_i32 s46, s46, 20480
    s_add_u32 s46, s46, 6291456
    s_waitcnt lgkmcnt(12)
    v_mfma_f32_16x16x32_bf16 v[104:107], v[40:43], v[56:59], v[104:107]
    ds_read_b64_tr_b16 v[80:81], v22 offset:34936
    ds_read_b64_tr_b16 v[82:83], v22 offset:36216
    s_lshl_b32 s47, s40, 5
    s_add_u32 s47, s47, s41
    s_lshl_b32 s47, s47, 2
    v_mfma_f32_16x16x32_bf16 v[108:111], v[44:47], v[56:59], v[108:111]
    ds_read_b64_tr_b16 v[84:85], v23 offset:34816
    ds_read_b64_tr_b16 v[86:87], v23 offset:36096
    s_add_u32 s75, s64, s47
    s_lshr_b32 s72, s39, 1
    s_mul_i32 s48, s72, 5120
    s_waitcnt lgkmcnt(14)
    v_mfma_f32_16x16x32_bf16 v[112:115], v[40:43], v[60:63], v[112:115]
    s_add_u32 s56, s0, 1474560
    s_sub_u32 s57, s56, 2457600
    s_min_u32 s56, s56, s57
    buffer_load_dword v143, v133, s[8:11], s56 offen offset:1280
    s_add_u32 s46, s46, s48
    s_and_b32 s47, s39, 1
    s_lshl_b32 s47, s47, 1
    v_mfma_f32_16x16x32_bf16 v[116:119], v[44:47], v[60:63], v[116:119]
    s_add_u32 s56, s1, 768
    s_cbranch_execz L_pfret
    s_sub_u32 s57, s56, 1280
    s_min_u32 s56, s56, s57
    buffer_load_dword v142, v132, s[4:7], s56 offen offset:0
    s_add_u32 s47, s47, s41
    s_lshl_b32 s48, s47, 10
    s_add_u32 s73, s46, s48
    s_waitcnt lgkmcnt(12)
    v_mfma_f32_16x16x32_bf16 v[120:123], v[40:43], v[64:67], v[120:123]
    s_lshl_b32 s48, s47, 8
    s_add_u32 s74, s46, s48
    s_add_u32 s74, s74, 4096
    v_mfma_f32_16x16x32_bf16 v[124:127], v[44:47], v[64:67], v[124:127]
    s_mul_i32 s47, s39, 160
    v_mul_u32_u24 v166, 205, v0
    v_lshrrev_b32 v166, 11, v166
    s_waitcnt vmcnt(9) lgkmcnt(0)
    s_barrier
    v_mfma_f32_16x16x32_bf16 v[88:91], v[176:179], v[68:71], v[88:91]
    ds_read_b128 v[40:43], v8 offset:4096
    ds_read_b64_tr_b16 v[48:49], v22 offset:45056
    v_mfma_f32_16x16x32_bf16 v[92:95], v[180:183], v[68:71], v[92:95]
    ds_read_b64_tr_b16 v[50:51], v22 offset:46336
    ds_read_b128 v[44:47], v8 offset:6144
    v_mul_u32_u24 v166, 1120, v166
    v_add3_u32 v30, v166, v1, s47
    v_add_u32 v165, 64, v0
    v_mfma_f32_16x16x32_bf16 v[96:99], v[176:179], v[72:75], v[96:99]
    ds_read_b64_tr_b16 v[52:53], v22 offset:45096
    ds_read_b64_tr_b16 v[54:55], v22 offset:46376
    v_mul_u32_u24 v166, 205, v165
    v_lshrrev_b32 v166, 11, v166
    v_mul_u32_u24 v166, 1120, v166
    v_mfma_f32_16x16x32_bf16 v[100:103], v[180:183], v[72:75], v[100:103]
    ds_read_b64_tr_b16 v[56:57], v22 offset:45136
    ds_read_b64_tr_b16 v[58:59], v22 offset:46416
    v_add3_u32 v31, v166, v1, s47
    v_add_u32 v165, 128, v0
    s_nop 0
    s_cbranch_execz L_pfret
    v_mul_u32_u24 v166, 205, v165
    v_mfma_f32_16x16x32_bf16 v[104:107], v[176:179], v[76:79], v[104:107]
    ds_read_b64_tr_b16 v[60:61], v22 offset:45176
    ds_read_b64_tr_b16 v[62:63], v22 offset:46456
    v_lshrrev_b32 v166, 11, v166
    v_mul_u32_u24 v166, 1120, v166
    v_add3_u32 v32, v166, v1, s47
    v_mfma_f32_16x16x32_bf16 v[108:111], v[180:183], v[76:79], v[108:111]
    ds_read_b64_tr_b16 v[64:65], v23 offset:45056
    ds_read_b64_tr_b16 v[66:67], v23 offset:46336
    v_add_u32 v165, 192, v0
    v_mul_u32_u24 v166, 205, v165
    v_lshrrev_b32 v166, 11, v166
    v_mfma_f32_16x16x32_bf16 v[112:115], v[176:179], v[80:83], v[112:115]
    s_add_u32 m0, s43, 36864
    s_add_u32 s57, s1, 512
    s_sub_u32 s56, s57, 1280
    s_min_u32 s57, s57, s56
    buffer_load_dwordx4 v2, s[4:7], s57 offen offset:0 lds
    v_mul_u32_u24 v166, 1120, v166
    v_add3_u32 v33, v166, v1, s47
    v_add_u32 v165, 256, v0
    v_mfma_f32_16x16x32_bf16 v[116:119], v[180:183], v[80:83], v[116:119]
    buffer_load_dwordx4 v3, s[4:7], s57 offen offset:1024 lds
    v_mul_u32_u24 v166, 205, v165
    v_lshrrev_b32 v166, 11, v166
    v_mul_u32_u24 v166, 1120, v166
    v_mfma_f32_16x16x32_bf16 v[120:123], v[176:179], v[84:87], v[120:123]
    buffer_load_dwordx4 v4, s[4:7], s57 offen offset:2048 lds
    v_add3_u32 v34, v166, v1, s47
    v_add_u32 v34, 1024, v34
    s_mul_i32 s71, s36, 5120
    v_mfma_f32_16x16x32_bf16 v[124:127], v[180:183], v[84:87], v[124:127]
    s_nop 0
    s_cbranch_execz L_pfret
    buffer_load_dwordx4 v5, s[4:7], s57 offen offset:3072 lds
    s_and_b32 s46, s36, 3
    s_mul_i32 s101, s46, 5120
    s_add_u32 s101, s101, 61440
    s_waitcnt lgkmcnt(9)
    v_mfma_f32_16x16x32_bf16 v[88:91], v[40:43], v[48:51], v[88:91]
    ds_read_b128 v[184:187], v9 offset:4096
    ds_read_b64_tr_b16 v[68:69], v22 offset:55296
    s_waitcnt lgkmcnt(10)
    v_mfma_f32_16x16x32_bf16 v[92:95], v[44:47], v[48:51], v[92:95]
    ds_read_b64_tr_b16 v[70:71], v22 offset:56576
    ds_read_b128 v[188:191], v9 offset:6144
    s_mul_i32 s47, s72, 5
    s_add_u32 s46, s46, s47
    s_mul_i32 s77, s46, 40960
    s_waitcnt lgkmcnt(10)
    v_mfma_f32_16x16x32_bf16 v[96:99], v[40:43], v[52:55], v[96:99]
    ds_read_b64_tr_b16 v[72:73], v22 offset:55336
    ds_read_b64_tr_b16 v[74:75], v22 offset:56616
    s_cmp_eq_u32 s41, 0
    s_cselect_b32 s58, -1, 0
    s_cselect_b32 s59, 0, -1
    s_not_b64 s[60:61], s[58:59]
    s_mov_b32 s62, 0x000fffff
    v_mfma_f32_16x16x32_bf16 v[100:103], v[44:47], v[52:55], v[100:103]
    ds_read_b64_tr_b16 v[76:77], v22 offset:55376
    ds_read_b64_tr_b16 v[78:79], v22 offset:56656
    s_mov_b32 s63, 0x000fffff
    v_bfe_u32 v165, v0, 2, 2
    v_and_b32 v166, 3, v0
    s_waitcnt lgkmcnt(12)
    v_mfma_f32_16x16x32_bf16 v[104:107], v[40:43], v[56:59], v[104:107]
    ds_read_b64_tr_b16 v[80:81], v22 offset:55416
    ds_read_b64_tr_b16 v[82:83], v22 offset:56696
    v_lshl_add_u32 v167, v164, 2, v165
    v_mad_u32_u24 v167, v162, 20, v167
    v_mul_u32_u24 v167, 160, v167
    s_nop 0
    s_cbranch_execz L_pfret
    v_mfma_f32_16x16x32_bf16 v[108:111], v[44:47], v[56:59], v[108:111]
    ds_read_b64_tr_b16 v[84:85], v23 offset:55296
    ds_read_b64_tr_b16 v[86:87], v23 offset:56576
    v_lshl_add_u32 v167, v166, 3, v167
    v_add_u32 v35, 61440, v167
    v_add_u32 v36, 112640, v167
    s_waitcnt lgkmcnt(14)
    v_mfma_f32_16x16x32_bf16 v[112:115], v[40:43], v[60:63], v[112:115]
    s_add_u32 s56, s0, 1966080
    s_sub_u32 s57, s56, 2457600
    s_min_u32 s56, s56, s57
    buffer_load_dword v145, v133, s[8:11], s56 offen offset:1280
    v_mad_u32_u24 v167, v159, 40, v165
    v_mul_u32_u24 v167, 160, v167
    v_lshl_add_u32 v167, v166, 3, v167
    v_mfma_f32_16x16x32_bf16 v[116:119], v[44:47], v[60:63], v[116:119]
    s_add_u32 s56, s1, 1024
    s_sub_u32 s57, s56, 1280
    s_min_u32 s56, s56, s57
    buffer_load_dword v144, v132, s[4:7], s56 offen offset:0
    v_add_u32 v37, 64000, v167
    v_add_u32 v38, 115200, v167
    s_lshl_b32 s46, s38, 2
    s_waitcnt lgkmcnt(12)
    v_mfma_f32_16x16x32_bf16 v[120:123], v[40:43], v[64:67], v[120:123]
    s_add_u32 s47, s46, s40
    s_min_u32 s67, s47, 8
    s_add_u32 s46, s46, s36
    v_mfma_f32_16x16x32_bf16 v[124:127], v[44:47], v[64:67], v[124:127]
    s_cmp_lt_u32 s46, 8
    s_cselect_b32 s70, 1, 0
    s_cmp_eq_u32 s37, 0
    s_cselect_b32 s70, 1, s70
    s_mov_b32 s98, 1051011932
    s_waitcnt vmcnt(8) lgkmcnt(0)
    s_barrier
    v_mfma_f32_16x16x32_bf16 v[88:91], v[184:187], v[68:71], v[88:91]
    ds_read_b128 v[40:43], v6 offset:20480
    s_nop 0
    s_cbranch_execz L_pfret
    ds_read_b64_tr_b16 v[48:49], v14 offset:0
    v_mfma_f32_16x16x32_bf16 v[92:95], v[188:191], v[68:71], v[92:95]
    ds_read_b64_tr_b16 v[50:51], v14 offset:1280
    ds_read_b128 v[44:47], v6 offset:22528
    s_mov_b32 s99, s98
    s_sub_u32 s46, s46, 8
    s_mul_i32 s46, s46, 10240
    v_mfma_f32_16x16x32_bf16 v[96:99], v[184:187], v[72:75], v[96:99]
    ds_read_b64_tr_b16 v[52:53], v14 offset:40
    ds_read_b64_tr_b16 v[54:55], v14 offset:1320
    s_mul_i32 s47, s39, 655360
    s_add_u32 s68, s46, s47
    s_lshl_b32 s46, s41, 13
    v_mfma_f32_16x16x32_bf16 v[100:103], v[188:191], v[72:75], v[100:103]
    ds_read_b64_tr_b16 v[56:57], v14 offset:80
    ds_read_b64_tr_b16 v[58:59], v14 offset:1360
    s_and_b32 s47, s36, 3
    s_lshl_b32 s47, s47, 7
    s_add_u32 s46, s46, s47
    v_mfma_f32_16x16x32_bf16 v[104:107], v[184:187], v[76:79], v[104:107]
    ds_read_b64_tr_b16 v[60:61], v14 offset:120
    ds_read_b64_tr_b16 v[62:63], v14 offset:1400
    s_add_u32 s46, s46, s64
    s_sub_u32 s69, s46, 15872
    s_mov_b32 s100, 0xf0000000
    v_mfma_f32_16x16x32_bf16 v[108:111], v[188:191], v[76:79], v[108:111]
    ds_read_b64_tr_b16 v[64:65], v15 offset:0
    ds_read_b64_tr_b16 v[66:67], v15 offset:1280
    s_mov_b32 s18, 819200
    s_mov_b32 s19, 0x00020000
    s_mov_b32 s22, 5242880
    v_mfma_f32_16x16x32_bf16 v[112:115], v[184:187], v[80:83], v[112:115]
    s_add_u32 m0, s43, 53248
    s_add_u32 s57, s1, 640
    s_sub_u32 s56, s57, 1280
    s_min_u32 s57, s57, s56
    s_cbranch_execz L_pfret
    buffer_load_dwordx4 v2, s[4:7], s57 offen offset:0 lds
    s_mov_b32 s23, 0x00020000
    s_mov_b32 s30, 25600
    s_mov_b32 s31, 0x00020000
    v_mfma_f32_16x16x32_bf16 v[116:119], v[188:191], v[80:83], v[116:119]
    buffer_load_dwordx4 v3, s[4:7], s57 offen offset:1024 lds
    s_and_b32 s17, s17, 0xffff
    s_and_b32 s21, s21, 0xffff
    s_and_b32 s29, s29, 0xffff
    v_mfma_f32_16x16x32_bf16 v[120:123], v[184:187], v[84:87], v[120:123]
    buffer_load_dwordx4 v4, s[4:7], s57 offen offset:2048 lds
    s_lshl_b32 s46, s39, 4
    s_add_u32 s46, s46, s38
    s_mul_i32 s46, s46, 40960
    v_mfma_f32_16x16x32_bf16 v[124:127], v[188:191], v[84:87], v[124:127]
    buffer_load_dwordx4 v5, s[4:7], s57 offen offset:3072 lds
    s_mul_i32 s47, s40, 10240
    s_add_u32 s46, s46, s47
    s_mul_i32 s47, s41, 5120
    s_waitcnt lgkmcnt(9)
    v_mfma_f32_16x16x32_bf16 v[88:91], v[40:43], v[48:51], v[88:91]
    ds_read_b128 v[192:195], v7 offset:20480
    ds_read_b64_tr_b16 v[68:69], v14 offset:10240
    s_waitcnt lgkmcnt(10)
    v_mfma_f32_16x16x32_bf16 v[92:95], v[44:47], v[48:51], v[92:95]
    ds_read_b64_tr_b16 v[70:71], v14 offset:11520
    ds_read_b128 v[196:199], v7 offset:22528
    s_add_u32 s65, s46, s47
    s_mul_i32 s49, s39, 160
    s_and_b32 s48, s36, 1
    s_waitcnt lgkmcnt(10)
    v_mfma_f32_16x16x32_bf16 v[96:99], v[40:43], v[52:55], v[96:99]
    ds_read_b64_tr_b16 v[72:73], v14 offset:10280
    ds_read_b64_tr_b16 v[74:75], v14 offset:11560
    v_mul_u32_u24 v158, 205, v0
    v_lshrrev_b32 v158, 12, v158
    s_cbranch_execz L_pfret
    v_mul_u32_u24 v160, 20, v158
    v_mfma_f32_16x16x32_bf16 v[100:103], v[44:47], v[52:55], v[100:103]
    ds_read_b64_tr_b16 v[76:77], v14 offset:10320
    ds_read_b64_tr_b16 v[78:79], v14 offset:11600
    v_sub_u32 v160, v0, v160
    v_mul_u32_u24 v161, 3840, v158
    v_lshl_add_u32 v249, v160, 4, v161
    s_waitcnt lgkmcnt(12)
    v_mfma_f32_16x16x32_bf16 v[104:107], v[40:43], v[56:59], v[104:107]
    ds_read_b64_tr_b16 v[80:81], v14 offset:10360
    ds_read_b64_tr_b16 v[82:83], v14 offset:11640
    v_mul_u32_u24 v160, 26, v160
    v_lshrrev_b32 v160, 8, v160
    v_mul_u32_u24 v161, 160, v160
    v_mfma_f32_16x16x32_bf16 v[108:111], v[44:47], v[56:59], v[108:111]
    ds_read_b64_tr_b16 v[84:85], v15 offset:10240
    ds_read_b64_tr_b16 v[86:87], v15 offset:11520
    v_sub_u32 v249, v249, v161
    v_xor_b32 v160, s48, v160
    v_mul_u32_u24 v160, 122880, v160
    s_waitcnt lgkmcnt(14)
    v_mfma_f32_16x16x32_bf16 v[112:115], v[40:43], v[60:63], v[112:115]
    s_and_b32 s56, s2, 0xf8
    s_add_u32 s56, s56, s36
    s_mul_i32 s56, s56, 3840
    s_add_u32 s56, s56, s0
    s_add_u32 s56, s56, 0
    s_sub_u32 s57, s56, 2457600
    s_min_u32 s56, s56, s57
    buffer_load_dword v146, v134, s[8:11], s56 offen offset:0
    v_add3_u32 v249, v249, v160, s49
    v_add_u32 v161, 64, v0
    v_mul_u32_u24 v158, 205, v161
    v_mfma_f32_16x16x32_bf16 v[116:119], v[44:47], v[60:63], v[116:119]
    v_lshrrev_b32 v158, 12, v158
    v_mul_u32_u24 v160, 20, v158
    v_sub_u32 v160, v161, v160
    s_waitcnt lgkmcnt(12)
    v_mfma_f32_16x16x32_bf16 v[120:123], v[40:43], v[64:67], v[120:123]
    v_mul_u32_u24 v161, 3840, v158
    s_cbranch_execz L_pfret
    v_lshl_add_u32 v250, v160, 4, v161
    v_mul_u32_u24 v160, 26, v160
    v_mfma_f32_16x16x32_bf16 v[124:127], v[44:47], v[64:67], v[124:127]
    v_lshrrev_b32 v160, 8, v160
    v_mul_u32_u24 v161, 160, v160
    v_sub_u32 v250, v250, v161
    s_waitcnt vmcnt(7) lgkmcnt(0)
    s_barrier
    v_mfma_f32_16x16x32_bf16 v[88:91], v[192:195], v[68:71], v[88:91]
    ds_read_b128 v[40:43], v6 offset:36864
    ds_read_b64_tr_b16 v[48:49], v22 offset:24576
    v_mfma_f32_16x16x32_bf16 v[92:95], v[196:199], v[68:71], v[92:95]
    ds_read_b64_tr_b16 v[50:51], v22 offset:25856
    ds_read_b128 v[44:47], v6 offset:38912
    v_xor_b32 v160, s48, v160
    v_mul_u32_u24 v160, 122880, v160
    v_add_u32 v160, -1024, v160
    v_mfma_f32_16x16x32_bf16 v[96:99], v[192:195], v[72:75], v[96:99]
    ds_read_b64_tr_b16 v[52:53], v22 offset:24616
    ds_read_b64_tr_b16 v[54:55], v22 offset:25896
    v_add3_u32 v250, v250, v160, s49
    v_add_u32 v161, 128, v0
    v_mul_u32_u24 v158, 205, v161
    v_mfma_f32_16x16x32_bf16 v[100:103], v[196:199], v[72:75], v[100:103]
    ds_read_b64_tr_b16 v[56:57], v22 offset:24656
    ds_read_b64_tr_b16 v[58:59], v22 offset:25936
    v_lshrrev_b32 v158, 12, v158
    v_mul_u32_u24 v160, 20, v158
    v_sub_u32 v160, v161, v160
    v_mfma_f32_16x16x32_bf16 v[104:107], v[192:195], v[76:79], v[104:107]
    ds_read_b64_tr_b16 v[60:61], v22 offset:24696
    ds_read_b64_tr_b16 v[62:63], v22 offset:25976
    v_mul_u32_u24 v161, 3840, v158
    v_lshl_add_u32 v251, v160, 4, v161
    v_mul_u32_u24 v160, 26, v160
    v_mfma_f32_16x16x32_bf16 v[108:111], v[196:199], v[76:79], v[108:111]
    s_nop 0
    s_cbranch_execz L_pfret
    ds_read_b64_tr_b16 v[64:65], v23 offset:24576
    ds_read_b64_tr_b16 v[66:67], v23 offset:25856
    v_lshrrev_b32 v160, 8, v160
    v_mul_u32_u24 v161, 160, v160
    v_sub_u32 v251, v251, v161
    v_mfma_f32_16x16x32_bf16 v[112:115], v[192:195], v[80:83], v[112:115]
    s_add_u32 m0, s43, 20480
    s_add_u32 s57, s1, 768
    s_sub_u32 s56, s57, 1280
    s_min_u32 s57, s57, s56
    buffer_load_dwordx4 v2, s[4:7], s57 offen offset:0 lds
    v_xor_b32 v160, s48, v160
    v_mul_u32_u24 v160, 122880, v160
    v_add_u32 v160, -2048, v160
    v_mfma_f32_16x16x32_bf16 v[116:119], v[196:199], v[80:83], v[116:119]
    buffer_load_dwordx4 v3, s[4:7], s57 offen offset:1024 lds
    v_add3_u32 v251, v251, v160, s49
    s_lshl_b32 s52, s39, 4
    s_add_u32 s52, s52, s38
    v_mfma_f32_16x16x32_bf16 v[120:123], v[192:195], v[84:87], v[120:123]
    buffer_load_dwordx4 v4, s[4:7], s57 offen offset:2048 lds
    s_lshl_b32 s52, s52, 3
    s_add_u32 s52, s52, s36
    s_lshl_b32 s52, s52, 10
    v_mfma_f32_16x16x32_bf16 v[124:127], v[196:199], v[84:87], v[124:127]
    buffer_load_dwordx4 v5, s[4:7], s57 offen offset:3072 lds
    s_add_u32 s52, s52, 12582912
    s_cmp_lg_u32 s37, 0
    s_cselect_b64 vcc, -1, 0
    s_waitcnt lgkmcnt(9)
    v_mfma_f32_16x16x32_bf16 v[88:91], v[40:43], v[48:51], v[88:91]
    ds_read_b128 v[200:203], v7 offset:36864
    ds_read_b64_tr_b16 v[68:69], v22 offset:34816
    s_waitcnt lgkmcnt(10)
    v_mfma_f32_16x16x32_bf16 v[92:95], v[44:47], v[48:51], v[92:95]
    ds_read_b64_tr_b16 v[70:71], v22 offset:36096
    ds_read_b128 v[204:207], v7 offset:38912
    s_waitcnt lgkmcnt(10)
    s_nop 0
    s_cbranch_execz L_pfret
    v_mfma_f32_16x16x32_bf16 v[96:99], v[40:43], v[52:55], v[96:99]
    ds_read_b64_tr_b16 v[72:73], v22 offset:34856
    ds_read_b64_tr_b16 v[74:75], v22 offset:36136
    v_mfma_f32_16x16x32_bf16 v[100:103], v[44:47], v[52:55], v[100:103]
    ds_read_b64_tr_b16 v[76:77], v22 offset:34896
    ds_read_b64_tr_b16 v[78:79], v22 offset:36176
    s_waitcnt lgkmcnt(12)
    v_mfma_f32_16x16x32_bf16 v[104:107], v[40:43], v[56:59], v[104:107]
    ds_read_b64_tr_b16 v[80:81], v22 offset:34936
    ds_read_b64_tr_b16 v[82:83], v22 offset:36216
    v_mfma_f32_16x16x32_bf16 v[108:111], v[44:47], v[56:59], v[108:111]
    ds_read_b64_tr_b16 v[84:85], v23 offset:34816
    ds_read_b64_tr_b16 v[86:87], v23 offset:36096
    s_waitcnt lgkmcnt(14)
    v_mfma_f32_16x16x32_bf16 v[112:115], v[40:43], v[60:63], v[112:115]
    s_and_b32 s56, s2, 0xf8
    s_add_u32 s56, s56, s36
    s_mul_i32 s56, s56, 3840
    s_add_u32 s56, s56, s0
    s_add_u32 s56, s56, 983040
    s_sub_u32 s57, s56, 2457600
    s_min_u32 s56, s56, s57
    buffer_load_dword v148, v134, s[8:11], s56 offen offset:0
    v_mfma_f32_16x16x32_bf16 v[116:119], v[44:47], v[60:63], v[116:119]
    s_waitcnt lgkmcnt(12)
    v_mfma_f32_16x16x32_bf16 v[120:123], v[40:43], v[64:67], v[120:123]
    v_mfma_f32_16x16x32_bf16 v[124:127], v[44:47], v[64:67], v[124:127]
    s_waitcnt vmcnt(6) lgkmcnt(0)
    s_barrier
    v_mfma_f32_16x16x32_bf16 v[88:91], v[200:203], v[68:71], v[88:91]
    ds_read_b128 v[40:43], v8 offset:4096
    ds_read_b64_tr_b16 v[48:49], v22 offset:45056
    v_mfma_f32_16x16x32_bf16 v[92:95], v[204:207], v[68:71], v[92:95]
    ds_read_b64_tr_b16 v[50:51], v22 offset:46336
    ds_read_b128 v[44:47], v8 offset:6144
    s_nop 0
    s_cbranch_execz L_pfret
    v_mfma_f32_16x16x32_bf16 v[96:99], v[200:203], v[72:75], v[96:99]
    ds_read_b64_tr_b16 v[52:53], v22 offset:45096
    ds_read_b64_tr_b16 v[54:55], v22 offset:46376
    v_mfma_f32_16x16x32_bf16 v[100:103], v[204:207], v[72:75], v[100:103]
    ds_read_b64_tr_b16 v[56:57], v22 offset:45136
    ds_read_b64_tr_b16 v[58:59], v22 offset:46416
    v_mfma_f32_16x16x32_bf16 v[104:107], v[200:203], v[76:79], v[104:107]
    ds_read_b64_tr_b16 v[60:61], v22 offset:45176
    ds_read_b64_tr_b16 v[62:63], v22 offset:46456
    v_mfma_f32_16x16x32_bf16 v[108:111], v[204:207], v[76:79], v[108:111]
    ds_read_b64_tr_b16 v[64:65], v23 offset:45056
    ds_read_b64_tr_b16 v[66:67], v23 offset:46336
    v_mfma_f32_16x16x32_bf16 v[112:115], v[200:203], v[80:83], v[112:115]
    s_add_u32 m0, s43, 36864
    s_add_u32 s57, s1, 896
    s_sub_u32 s56, s57, 1280
    s_min_u32 s57, s57, s56
    buffer_load_dwordx4 v2, s[4:7], s57 offen offset:0 lds
    v_mfma_f32_16x16x32_bf16 v[116:119], v[204:207], v[80:83], v[116:119]
    buffer_load_dwordx4 v3, s[4:7], s57 offen offset:1024 lds
    v_mfma_f32_16x16x32_bf16 v[120:123], v[200:203], v[84:87], v[120:123]
    buffer_load_dwordx4 v4, s[4:7], s57 offen offset:2048 lds
    v_mfma_f32_16x16x32_bf16 v[124:127], v[204:207], v[84:87], v[124:127]
    buffer_load_dwordx4 v5, s[4:7], s57 offen offset:3072 lds
    s_waitcnt lgkmcnt(9)
    v_mfma_f32_16x16x32_bf16 v[88:91], v[40:43], v[48:51], v[88:91]
    ds_read_b128 v[208:211], v9 offset:4096
    ds_read_b64_tr_b16 v[68:69], v22 offset:55296
    s_waitcnt lgkmcnt(10)
    v_mfma_f32_16x16x32_bf16 v[92:95], v[44:47], v[48:51], v[92:95]
    ds_read_b64_tr_b16 v[70:71], v22 offset:56576
    ds_read_b128 v[212:215], v9 offset:6144
    s_waitcnt lgkmcnt(10)
    s_nop 0
    s_cbranch_execz L_pfret
    v_mfma_f32_16x16x32_bf16 v[96:99], v[40:43], v[52:55], v[96:99]
    ds_read_b64_tr_b16 v[72:73], v22 offset:55336
    ds_read_b64_tr_b16 v[74:75], v22 offset:56616
    v_mfma_f32_16x16x32_bf16 v[100:103], v[44:47], v[52:55], v[100:103]
    ds_read_b64_tr_b16 v[76:77], v22 offset:55376
    ds_read_b64_tr_b16 v[78:79], v22 offset:56656
    s_waitcnt lgkmcnt(12)
    v_mfma_f32_16x16x32_bf16 v[104:107], v[40:43], v[56:59], v[104:107]
    ds_read_b64_tr_b16 v[80:81], v22 offset:55416
    ds_read_b64_tr_b16 v[82:83], v22 offset:56696
    v_mfma_f32_16x16x32_bf16 v[108:111], v[44:47], v[56:59], v[108:111]
    ds_read_b64_tr_b16 v[84:85], v23 offset:55296
    ds_read_b64_tr_b16 v[86:87], v23 offset:56576
    s_waitcnt lgkmcnt(14)
    v_mfma_f32_16x16x32_bf16 v[112:115], v[40:43], v[60:63], v[112:115]
    s_and_b32 s56, s2, 0xf8
    s_add_u32 s56, s56, s36
    s_mul_i32 s56, s56, 3840
    s_add_u32 s56, s56, s0
    s_add_u32 s56, s56, 1966080
    s_sub_u32 s57, s56, 2457600
    s_min_u32 s56, s56, s57
    buffer_load_dword v150, v134, s[8:11], s56 offen offset:0
    v_mfma_f32_16x16x32_bf16 v[116:119], v[44:47], v[60:63], v[116:119]
    s_waitcnt lgkmcnt(12)
    v_mfma_f32_16x16x32_bf16 v[120:123], v[40:43], v[64:67], v[120:123]
    v_mfma_f32_16x16x32_bf16 v[124:127], v[44:47], v[64:67], v[124:127]
    s_waitcnt vmcnt(6) lgkmcnt(0)
    s_barrier
    v_mfma_f32_16x16x32_bf16 v[88:91], v[208:211], v[68:71], v[88:91]
    ds_read_b128 v[40:43], v6 offset:20480
    ds_read_b64_tr_b16 v[48:49], v14 offset:0
    v_mfma_f32_16x16x32_bf16 v[92:95], v[212:215], v[68:71], v[92:95]
    ds_read_b64_tr_b16 v[50:51], v14 offset:1280
    ds_read_b128 v[44:47], v6 offset:22528
    s_nop 0
    s_cbranch_execz L_pfret
    v_mfma_f32_16x16x32_bf16 v[96:99], v[208:211], v[72:75], v[96:99]
    ds_read_b64_tr_b16 v[52:53], v14 offset:40
    ds_read_b64_tr_b16 v[54:55], v14 offset:1320
    v_mfma_f32_16x16x32_bf16 v[100:103], v[212:215], v[72:75], v[100:103]
    ds_read_b64_tr_b16 v[56:57], v14 offset:80
    ds_read_b64_tr_b16 v[58:59], v14 offset:1360
    v_mfma_f32_16x16x32_bf16 v[104:107], v[208:211], v[76:79], v[104:107]
    ds_read_b64_tr_b16 v[60:61], v14 offset:120
    ds_read_b64_tr_b16 v[62:63], v14 offset:1400
    v_mfma_f32_16x16x32_bf16 v[108:111], v[212:215], v[76:79], v[108:111]
    ds_read_b64_tr_b16 v[64:65], v15 offset:0
    ds_read_b64_tr_b16 v[66:67], v15 offset:1280
    v_mfma_f32_16x16x32_bf16 v[112:115], v[208:211], v[80:83], v[112:115]
    s_add_u32 m0, s43, 53248
    s_add_u32 s57, s1, 1024
    s_sub_u32 s56, s57, 1280
    s_min_u32 s57, s57, s56
    buffer_load_dwordx4 v2, s[4:7], s57 offen offset:0 lds
    v_mfma_f32_16x16x32_bf16 v[116:119], v[212:215], v[80:83], v[116:119]
    buffer_load_dwordx4 v3, s[4:7], s57 offen offset:1024 lds
    v_mfma_f32_16x16x32_bf16 v[120:123], v[208:211], v[84:87], v[120:123]
    buffer_load_dwordx4 v4, s[4:7], s57 offen offset:2048 lds
    v_mfma_f32_16x16x32_bf16 v[124:127], v[212:215], v[84:87], v[124:127]
    buffer_load_dwordx4 v5, s[4:7], s57 offen offset:3072 lds
    s_waitcnt lgkmcnt(9)
    v_mfma_f32_16x16x32_bf16 v[88:91], v[40:43], v[48:51], v[88:91]
    ds_read_b128 v[216:219], v7 offset:20480
    ds_read_b64_tr_b16 v[68:69], v14 offset:10240
    s_waitcnt lgkmcnt(10)
    v_mfma_f32_16x16x32_bf16 v[92:95], v[44:47], v[48:51], v[92:95]
    ds_read_b64_tr_b16 v[70:71], v14 offset:11520
    ds_read_b128 v[220:223], v7 offset:22528
    s_waitcnt lgkmcnt(10)
    s_nop 0
    s_cbranch_execz L_pfret
    v_mfma_f32_16x16x32_bf16 v[96:99], v[40:43], v[52:55], v[96:99]
    ds_read_b64_tr_b16 v[72:73], v14 offset:10280
    ds_read_b64_tr_b16 v[74:75], v14 offset:11560
    v_mfma_f32_16x16x32_bf16 v[100:103], v[44:47], v[52:55], v[100:103]
    ds_read_b64_tr_b16 v[76:77], v14 offset:10320
    ds_read_b64_tr_b16 v[78:79], v14 offset:11600
    s_waitcnt lgkmcnt(12)
    v_mfma_f32_16x16x32_bf16 v[104:107], v[40:43], v[56:59], v[104:107]
    ds_read_b64_tr_b16 v[80:81], v14 offset:10360
    ds_read_b64_tr_b16 v[82:83], v14 offset:11640
    v_mfma_f32_16x16x32_bf16 v[108:111], v[44:47], v[56:59], v[108:111]
    ds_read_b64_tr_b16 v[84:85], v15 offset:10240
    ds_read_b64_tr_b16 v[86:87], v15 offset:11520
    s_waitcnt lgkmcnt(14)
    v_mfma_f32_16x16x32_bf16 v[112:115], v[40:43], v[60:63], v[112:115]
    s_lshl_b32 s48, s37, 7
    v_and_b32 v39, 15, v0
    v_lshlrev_b32 v39, 2, v39
    buffer_load_dword v39, v39, s[24:27], s48 offen sc1
    v_mfma_f32_16x16x32_bf16 v[116:119], v[44:47], v[60:63], v[116:119]
    s_waitcnt lgkmcnt(12)
    v_mfma_f32_16x16x32_bf16 v[120:123], v[40:43], v[64:67], v[120:123]
    v_mfma_f32_16x16x32_bf16 v[124:127], v[44:47], v[64:67], v[124:127]
    s_waitcnt vmcnt(6) lgkmcnt(0)
    s_barrier
    v_mfma_f32_16x16x32_bf16 v[88:91], v[216:219], v[68:71], v[88:91]
    ds_read_b128 v[40:43], v6 offset:36864
    ds_read_b64_tr_b16 v[48:49], v22 offset:24576
    v_mfma_f32_16x16x32_bf16 v[92:95], v[220:223], v[68:71], v[92:95]
    ds_read_b64_tr_b16 v[50:51], v22 offset:25856
    ds_read_b128 v[44:47], v6 offset:38912
    v_mfma_f32_16x16x32_bf16 v[96:99], v[216:219], v[72:75], v[96:99]
    ds_read_b64_tr_b16 v[52:53], v22 offset:24616
    ds_read_b64_tr_b16 v[54:55], v22 offset:25896
    v_mfma_f32_16x16x32_bf16 v[100:103], v[220:223], v[72:75], v[100:103]
    s_nop 0
    s_cbranch_execz L_pfret
    ds_read_b64_tr_b16 v[56:57], v22 offset:24656
    ds_read_b64_tr_b16 v[58:59], v22 offset:25936
    v_mfma_f32_16x16x32_bf16 v[104:107], v[216:219], v[76:79], v[104:107]
    ds_read_b64_tr_b16 v[60:61], v22 offset:24696
    ds_read_b64_tr_b16 v[62:63], v22 offset:25976
    v_mfma_f32_16x16x32_bf16 v[108:111], v[220:223], v[76:79], v[108:111]
    ds_read_b64_tr_b16 v[64:65], v23 offset:24576
    ds_read_b64_tr_b16 v[66:67], v23 offset:25856
    v_mfma_f32_16x16x32_bf16 v[112:115], v[216:219], v[80:83], v[112:115]
    s_add_u32 m0, s43, 20480
    s_add_u32 s57, s1, 1152
    s_sub_u32 s56, s57, 1280
    s_min_u32 s57, s57, s56
    buffer_load_dwordx4 v2, s[4:7], s57 offen offset:0 lds
    v_mfma_f32_16x16x32_bf16 v[116:119], v[220:223], v[80:83], v[116:119]
    buffer_load_dwordx4 v3, s[4:7], s57 offen offset:1024 lds
    v_mfma_f32_16x16x32_bf16 v[120:123], v[216:219], v[84:87], v[120:123]
    buffer_load_dwordx4 v4, s[4:7], s57 offen offset:2048 lds
    v_mfma_f32_16x16x32_bf16 v[124:127], v[220:223], v[84:87], v[124:127]
    buffer_load_dwordx4 v5, s[4:7], s57 offen offset:3072 lds
    s_waitcnt lgkmcnt(9)
    v_mfma_f32_16x16x32_bf16 v[88:91], v[40:43], v[48:51], v[88:91]
    ds_read_b128 v[224:227], v7 offset:36864
    ds_read_b64_tr_b16 v[68:69], v22 offset:34816
    s_waitcnt lgkmcnt(10)
    v_mfma_f32_16x16x32_bf16 v[92:95], v[44:47], v[48:51], v[92:95]
    ds_read_b64_tr_b16 v[70:71], v22 offset:36096
    ds_read_b128 v[228:231], v7 offset:38912
    s_waitcnt lgkmcnt(10)
    v_mfma_f32_16x16x32_bf16 v[96:99], v[40:43], v[52:55], v[96:99]
    ds_read_b64_tr_b16 v[72:73], v22 offset:34856
    ds_read_b64_tr_b16 v[74:75], v22 offset:36136
    v_mfma_f32_16x16x32_bf16 v[100:103], v[44:47], v[52:55], v[100:103]
    s_nop 0
    s_cbranch_execz L_pfret
    ds_read_b64_tr_b16 v[76:77], v22 offset:34896
    ds_read_b64_tr_b16 v[78:79], v22 offset:36176
    s_waitcnt lgkmcnt(12)
    v_mfma_f32_16x16x32_bf16 v[104:107], v[40:43], v[56:59], v[104:107]
    ds_read_b64_tr_b16 v[80:81], v22 offset:34936
    ds_read_b64_tr_b16 v[82:83], v22 offset:36216
    v_mfma_f32_16x16x32_bf16 v[108:111], v[44:47], v[56:59], v[108:111]
    ds_read_b64_tr_b16 v[84:85], v23 offset:34816
    ds_read_b64_tr_b16 v[86:87], v23 offset:36096
    s_waitcnt lgkmcnt(14)
    v_mfma_f32_16x16x32_bf16 v[112:115], v[40:43], v[60:63], v[112:115]
    s_mov_b32 s56, 0
    buffer_load_dword v152, v135, s[16:19], s56 offen offset:0
    v_mfma_f32_16x16x32_bf16 v[116:119], v[44:47], v[60:63], v[116:119]
    s_mov_b32 s56, 327680
    buffer_load_dword v154, v135, s[16:19], s56 offen offset:0
    s_waitcnt lgkmcnt(12)
    v_mfma_f32_16x16x32_bf16 v[120:123], v[40:43], v[64:67], v[120:123]
    s_mov_b32 s56, 655360
    buffer_load_dword v156, v135, s[16:19], s56 offen offset:0
    v_mfma_f32_16x16x32_bf16 v[124:127], v[44:47], v[64:67], v[124:127]
    s_waitcnt vmcnt(8) lgkmcnt(0)
    s_barrier
    v_mfma_f32_16x16x32_bf16 v[88:91], v[224:227], v[68:71], v[88:91]
    ds_read_b128 v[40:43], v8 offset:4096
    ds_read_b64_tr_b16 v[48:49], v22 offset:45056
    v_mfma_f32_16x16x32_bf16 v[92:95], v[228:231], v[68:71], v[92:95]
    ds_read_b64_tr_b16 v[50:51], v22 offset:46336
    ds_read_b128 v[44:47], v8 offset:6144
    v_mfma_f32_16x16x32_bf16 v[96:99], v[224:227], v[72:75], v[96:99]
    ds_read_b64_tr_b16 v[52:53], v22 offset:45096
    ds_read_b64_tr_b16 v[54:55], v22 offset:46376
    v_mfma_f32_16x16x32_bf16 v[100:103], v[228:231], v[72:75], v[100:103]
    ds_read_b64_tr_b16 v[56:57], v22 offset:45136
    s_nop 0
    s_cbranch_execz L_pfret
    ds_read_b64_tr_b16 v[58:59], v22 offset:46416
    v_mfma_f32_16x16x32_bf16 v[104:107], v[224:227], v[76:79], v[104:107]
    ds_read_b64_tr_b16 v[60:61], v22 offset:45176
    ds_read_b64_tr_b16 v[62:63], v22 offset:46456
    v_mfma_f32_16x16x32_bf16 v[108:111], v[228:231], v[76:79], v[108:111]
    ds_read_b64_tr_b16 v[64:65], v23 offset:45056
    ds_read_b64_tr_b16 v[66:67], v23 offset:46336
    v_mfma_f32_16x16x32_bf16 v[112:115], v[224:227], v[80:83], v[112:115]
    s_add_u32 m0, s44, 133120
    s_add_u32 s57, s76, 245760
    buffer_load_dwordx4 v249, s[8:11], s57 offen offset:0 lds
    v_mfma_f32_16x16x32_bf16 v[116:119], v[228:231], v[80:83], v[116:119]
    buffer_load_dwordx4 v250, s[8:11], s57 offen offset:1024 lds
    v_mfma_f32_16x16x32_bf16 v[120:123], v[224:227], v[84:87], v[120:123]
    s_mov_b64 exec, 0xffffffff
    buffer_load_dwordx4 v251, s[8:11], s57 offen offset:2048 lds
    s_mov_b64 exec, -1
    v_mfma_f32_16x16x32_bf16 v[124:127], v[228:231], v[84:87], v[124:127]
    s_waitcnt lgkmcnt(9)
    v_mfma_f32_16x16x32_bf16 v[88:91], v[40:43], v[48:51], v[88:91]
    ds_read_b128 v[232:235], v9 offset:4096
    ds_read_b64_tr_b16 v[68:69], v22 offset:55296
    s_waitcnt lgkmcnt(10)
    v_mfma_f32_16x16x32_bf16 v[92:95], v[44:47], v[48:51], v[92:95]
    ds_read_b64_tr_b16 v[70:71], v22 offset:56576
    ds_read_b128 v[236:239], v9 offset:6144
    s_waitcnt lgkmcnt(10)
    v_mfma_f32_16x16x32_bf16 v[96:99], v[40:43], v[52:55], v[96:99]
    ds_read_b64_tr_b16 v[72:73], v22 offset:55336
    ds_read_b64_tr_b16 v[74:75], v22 offset:56616
    v_mfma_f32_16x16x32_bf16 v[100:103], v[44:47], v[52:55], v[100:103]
    ds_read_b64_tr_b16 v[76:77], v22 offset:55376
    ds_read_b64_tr_b16 v[78:79], v22 offset:56656
    s_waitcnt lgkmcnt(12)
    s_cbranch_execz L_pfret
    v_mfma_f32_16x16x32_bf16 v[104:107], v[40:43], v[56:59], v[104:107]
    ds_read_b64_tr_b16 v[80:81], v22 offset:55416
    ds_read_b64_tr_b16 v[82:83], v22 offset:56696
    v_mfma_f32_16x16x32_bf16 v[108:111], v[44:47], v[56:59], v[108:111]
    ds_read_b64_tr_b16 v[84:85], v23 offset:55296
    ds_read_b64_tr_b16 v[86:87], v23 offset:56576
    s_waitcnt lgkmcnt(14)
    v_mfma_f32_16x16x32_bf16 v[112:115], v[40:43], v[60:63], v[112:115]
    v_mfma_f32_16x16x32_bf16 v[116:119], v[44:47], v[60:63], v[116:119]
    s_waitcnt lgkmcnt(12)
    v_mfma_f32_16x16x32_bf16 v[120:123], v[40:43], v[64:67], v[120:123]
    v_mfma_f32_16x16x32_bf16 v[124:127], v[44:47], v[64:67], v[124:127]
    s_waitcnt vmcnt(6)
    s_mov_b32 s48, 0x88888888
    v_and_b32 v254, s48, v39
    v_cmp_ne_u32 s[46:47], s48, v254
    s_nop 0
    s_cmp_eq_u64 s[46:47], 0
    s_cbranch_scc1 L_cnt_ok1
    s_mov_b32 s49, 100000
L_cnt_poll1:
    s_lshl_b32 s48, s37, 7
    v_and_b32 v39, 15, v0
    v_lshlrev_b32 v39, 2, v39
    buffer_load_dword v39, v39, s[24:27], s48 offen sc1
    s_waitcnt vmcnt(0)
    s_sub_u32 s49, s49, 1
    s_cbranch_scc1 L_cnt_ok1
    s_mov_b32 s48, 0x88888888
    v_and_b32 v254, s48, v39
    v_cmp_ne_u32 s[46:47], s48, v254
    s_nop 0
    s_cmp_eq_u64 s[46:47], 0
    s_cbranch_scc0 L_cnt_poll1
    s_nop 1
L_cnt_ok1:
    s_waitcnt lgkmcnt(0)
    s_barrier
    v_mfma_f32_16x16x32_bf16 v[88:91], v[232:235], v[68:71], v[88:91]
    ds_read_b128 v[40:43], v6 offset:20480
    ds_read_b64_tr_b16 v[48:49], v14 offset:0
    v_mfma_f32_16x16x32_bf16 v[92:95], v[236:239], v[68:71], v[92:95]
    ds_read_b64_tr_b16 v[50:51], v14 offset:1280
    s_nop 0
    s_cbranch_execz L_pfret
    ds_read_b128 v[44:47], v6 offset:22528
    v_mfma_f32_16x16x32_bf16 v[96:99], v[232:235], v[72:75], v[96:99]
    ds_read_b64_tr_b16 v[52:53], v14 offset:40
    ds_read_b64_tr_b16 v[54:55], v14 offset:1320
    v_mfma_f32_16x16x32_bf16 v[100:103], v[236:239], v[72:75], v[100:103]
    ds_read_b64_tr_b16 v[56:57], v14 offset:80
    ds_read_b64_tr_b16 v[58:59], v14 offset:1360
    v_mfma_f32_16x16x32_bf16 v[104:107], v[232:235], v[76:79], v[104:107]
    ds_read_b64_tr_b16 v[60:61], v14 offset:120
    ds_read_b64_tr_b16 v[62:63], v14 offset:1400
    v_mfma_f32_16x16x32_bf16 v[108:111], v[236:239], v[76:79], v[108:111]
    ds_read_b64_tr_b16 v[64:65], v15 offset:0
    ds_read_b64_tr_b16 v[66:67], v15 offset:1280
    v_mfma_f32_16x16x32_bf16 v[112:115], v[232:235], v[80:83], v[112:115]
    s_add_u32 m0, s44, 153600
    s_add_u32 s57, s76, 737280
    buffer_load_dwordx4 v249, s[8:11], s57 offen offset:0 lds
    v_mfma_f32_16x16x32_bf16 v[116:119], v[236:239], v[80:83], v[116:119]
    buffer_load_dwordx4 v250, s[8:11], s57 offen offset:1024 lds
    v_mfma_f32_16x16x32_bf16 v[120:123], v[232:235], v[84:87], v[120:123]
    s_mov_b64 exec, 0xffffffff
    buffer_load_dwordx4 v251, s[8:11], s57 offen offset:2048 lds
    s_mov_b64 exec, -1
    v_mfma_f32_16x16x32_bf16 v[124:127], v[236:239], v[84:87], v[124:127]
    s_add_u32 m0, s44, 47104
    s_add_u32 s57, s76, 1228800
    s_sub_u32 s56, s57, 2457600
    s_min_u32 s57, s57, s56
    buffer_load_dwordx4 v249, s[8:11], s57 offen offset:0 lds
    s_waitcnt lgkmcnt(9)
    v_mfma_f32_16x16x32_bf16 v[88:91], v[40:43], v[48:51], v[88:91]
    ds_read_b128 v[240:243], v7 offset:20480
    ds_read_b64_tr_b16 v[68:69], v14 offset:10240
    s_cbranch_execz L_pfret
    s_waitcnt lgkmcnt(10)
    v_mfma_f32_16x16x32_bf16 v[92:95], v[44:47], v[48:51], v[92:95]
    ds_read_b64_tr_b16 v[70:71], v14 offset:11520
    ds_read_b128 v[244:247], v7 offset:22528
    s_waitcnt lgkmcnt(10)
    v_mfma_f32_16x16x32_bf16 v[96:99], v[40:43], v[52:55], v[96:99]
    ds_read_b64_tr_b16 v[72:73], v14 offset:10280
    ds_read_b64_tr_b16 v[74:75], v14 offset:11560
    v_mfma_f32_16x16x32_bf16 v[100:103], v[44:47], v[52:55], v[100:103]
    ds_read_b64_tr_b16 v[76:77], v14 offset:10320
    ds_read_b64_tr_b16 v[78:79], v14 offset:11600
    s_waitcnt lgkmcnt(12)
    v_mfma_f32_16x16x32_bf16 v[104:107], v[40:43], v[56:59], v[104:107]
    ds_read_b64_tr_b16 v[80:81], v14 offset:10360
    ds_read_b64_tr_b16 v[82:83], v14 offset:11640
    v_mfma_f32_16x16x32_bf16 v[108:111], v[44:47], v[56:59], v[108:111]
    ds_read_b64_tr_b16 v[84:85], v15 offset:10240
    ds_read_b64_tr_b16 v[86:87], v15 offset:11520
    s_waitcnt lgkmcnt(14)
    v_mfma_f32_16x16x32_bf16 v[112:115], v[40:43], v[60:63], v[112:115]
    buffer_load_dwordx4 v250, s[8:11], s57 offen offset:1024 lds
    v_mfma_f32_16x16x32_bf16 v[116:119], v[44:47], v[60:63], v[116:119]
    s_mov_b64 exec, 0xffffffff
    buffer_load_dwordx4 v251, s[8:11], s57 offen offset:2048 lds
    s_mov_b64 exec, -1
    s_waitcnt lgkmcnt(12)
    v_mfma_f32_16x16x32_bf16 v[120:123], v[40:43], v[64:67], v[120:123]
    s_add_u32 s47, s38, 1
    s_add_u32 s48, s38, 2
    s_mul_i32 s3, s3, 0x11111111
    v_readlane_b32 s46, v39, s38
    v_readlane_b32 s47, v39, s47
    v_readlane_b32 s48, v39, s48
    v_mfma_f32_16x16x32_bf16 v[124:127], v[44:47], v[64:67], v[124:127]
    s_lshl_b32 s49, s39, 2
    s_xor_b32 s47, s47, s3
    s_xor_b32 s48, s48, s3
    s_cbranch_execz L_pfret
    s_or_b32 s47, s47, s48
    s_lshr_b32 s47, s47, s49
    s_cmp_eq_u32 s46, s3
    s_cselect_b32 s3, 1, 0
    s_and_b32 s47, s47, 15
    s_cselect_b32 s47, 0, 2
    s_mul_i32 s47, s47, s3
    s_or_b32 s3, s3, s47
    s_waitcnt vmcnt(6) lgkmcnt(0)
    s_barrier
    v_mfma_f32_16x16x32_bf16 v[88:91], v[240:243], v[68:71], v[88:91]
    ds_read_b64_tr_b16 v[48:49], v22 offset:24576
    ds_read_b64_tr_b16 v[50:51], v22 offset:25856
    v_mfma_f32_16x16x32_bf16 v[92:95], v[244:247], v[68:71], v[92:95]
    ds_read_b64_tr_b16 v[52:53], v22 offset:24616
    ds_read_b64_tr_b16 v[54:55], v22 offset:25896
    v_mfma_f32_16x16x32_bf16 v[96:99], v[240:243], v[72:75], v[96:99]
    ds_read_b64_tr_b16 v[56:57], v22 offset:24656
    ds_read_b64_tr_b16 v[58:59], v22 offset:25936
    v_mfma_f32_16x16x32_bf16 v[100:103], v[244:247], v[72:75], v[100:103]
    ds_read_b64_tr_b16 v[60:61], v22 offset:24696
    ds_read_b64_tr_b16 v[62:63], v22 offset:25976
    v_mfma_f32_16x16x32_bf16 v[104:107], v[240:243], v[76:79], v[104:107]
    ds_read_b64_tr_b16 v[64:65], v23 offset:24576
    ds_read_b64_tr_b16 v[66:67], v23 offset:25856
    v_mfma_f32_16x16x32_bf16 v[108:111], v[244:247], v[76:79], v[108:111]
    v_mfma_f32_16x16x32_bf16 v[112:115], v[240:243], v[80:83], v[112:115]
    v_mfma_f32_16x16x32_bf16 v[116:119], v[244:247], v[80:83], v[116:119]
    v_mfma_f32_16x16x32_bf16 v[120:123], v[240:243], v[84:87], v[120:123]
    v_mfma_f32_16x16x32_bf16 v[124:127], v[244:247], v[84:87], v[124:127]
    s_cbranch_vccz L_ains1
L_aret1:
    s_waitcnt lgkmcnt(8)
    v_mfma_f32_16x16x32_bf16 v[144:147], v[48:51], v[168:171], 0
    ds_read_b64_tr_b16 v[68:69], v22 offset:34816
    ds_read_b64_tr_b16 v[70:71], v22 offset:36096
    v_mfma_f32_16x16x32_bf16 v[148:151], v[48:51], v[172:175], 0
    ds_read_b64_tr_b16 v[72:73], v22 offset:34856
    s_nop 0
    s_cbranch_execz L_pfret
    ds_read_b64_tr_b16 v[74:75], v22 offset:36136
    v_mov_b64 v[40:41], -1
    v_mov_b64 v[42:43], -1
    s_waitcnt lgkmcnt(10)
    v_mfma_f32_16x16x32_bf16 v[152:155], v[52:55], v[168:171], 0
    ds_read_b64_tr_b16 v[76:77], v22 offset:34896
    ds_read_b64_tr_b16 v[78:79], v22 offset:36176
    v_cvt_pk_bf16_f32 v88, v88, v89
    v_cvt_pk_bf16_f32 v89, v90, v91
    v_mfma_f32_16x16x32_bf16 v[156:159], v[52:55], v[172:175], 0
    ds_read_b64_tr_b16 v[80:81], v22 offset:34936
    ds_read_b64_tr_b16 v[82:83], v22 offset:36216
    v_cvt_pk_bf16_f32 v90, v92, v93
    v_cvt_pk_bf16_f32 v91, v94, v95
    s_waitcnt lgkmcnt(12)
    v_mfma_f32_16x16x32_bf16 v[128:131], v[56:59], v[168:171], 0
    ds_read_b64_tr_b16 v[84:85], v23 offset:34816
    ds_read_b64_tr_b16 v[86:87], v23 offset:36096
    v_permlane32_swap_b32 v88, v90
    v_permlane32_swap_b32 v89, v91
    v_mfma_f32_16x16x32_bf16 v[132:135], v[56:59], v[172:175], 0
    s_add_u32 m0, s44, 10240
    s_add_u32 s57, s76, 1720320
    s_sub_u32 s56, s57, 2457600
    s_min_u32 s57, s57, s56
    buffer_load_dwordx4 v249, s[8:11], s57 offen offset:0 lds
    s_cbranch_vccz L_pa10
    buffer_store_dwordx4 v[88:91], v1, s[32:35], s65 offen offset:0 sc1
L_pa10:
    s_cbranch_vccnz L_pb10
    s_bitcmp1_b32 s36, 0
    s_cbranch_scc1 L_pk1
    buffer_store_dwordx4 v[120:123], v44, s[12:15], s48 offen sc1
    s_branch L_pb10
L_pk1:
    buffer_store_dwordx2 v[120:121], v44, s[12:15], s48 offen offset:1344 sc1
L_pb10:
    s_waitcnt lgkmcnt(12)
    v_mfma_f32_16x16x32_bf16 v[136:139], v[60:63], v[168:171], 0
    buffer_load_dwordx4 v250, s[8:11], s57 offen offset:1024 lds
    ds_write_b128 v28, v[88:91] offset:0
    s_cbranch_execz L_pfret
    v_cvt_pk_bf16_f32 v96, v96, v97
    v_mfma_f32_16x16x32_bf16 v[140:143], v[60:63], v[172:175], 0
    s_mov_b64 exec, 0xffffffff
    buffer_load_dwordx4 v251, s[8:11], s57 offen offset:2048 lds
    s_mov_b64 exec, -1
    v_cvt_pk_bf16_f32 v97, v98, v99
    v_cvt_pk_bf16_f32 v98, v100, v101
    s_waitcnt lgkmcnt(11)
    v_mfma_f32_16x16x32_bf16 v[164:167], v[64:67], v[168:171], 0
    s_add_u32 m0, s44, 20480
    s_add_u32 s57, s76, 2211840
    s_sub_u32 s56, s57, 2457600
    s_min_u32 s57, s57, s56
    buffer_load_dwordx4 v249, s[8:11], s57 offen offset:0 lds
    v_cvt_pk_bf16_f32 v99, v102, v103
    v_permlane32_swap_b32 v96, v98
    v_mfma_f32_16x16x32_bf16 v[160:163], v[64:67], v[172:175], 0
    buffer_load_dwordx4 v250, s[8:11], s57 offen offset:1024 lds
    v_permlane32_swap_b32 v97, v99
    s_cbranch_vccz L_pa11
    buffer_store_dwordx4 v[96:99], v1, s[32:35], s65 offen offset:1024 sc1
L_pa11:
    s_cbranch_vccnz L_pb11
    buffer_store_dwordx4 v[124:127], v45, s[12:15], s48 offen offset:16 sc1
L_pb11:
    s_mov_b64 exec, 0xffffffff
    buffer_load_dwordx4 v251, s[8:11], s57 offen offset:2048 lds
    s_mov_b64 exec, -1
    s_waitcnt vmcnt(11) lgkmcnt(0)
    s_barrier
    v_mfma_f32_16x16x32_bf16 v[144:147], v[68:71], v[176:179], v[144:147]
    ds_read_b64_tr_b16 v[48:49], v22 offset:45056
    ds_read_b64_tr_b16 v[50:51], v22 offset:46336
    v_mfma_f32_16x16x32_bf16 v[148:151], v[68:71], v[180:183], v[148:151]
    ds_read_b64_tr_b16 v[52:53], v22 offset:45096
    ds_read_b64_tr_b16 v[54:55], v22 offset:46376
    ds_write_b128 v28, v[96:99] offset:1024
    v_cvt_pk_bf16_f32 v104, v104, v105
    s_nop 0
    s_cbranch_execz L_pfret
    v_mfma_f32_16x16x32_bf16 v[152:155], v[72:75], v[176:179], v[152:155]
    ds_read_b64_tr_b16 v[56:57], v22 offset:45136
    ds_read_b64_tr_b16 v[58:59], v22 offset:46416
    v_cvt_pk_bf16_f32 v105, v106, v107
    v_cvt_pk_bf16_f32 v106, v108, v109
    v_mfma_f32_16x16x32_bf16 v[156:159], v[72:75], v[180:183], v[156:159]
    ds_read_b64_tr_b16 v[60:61], v22 offset:45176
    ds_read_b64_tr_b16 v[62:63], v22 offset:46456
    v_cvt_pk_bf16_f32 v107, v110, v111
    v_permlane32_swap_b32 v104, v106
    v_mfma_f32_16x16x32_bf16 v[128:131], v[76:79], v[176:179], v[128:131]
    ds_read_b64_tr_b16 v[64:65], v23 offset:45056
    ds_read_b64_tr_b16 v[66:67], v23 offset:46336
    v_permlane32_swap_b32 v105, v107
    s_cbranch_vccz L_pa12
    buffer_store_dwordx4 v[104:107], v1, s[32:35], s65 offen offset:2048 sc1
L_pa12:
    s_cbranch_vccnz L_pb12
    s_add_u32 m0, s71, 81920
    s_nop 0
    buffer_load_dwordx4 v30, s[16:19], s45 offen offset:0 lds
L_pb12:
    v_mfma_f32_16x16x32_bf16 v[132:135], v[76:79], v[180:183], v[132:135]
    ds_write_b128 v28, v[104:107] offset:2048
    v_cvt_pk_bf16_f32 v112, v112, v113
    v_mfma_f32_16x16x32_bf16 v[136:139], v[80:83], v[176:179], v[136:139]
    v_cvt_pk_bf16_f32 v113, v114, v115
    v_cvt_pk_bf16_f32 v114, v116, v117
    v_mfma_f32_16x16x32_bf16 v[140:143], v[80:83], v[180:183], v[140:143]
    v_cvt_pk_bf16_f32 v115, v118, v119
    v_permlane32_swap_b32 v112, v114
    v_mfma_f32_16x16x32_bf16 v[164:167], v[84:87], v[176:179], v[164:167]
    v_permlane32_swap_b32 v113, v115
    s_cbranch_vccz L_pa13
    buffer_store_dwordx4 v[112:115], v1, s[32:35], s65 offen offset:3072 sc1
L_pa13:
    s_cbranch_vccnz L_pb13
    s_add_u32 m0, s71, 81920
    s_nop 0
    s_nop 0
    s_cbranch_execz L_pfret
    buffer_load_dwordx4 v31, s[16:19], s45 offen offset:1024 lds
L_pb13:
    v_mfma_f32_16x16x32_bf16 v[160:163], v[84:87], v[180:183], v[160:163]
    ds_write_b128 v28, v[112:115] offset:3072
    v_cvt_pk_bf16_f32 v120, v120, v121
    s_waitcnt lgkmcnt(11)
    v_mfma_f32_16x16x32_bf16 v[144:147], v[48:51], v[184:187], v[144:147]
    ds_read_b64_tr_b16 v[68:69], v22 offset:55296
    ds_read_b64_tr_b16 v[70:71], v22 offset:56576
    v_mfma_f32_16x16x32_bf16 v[148:151], v[48:51], v[188:191], v[148:151]
    ds_read_b64_tr_b16 v[72:73], v22 offset:55336
    ds_read_b64_tr_b16 v[74:75], v22 offset:56616
    v_cvt_pk_bf16_f32 v121, v122, v123
    v_cvt_pk_bf16_f32 v122, v124, v125
    s_waitcnt lgkmcnt(13)
    v_mfma_f32_16x16x32_bf16 v[152:155], v[52:55], v[184:187], v[152:155]
    ds_read_b64_tr_b16 v[76:77], v22 offset:55376
    ds_read_b64_tr_b16 v[78:79], v22 offset:56656
    v_cvt_pk_bf16_f32 v123, v126, v127
    v_permlane32_swap_b32 v120, v122
    v_mfma_f32_16x16x32_bf16 v[156:159], v[52:55], v[188:191], v[156:159]
    ds_read_b64_tr_b16 v[80:81], v22 offset:55416
    ds_read_b64_tr_b16 v[82:83], v22 offset:56696
    v_permlane32_swap_b32 v121, v123
    s_add_u32 s55, s65, 4096
    s_waitcnt lgkmcnt(14)
    v_mfma_f32_16x16x32_bf16 v[128:131], v[56:59], v[184:187], v[128:131]
    ds_read_b64_tr_b16 v[84:85], v23 offset:55296
    ds_read_b64_tr_b16 v[86:87], v23 offset:56576
    s_cbranch_vccz L_pa14
    buffer_store_dwordx4 v[120:123], v1, s[32:35], s55 offen sc1
L_pa14:
    s_cbranch_vccnz L_pb14
    s_add_u32 m0, s71, 81920
    s_nop 0
    buffer_load_dwordx4 v32, s[16:19], s45 offen offset:2048 lds
L_pb14:
    v_mfma_f32_16x16x32_bf16 v[132:135], v[56:59], v[188:191], v[132:135]
    s_nop 0
    s_cbranch_execz L_pfret
    ds_write_b128 v28, v[120:123] offset:4096
    s_mul_i32 s43, s72, 5
    s_add_u32 s43, s43, 19
    s_sub_u32 s43, s43, s36
    s_sub_u32 s52, s43, 20
    s_cselect_b32 s43, s43, s52
    s_mul_i32 s43, s43, 40960
    s_waitcnt lgkmcnt(15)
    v_mfma_f32_16x16x32_bf16 v[136:139], v[60:63], v[184:187], v[136:139]
    s_mul_i32 s45, s72, 5
    s_add_u32 s45, s45, 4
    s_add_u32 s45, s45, s36
    s_sub_u32 s52, s45, 20
    s_cselect_b32 s45, s45, s52
    s_mul_i32 s45, s45, 40960
    v_add_u32 v252, 3072, v33
    v_mfma_f32_16x16x32_bf16 v[140:143], v[60:63], v[188:191], v[140:143]
    v_add_u32 v253, 2048, v34
    s_mov_b32 s50, 1065369472
    s_waitcnt lgkmcnt(13)
    v_mfma_f32_16x16x32_bf16 v[164:167], v[64:67], v[184:187], v[164:167]
    s_mov_b32 s51, 1065369472
    v_mov_b64 v[2:3], s[50:51]
    v_mfma_f32_16x16x32_bf16 v[160:163], v[64:67], v[188:191], v[160:163]
    v_mov_b64 v[4:5], s[50:51]
    v_mov_b64 v[6:7], s[50:51]
    s_waitcnt vmcnt(11) lgkmcnt(0)
    s_barrier
    v_mfma_f32_16x16x32_bf16 v[144:147], v[68:71], v[192:195], v[144:147]
    ds_read_b64_tr_b16 v[48:49], v14 offset:36864
    ds_read_b64_tr_b16 v[50:51], v14 offset:38144
    v_mfma_f32_16x16x32_bf16 v[148:151], v[68:71], v[196:199], v[148:151]
    ds_read_b64_tr_b16 v[52:53], v14 offset:36904
    ds_read_b64_tr_b16 v[54:55], v14 offset:38184
    v_mov_b64 v[8:9], s[50:51]
    v_mov_b64 v[92:93], s[50:51]
    v_mfma_f32_16x16x32_bf16 v[152:155], v[72:75], v[192:195], v[152:155]
    ds_read_b64_tr_b16 v[56:57], v14 offset:36944
    ds_read_b64_tr_b16 v[58:59], v14 offset:38224
    v_mov_b64 v[94:95], s[50:51]
    v_mov_b64 v[100:101], s[50:51]
    v_mfma_f32_16x16x32_bf16 v[156:159], v[72:75], v[196:199], v[156:159]
    s_cbranch_execz L_pfret
    ds_read_b64_tr_b16 v[60:61], v14 offset:36984
    ds_read_b64_tr_b16 v[62:63], v14 offset:38264
    v_mov_b64 v[102:103], s[50:51]
    s_movk_i32 s51, 0x3f80
    v_mfma_f32_16x16x32_bf16 v[128:131], v[76:79], v[192:195], v[128:131]
    ds_read_b64_tr_b16 v[64:65], v15 offset:36864
    ds_read_b64_tr_b16 v[66:67], v15 offset:38144
    v_mov_b64 v[40:41], s[50:51]
    v_mov_b64 v[42:43], s[50:51]
    v_mfma_f32_16x16x32_bf16 v[132:135], v[76:79], v[196:199], v[132:135]
    v_mov_b64 v[44:45], s[50:51]
    v_mov_b64 v[46:47], s[50:51]
    v_mfma_f32_16x16x32_bf16 v[136:139], v[80:83], v[192:195], v[136:139]
    v_mov_b64 v[108:109], 0
    v_mov_b64 v[110:111], 0
    v_mfma_f32_16x16x32_bf16 v[140:143], v[80:83], v[196:199], v[140:143]
    v_lshrrev_b32 v116, 5, v0
    v_and_b32 v117, 31, v0
    v_mfma_f32_16x16x32_bf16 v[164:167], v[84:87], v[192:195], v[164:167]
    v_lshlrev_b32 v116, 2, v116
    v_sub_u32 v116, v117, v116
    v_mfma_f32_16x16x32_bf16 v[160:163], v[84:87], v[196:199], v[160:163]
    v_subrev_u32 v168, 0, v116
    v_and_b32 v168, s100, v168
    s_waitcnt lgkmcnt(8)
    v_mfma_f32_16x16x32_bf16 v[144:147], v[48:51], v[200:203], v[144:147]
    ds_read_b64_tr_b16 v[68:69], v14 offset:47104
    ds_read_b64_tr_b16 v[70:71], v14 offset:48384
    v_mfma_f32_16x16x32_bf16 v[148:151], v[48:51], v[204:207], v[148:151]
    ds_read_b64_tr_b16 v[72:73], v14 offset:47144
    ds_read_b64_tr_b16 v[74:75], v14 offset:48424
    v_subrev_u32 v169, 1, v116
    v_and_b32 v169, s100, v169
    s_waitcnt lgkmcnt(10)
    v_mfma_f32_16x16x32_bf16 v[152:155], v[52:55], v[200:203], v[152:155]
    ds_read_b64_tr_b16 v[76:77], v14 offset:47184
    ds_read_b64_tr_b16 v[78:79], v14 offset:48464
    v_subrev_u32 v170, 2, v116
    v_and_b32 v170, s100, v170
    v_mfma_f32_16x16x32_bf16 v[156:159], v[52:55], v[204:207], v[156:159]
    ds_read_b64_tr_b16 v[80:81], v14 offset:47224
    s_nop 0
    s_cbranch_execz L_pfret
    ds_read_b64_tr_b16 v[82:83], v14 offset:48504
    v_subrev_u32 v171, 3, v116
    v_and_b32 v171, s100, v171
    s_waitcnt lgkmcnt(12)
    v_mfma_f32_16x16x32_bf16 v[128:131], v[56:59], v[200:203], v[128:131]
    ds_read_b64_tr_b16 v[84:85], v15 offset:47104
    ds_read_b64_tr_b16 v[86:87], v15 offset:48384
    v_subrev_u32 v172, 8, v116
    v_and_b32 v172, s100, v172
    v_mfma_f32_16x16x32_bf16 v[132:135], v[56:59], v[204:207], v[132:135]
    v_subrev_u32 v173, 9, v116
    v_and_b32 v173, s100, v173
    s_waitcnt lgkmcnt(12)
    v_mfma_f32_16x16x32_bf16 v[136:139], v[60:63], v[200:203], v[136:139]
    v_subrev_u32 v174, 10, v116
    v_and_b32 v174, s100, v174
    v_mfma_f32_16x16x32_bf16 v[140:143], v[60:63], v[204:207], v[140:143]
    v_subrev_u32 v175, 11, v116
    v_and_b32 v175, s100, v175
    s_waitcnt lgkmcnt(10)
    v_mfma_f32_16x16x32_bf16 v[164:167], v[64:67], v[200:203], v[164:167]
    v_subrev_u32 v176, 16, v116
    v_and_b32 v176, s100, v176
    v_mfma_f32_16x16x32_bf16 v[160:163], v[64:67], v[204:207], v[160:163]
    v_subrev_u32 v177, 17, v116
    v_and_b32 v177, s100, v177
    s_waitcnt vmcnt(7) lgkmcnt(0)
    s_barrier
    v_mfma_f32_16x16x32_bf16 v[144:147], v[68:71], v[208:211], v[144:147]
    ds_read_b64_tr_b16 v[48:49], v14 offset:0
    ds_read_b64_tr_b16 v[50:51], v14 offset:1280
    v_mfma_f32_16x16x32_bf16 v[148:151], v[68:71], v[212:215], v[148:151]
    ds_read_b64_tr_b16 v[52:53], v14 offset:40
    ds_read_b64_tr_b16 v[54:55], v14 offset:1320
    v_subrev_u32 v178, 18, v116
    v_and_b32 v178, s100, v178
    v_mfma_f32_16x16x32_bf16 v[152:155], v[72:75], v[208:211], v[152:155]
    ds_read_b64_tr_b16 v[56:57], v14 offset:80
    ds_read_b64_tr_b16 v[58:59], v14 offset:1360
    v_subrev_u32 v179, 19, v116
    v_and_b32 v179, s100, v179
    v_mfma_f32_16x16x32_bf16 v[156:159], v[72:75], v[212:215], v[156:159]
    ds_read_b64_tr_b16 v[60:61], v14 offset:120
    s_cbranch_execz L_pfret
    ds_read_b64_tr_b16 v[62:63], v14 offset:1400
    v_subrev_u32 v180, 24, v116
    v_and_b32 v180, s100, v180
    v_mfma_f32_16x16x32_bf16 v[128:131], v[76:79], v[208:211], v[128:131]
    ds_read_b64_tr_b16 v[64:65], v15 offset:0
    ds_read_b64_tr_b16 v[66:67], v15 offset:1280
    v_subrev_u32 v181, 25, v116
    v_and_b32 v181, s100, v181
    v_mfma_f32_16x16x32_bf16 v[132:135], v[76:79], v[212:215], v[132:135]
    v_subrev_u32 v182, 26, v116
    v_and_b32 v182, s100, v182
    v_mfma_f32_16x16x32_bf16 v[136:139], v[80:83], v[208:211], v[136:139]
    v_subrev_u32 v183, 27, v116
    v_and_b32 v183, s100, v183
    v_mfma_f32_16x16x32_bf16 v[140:143], v[80:83], v[212:215], v[140:143]
    v_xor_b32 v184, s100, v168
    v_xor_b32 v185, s100, v169
    v_mfma_f32_16x16x32_bf16 v[164:167], v[84:87], v[208:211], v[164:167]
    v_xor_b32 v186, s100, v170
    v_xor_b32 v187, s100, v171
    v_mfma_f32_16x16x32_bf16 v[160:163], v[84:87], v[212:215], v[160:163]
    v_xor_b32 v188, s100, v172
    v_xor_b32 v189, s100, v173
    s_cbranch_vccz L_w2f1
    s_waitcnt vmcnt(0)
L_w2f1:
    s_waitcnt vmcnt(3)
    s_mov_b64 exec, 1
    s_bitcmp1_b32 s3, 1
    s_cbranch_scc0 L_fc1
    buffer_store_dword v26, off, s[32:35], s75 offset:512
    s_branch L_fd1
L_fc1:
    buffer_store_dword v26, off, s[32:35], s75 offset:512 sc1
L_fd1:
    s_mov_b64 exec, -1
    s_waitcnt lgkmcnt(8)
    v_mfma_f32_16x16x32_bf16 v[144:147], v[48:51], v[216:219], v[144:147]
    ds_read_b64_tr_b16 v[68:69], v14 offset:10240
    ds_read_b64_tr_b16 v[70:71], v14 offset:11520
    v_mfma_f32_16x16x32_bf16 v[148:151], v[48:51], v[220:223], v[148:151]
    ds_read_b64_tr_b16 v[72:73], v14 offset:10280
    ds_read_b64_tr_b16 v[74:75], v14 offset:11560
    v_xor_b32 v190, s100, v174
    v_xor_b32 v191, s100, v175
    s_waitcnt lgkmcnt(10)
    v_mfma_f32_16x16x32_bf16 v[152:155], v[52:55], v[216:219], v[152:155]
    s_nop 0
    s_cbranch_execz L_pfret
    ds_read_b64_tr_b16 v[76:77], v14 offset:10320
    ds_read_b64_tr_b16 v[78:79], v14 offset:11600
    v_xor_b32 v192, s100, v176
    v_xor_b32 v193, s100, v177
    v_mfma_f32_16x16x32_bf16 v[156:159], v[52:55], v[220:223], v[156:159]
    ds_read_b64_tr_b16 v[80:81], v14 offset:10360
    ds_read_b64_tr_b16 v[82:83], v14 offset:11640
    v_xor_b32 v194, s100, v178
    v_xor_b32 v195, s100, v179
    s_waitcnt lgkmcnt(12)
    v_mfma_f32_16x16x32_bf16 v[128:131], v[56:59], v[216:219], v[128:131]
    ds_read_b64_tr_b16 v[84:85], v15 offset:10240
    ds_read_b64_tr_b16 v[86:87], v15 offset:11520
    v_xor_b32 v196, s100, v180
    v_xor_b32 v197, s100, v181
    v_mfma_f32_16x16x32_bf16 v[132:135], v[56:59], v[220:223], v[132:135]
    v_xor_b32 v198, s100, v182
    v_xor_b32 v199, s100, v183
    s_waitcnt lgkmcnt(12)
    v_mfma_f32_16x16x32_bf16 v[136:139], v[60:63], v[216:219], v[136:139]
    s_cbranch_vccnz L_pe10
    s_add_u32 s56, s0, 0
    buffer_load_dwordx4 v[104:107], v39, s[12:15], s56 offen sc1
    s_add_u32 s56, s0, 8192
    buffer_load_dwordx4 v[112:115], v39, s[12:15], s56 offen sc1
L_pe10:
    s_mul_i32 s52, s39, 1016
    s_sub_u32 s76, s64, s52
    s_lshl_b32 s52, s40, 6
    s_add_u32 s76, s76, s52
    s_lshl_b32 s52, s41, 2
    s_add_u32 s76, s76, s52
    v_mfma_f32_16x16x32_bf16 v[140:143], v[60:63], v[220:223], v[140:143]
    s_waitcnt lgkmcnt(10)
    v_mfma_f32_16x16x32_bf16 v[164:167], v[64:67], v[216:219], v[164:167]
    s_cbranch_vccnz L_pe11
    s_add_u32 s56, s0, 16384
    buffer_load_dwordx4 v[120:123], v39, s[12:15], s56 offen sc1
    s_add_u32 s56, s0, 24576
    buffer_load_dwordx4 v[124:127], v39, s[12:15], s56 offen sc1
L_pe11:
    v_mfma_f32_16x16x32_bf16 v[160:163], v[64:67], v[220:223], v[160:163]
    buffer_load_dwordx2 v[254:255], off, s[12:15], s69 sc1
    s_cbranch_execz L_pfret
    s_waitcnt lgkmcnt(0)
    s_barrier
    v_mfma_f32_16x16x32_bf16 v[144:147], v[68:71], v[224:227], v[144:147]
    ds_read_b64_tr_b16 v[48:49], v14 offset:57344
    ds_read_b64_tr_b16 v[50:51], v14 offset:58624
    v_mfma_f32_16x16x32_bf16 v[148:151], v[68:71], v[228:231], v[148:151]
    ds_read_b64_tr_b16 v[52:53], v14 offset:57384
    ds_read_b64_tr_b16 v[54:55], v14 offset:58664
    v_mfma_f32_16x16x32_bf16 v[152:155], v[72:75], v[224:227], v[152:155]
    ds_read_b64_tr_b16 v[56:57], v14 offset:57424
    ds_read_b64_tr_b16 v[58:59], v14 offset:58704
    v_mfma_f32_16x16x32_bf16 v[156:159], v[72:75], v[228:231], v[156:159]
    ds_read_b64_tr_b16 v[60:61], v14 offset:57464
    ds_read_b64_tr_b16 v[62:63], v14 offset:58744
    v_mfma_f32_16x16x32_bf16 v[128:131], v[76:79], v[224:227], v[128:131]
    ds_read_b64_tr_b16 v[64:65], v15 offset:57344
    ds_read_b64_tr_b16 v[66:67], v15 offset:58624
    v_mfma_f32_16x16x32_bf16 v[132:135], v[76:79], v[228:231], v[132:135]
    v_mfma_f32_16x16x32_bf16 v[136:139], v[80:83], v[224:227], v[136:139]
    s_cbranch_vccnz L_pe12
    s_add_u32 s56, s0, 32768
    buffer_load_dwordx4 v[200:203], v39, s[12:15], s56 offen sc1
    s_add_u32 s56, s0, 40960
    buffer_load_dwordx4 v[44:47], v39, s[12:15], s56 offen sc1
L_pe12:
    v_mfma_f32_16x16x32_bf16 v[140:143], v[80:83], v[228:231], v[140:143]
    v_mfma_f32_16x16x32_bf16 v[164:167], v[84:87], v[224:227], v[164:167]
    s_cbranch_vccnz L_pe13
    s_add_u32 s56, s0, 49152
    buffer_load_dwordx4 v[108:111], v39, s[12:15], s56 offen sc1
    s_add_u32 s56, s0, 57344
    buffer_load_dwordx4 v[116:119], v39, s[12:15], s56 offen sc1
L_pe13:
    v_mfma_f32_16x16x32_bf16 v[160:163], v[84:87], v[228:231], v[160:163]
    s_waitcnt lgkmcnt(8)
    v_mfma_f32_16x16x32_bf16 v[144:147], v[48:51], v[232:235], v[144:147]
    s_cbranch_execz L_pfret
    ds_read_b64_tr_b16 v[68:69], v14 offset:20480
    ds_read_b64_tr_b16 v[70:71], v14 offset:21760
    v_mfma_f32_16x16x32_bf16 v[148:151], v[48:51], v[236:239], v[148:151]
    ds_read_b64_tr_b16 v[72:73], v14 offset:20520
    ds_read_b64_tr_b16 v[74:75], v14 offset:21800
    s_waitcnt lgkmcnt(10)
    v_mfma_f32_16x16x32_bf16 v[152:155], v[52:55], v[232:235], v[152:155]
    ds_read_b64_tr_b16 v[76:77], v14 offset:20560
    ds_read_b64_tr_b16 v[78:79], v14 offset:21840
    v_mfma_f32_16x16x32_bf16 v[156:159], v[52:55], v[236:239], v[156:159]
    ds_read_b64_tr_b16 v[80:81], v14 offset:20600
    ds_read_b64_tr_b16 v[82:83], v14 offset:21880
    s_waitcnt lgkmcnt(12)
    v_mfma_f32_16x16x32_bf16 v[128:131], v[56:59], v[232:235], v[128:131]
    ds_read_b64_tr_b16 v[84:85], v15 offset:20480
    ds_read_b64_tr_b16 v[86:87], v15 offset:21760
    v_mfma_f32_16x16x32_bf16 v[132:135], v[56:59], v[236:239], v[132:135]
    s_waitcnt lgkmcnt(12)
    v_mfma_f32_16x16x32_bf16 v[136:139], v[60:63], v[232:235], v[136:139]
    s_cbranch_vccnz L_pe14
    s_add_u32 s56, s0, 65536
    buffer_load_dwordx4 v[168:171], v39, s[12:15], s56 offen sc1
    s_add_u32 s56, s0, 73728
    buffer_load_dwordx4 v[172:175], v39, s[12:15], s56 offen sc1
L_pe14:
    v_mfma_f32_16x16x32_bf16 v[140:143], v[60:63], v[236:239], v[140:143]
    s_waitcnt lgkmcnt(10)
    v_mfma_f32_16x16x32_bf16 v[164:167], v[64:67], v[232:235], v[164:167]
    s_cbranch_vccnz L_pe15
    s_add_u32 s56, s0, 81920
    buffer_load_dwordx4 v[176:179], v39, s[12:15], s56 offen sc1
    s_add_u32 s56, s0, 90112
    buffer_load_dwordx4 v[180:183], v39, s[12:15], s56 offen sc1
L_pe15:
    v_mfma_f32_16x16x32_bf16 v[160:163], v[64:67], v[236:239], v[160:163]
    s_waitcnt lgkmcnt(0)
    s_barrier
    s_nop 0
    s_cbranch_execz L_pfret
    v_mfma_f32_16x16x32_bf16 v[164:167], v[84:87], v[240:243], v[164:167]
    v_mfma_f32_16x16x32_bf16 v[160:163], v[84:87], v[244:247], v[160:163]
    v_mfma_f32_16x16x32_bf16 v[144:147], v[68:71], v[240:243], v[144:147]
    v_mfma_f32_16x16x32_bf16 v[148:151], v[68:71], v[244:247], v[148:151]
    v_mfma_f32_16x16x32_bf16 v[152:155], v[72:75], v[240:243], v[152:155]
    s_nop 4
    v_permlane32_swap_b32 v164, v160
    v_permlane32_swap_b32 v165, v161
    v_mfma_f32_16x16x32_bf16 v[156:159], v[72:75], v[244:247], v[156:159]
    v_permlane32_swap_b32 v166, v162
    v_permlane32_swap_b32 v167, v163
    v_mfma_f32_16x16x32_bf16 v[128:131], v[76:79], v[240:243], v[128:131]
    s_cbranch_vccnz L_pe16
    s_add_u32 s56, s0, 98304
    buffer_load_dwordx4 v[184:187], v39, s[12:15], s56 offen sc1
    s_add_u32 s56, s0, 106496
    buffer_load_dwordx4 v[188:191], v39, s[12:15], s56 offen sc1
L_pe16:
    ds_write_b128 v26, v[144:147]
    ds_write_b128 v26, v[148:151] offset:1024
    v_mfma_f32_16x16x32_bf16 v[132:135], v[76:79], v[244:247], v[132:135]
    ds_write_b128 v26, v[164:167] offset:4096
    v_mfma_f32_16x16x32_bf16 v[136:139], v[80:83], v[240:243], v[136:139]
    s_cbranch_vccnz L_pe17
    s_add_u32 s56, s0, 114688
    buffer_load_dwordx4 v[192:195], v39, s[12:15], s56 offen sc1
    s_add_u32 s56, s0, 122880
    buffer_load_dwordx4 v[196:199], v39, s[12:15], s56 offen sc1
L_pe17:
    ds_write_b128 v26, v[152:155] offset:2048
    v_mfma_f32_16x16x32_bf16 v[140:143], v[80:83], v[244:247], v[140:143]
    ds_write_b128 v26, v[156:159] offset:3072
    s_nop 0
L_g_post:
    s_cmp_eq_u32 s37, 0
    s_cbranch_scc1 L_apath
    s_bitcmp0_b32 12, s40
    s_cbranch_scc1 L_pr01
    s_setprio 1
L_pr01:
    s_waitcnt lgkmcnt(0)
    s_barrier
    ds_read_b128 v[88:91], v11 offset:40960
    s_cbranch_execz L_pfret
    s_mov_b64 exec, s[58:59]
    ds_read_b128 v[40:43], v13 offset:40960
    s_mov_b64 exec, -1
    ds_read_b128 v[96:99], v11 offset:41984
    s_mov_b64 exec, s[62:63]
    ds_read_b128 v[2:5], v19 offset:40960
    ds_read_b128 v[6:9], v19 offset:41472
    s_mov_b64 exec, -1
    ds_read_b128 v[216:219], v27 offset:4096
    ds_read_b128 v[200:203], v27 offset:0
    ds_read_b128 v[204:207], v27 offset:1024
    ds_read_b128 v[208:211], v27 offset:2048
    ds_read_b128 v[212:215], v27 offset:3072
    v_pk_mul_f32 v[160:161], v[160:161], s[98:99]
    v_pk_mul_f32 v[162:163], v[162:163], s[98:99]
    v_pk_mul_f32 v[128:129], v[128:129], s[98:99]
    v_pk_mul_f32 v[130:131], v[130:131], s[98:99]
    v_pk_mul_f32 v[132:133], v[132:133], s[98:99]
    v_pk_mul_f32 v[134:135], v[134:135], s[98:99]
    v_pk_mul_f32 v[136:137], v[136:137], s[98:99]
    v_pk_mul_f32 v[138:139], v[138:139], s[98:99]
    v_pk_mul_f32 v[140:141], v[140:141], s[98:99]
    v_pk_mul_f32 v[142:143], v[142:143], s[98:99]
    s_cmp_lg_u32 s70, 0
    s_cbranch_scc1 L_tr1
    s_waitcnt vmcnt(0)
    v_min_u32 v254, v254, v255
    s_nop 0
    v_readfirstlane_b32 s46, v254
    s_nop 0
    s_cmp_eq_u32 s46, 0
    s_cbranch_scc1 L_tr1_re
    s_mul_i32 s46, s36, 10240
    s_add_u32 m0, s46, 0
    s_add_u32 s47, s68, 0
    buffer_load_dwordx4 v1, s[12:15], s47 offen offset:0 lds
    buffer_load_dwordx4 v1, s[12:15], s47 offen offset:1024 lds
    buffer_load_dwordx4 v1, s[12:15], s47 offen offset:2048 lds
    buffer_load_dwordx4 v1, s[12:15], s47 offen offset:3072 lds
    s_cbranch_execz L_pfret
    s_add_u32 m0, s46, 4096
    s_add_u32 s47, s68, 4096
    buffer_load_dwordx4 v1, s[12:15], s47 offen offset:0 lds
    buffer_load_dwordx4 v1, s[12:15], s47 offen offset:1024 lds
    buffer_load_dwordx4 v1, s[12:15], s47 offen offset:2048 lds
    buffer_load_dwordx4 v1, s[12:15], s47 offen offset:3072 lds
    s_add_u32 m0, s46, 8192
    s_add_u32 s47, s68, 8192
    buffer_load_dwordx4 v1, s[12:15], s47 offen offset:0 lds
    buffer_load_dwordx4 v1, s[12:15], s47 offen offset:1024 lds
    s_mov_b32 s70, 1
    s_branch L_tr1
L_tr1_re:
    buffer_load_dwordx2 v[254:255], off, s[12:15], s69 sc1
L_tr1:
    s_waitcnt lgkmcnt(4)
    v_pk_fma_f32 v[160:161], v[216:217], s[98:99], v[160:161]
    v_pk_fma_f32 v[162:163], v[218:219], s[98:99], v[162:163]
    s_waitcnt lgkmcnt(3)
    v_pk_fma_f32 v[128:129], v[200:201], s[98:99], v[128:129]
    v_pk_fma_f32 v[130:131], v[202:203], s[98:99], v[130:131]
    v_cvt_pk_bf16_f32 v144, v160, v161
    v_cvt_pk_bf16_f32 v145, v162, v163
    s_waitcnt lgkmcnt(2)
    v_pk_fma_f32 v[132:133], v[204:205], s[98:99], v[132:133]
    v_pk_fma_f32 v[134:135], v[206:207], s[98:99], v[134:135]
    v_mov_b64 v[146:147], v[144:145]
    v_cvt_pk_bf16_f32 v128, v128, v129
    v_cvt_pk_bf16_f32 v129, v130, v131
    v_cvt_pk_bf16_f32 v130, v132, v133
    v_cvt_pk_bf16_f32 v131, v134, v135
    v_permlane32_swap_b32 v144, v146
    v_permlane32_swap_b32 v145, v147
    s_waitcnt lgkmcnt(1)
    v_pk_fma_f32 v[136:137], v[208:209], s[98:99], v[136:137]
    v_pk_fma_f32 v[138:139], v[210:211], s[98:99], v[138:139]
    v_permlane16_swap_b32 v128, v130
    v_permlane16_swap_b32 v129, v131
    v_permlane16_swap_b32 v144, v146
    v_permlane16_swap_b32 v145, v147
    s_cbranch_execz L_pfret
    s_waitcnt lgkmcnt(0)
    v_pk_fma_f32 v[140:141], v[212:213], s[98:99], v[140:141]
    v_pk_fma_f32 v[142:143], v[214:215], s[98:99], v[142:143]
    s_mov_b64 exec, s[60:61]
    v_mov_b64 v[144:145], 0
    v_mov_b64 v[146:147], 0
    s_mov_b64 exec, -1
    v_mfma_f32_32x32x16_bf16 v[48:63], v[88:91], v[128:131], v[168:183]
    v_mfma_f32_32x32x8_bf16 v[48:63], v[40:41], v[144:145], v[48:63]
    v_cvt_pk_bf16_f32 v136, v136, v137
    v_cvt_pk_bf16_f32 v137, v138, v139
    v_cvt_pk_bf16_f32 v138, v140, v141
    v_cvt_pk_bf16_f32 v139, v142, v143
    s_nop 0
    v_permlane16_swap_b32 v136, v138
    v_permlane16_swap_b32 v137, v139
    s_nop 1
    v_mfma_f32_32x32x16_bf16 v[64:79], v[96:99], v[136:139], v[168:183]
    v_mfma_f32_32x32x8_bf16 v[64:79], v[42:43], v[146:147], v[64:79]
    s_mov_b32 s50, 3256877056
    v_max3_f32 v148, v48, v49, v50
    v_max3_f32 v149, v51, v52, v53
    v_max3_f32 v148, v148, v54, v55
    v_max3_f32 v149, v149, v56, v57
    v_max3_f32 v148, v148, v58, v59
    v_max3_f32 v149, v149, v60, v61
    v_max3_f32 v148, v148, v62, v63
    v_max_f32 v148, v148, v149
    v_mov_b32 v149, v148
    s_nop 1
    v_permlane32_swap_b32 v148, v149
    v_max_f32 v148, v148, v149
    s_mov_b64 exec, s[60:61]
    v_cvt_pk_bf16_f32 v108, -v148, s50
    v_cvt_pk_bf16_f32 v144, -v148, s50
    s_mov_b64 exec, -1
    v_mfma_f32_32x32x8_bf16 v[48:63], v[40:41], v[108:109], v[48:63]
    v_max3_f32 v150, v64, v65, v66
    v_max3_f32 v151, v67, v68, v69
    s_nop 0
    s_cbranch_execz L_pfret
    v_max3_f32 v150, v150, v70, v71
    v_max3_f32 v151, v151, v72, v73
    v_max3_f32 v150, v150, v74, v75
    v_max3_f32 v151, v151, v76, v77
    v_max3_f32 v150, v150, v78, v79
    v_max_f32 v150, v150, v151
    v_mov_b32 v151, v150
    s_nop 1
    v_permlane32_swap_b32 v150, v151
    v_max_f32 v150, v150, v151
    s_mov_b64 exec, s[60:61]
    v_cvt_pk_bf16_f32 v110, -v150, s50
    v_cvt_pk_bf16_f32 v146, -v150, s50
    s_mov_b64 exec, -1
    v_mfma_f32_32x32x8_bf16 v[64:79], v[42:43], v[110:111], v[64:79]
    s_cmp_lg_u32 s70, 0
    s_cbranch_scc1 L_tr2
    s_waitcnt vmcnt(0)
    v_min_u32 v254, v254, v255
    s_nop 0
    v_readfirstlane_b32 s46, v254
    s_nop 0
    s_cmp_eq_u32 s46, 0
    s_cbranch_scc1 L_tr2_re
    s_mul_i32 s46, s36, 10240
    s_add_u32 m0, s46, 0
    s_add_u32 s47, s68, 0
    buffer_load_dwordx4 v1, s[12:15], s47 offen offset:0 lds
    buffer_load_dwordx4 v1, s[12:15], s47 offen offset:1024 lds
    buffer_load_dwordx4 v1, s[12:15], s47 offen offset:2048 lds
    buffer_load_dwordx4 v1, s[12:15], s47 offen offset:3072 lds
    s_add_u32 m0, s46, 4096
    s_add_u32 s47, s68, 4096
    buffer_load_dwordx4 v1, s[12:15], s47 offen offset:0 lds
    buffer_load_dwordx4 v1, s[12:15], s47 offen offset:1024 lds
    buffer_load_dwordx4 v1, s[12:15], s47 offen offset:2048 lds
    buffer_load_dwordx4 v1, s[12:15], s47 offen offset:3072 lds
    s_add_u32 m0, s46, 8192
    s_add_u32 s47, s68, 8192
    buffer_load_dwordx4 v1, s[12:15], s47 offen offset:0 lds
    s_nop 0
    s_cbranch_execz L_pfret
    buffer_load_dwordx4 v1, s[12:15], s47 offen offset:1024 lds
    s_mov_b32 s70, 1
    s_branch L_tr2
L_tr2_re:
    buffer_load_dwordx2 v[254:255], off, s[12:15], s69 sc1
L_tr2:
    s_sub_u32 m0, 158720, s71
    s_nop 0
    buffer_load_dwordx4 v30, s[16:19], s43 offen offset:0 lds
    buffer_load_dwordx4 v31, s[16:19], s43 offen offset:1024 lds
    buffer_load_dwordx4 v32, s[16:19], s43 offen offset:2048 lds
    buffer_load_dwordx4 v33, s[16:19], s43 offen offset:3072 lds
    s_sub_u32 m0, 159744, s71
    s_nop 0
    buffer_load_dwordx4 v34, s[16:19], s43 offen offset:3072 lds
    v_exp_f32 v48, v48
    v_exp_f32 v49, v49
    v_exp_f32 v50, v50
    v_exp_f32 v51, v51
    v_exp_f32 v52, v52
    s_mov_b64 exec, s[62:63]
    ds_read_b128 v[92:95], v21 offset:40960
    ds_read_b128 v[100:103], v21 offset:41472
    s_mov_b64 exec, -1
    v_exp_f32 v53, v53
    v_exp_f32 v54, v54
    v_exp_f32 v55, v55
    v_cvt_pk_bf16_f32 v80, v48, v49
    v_cvt_pk_bf16_f32 v81, v50, v51
    v_cvt_pk_bf16_f32 v82, v52, v53
    v_cvt_pk_bf16_f32 v83, v54, v55
    s_bitcmp0_b32 1, s40
    s_cbranch_scc1 L_ev0
    s_cmp_lg_u32 s70, 0
    s_cbranch_scc1 L_pr0_1
    s_mov_b32 s48, 100000
L_pr0_1_lp:
    s_waitcnt vmcnt(0)
    v_min_u32 v254, v254, v255
    s_nop 0
    v_readfirstlane_b32 s46, v254
    buffer_load_dwordx2 v[254:255], off, s[12:15], s69 sc1
    s_sub_u32 s48, s48, 1
    s_cmp_eq_u32 s48, 0
    s_cselect_b32 s46, 1, s46
    s_cmp_eq_u32 s46, 0
    s_cbranch_scc1 L_pr0_1_lp
    s_mul_i32 s46, s36, 10240
    s_cbranch_execz L_pfret
    s_add_u32 m0, s46, 0
    s_add_u32 s47, s68, 0
    buffer_load_dwordx4 v1, s[12:15], s47 offen offset:0 lds
    buffer_load_dwordx4 v1, s[12:15], s47 offen offset:1024 lds
    buffer_load_dwordx4 v1, s[12:15], s47 offen offset:2048 lds
    buffer_load_dwordx4 v1, s[12:15], s47 offen offset:3072 lds
    s_add_u32 m0, s46, 4096
    s_add_u32 s47, s68, 4096
    buffer_load_dwordx4 v1, s[12:15], s47 offen offset:0 lds
    buffer_load_dwordx4 v1, s[12:15], s47 offen offset:1024 lds
    buffer_load_dwordx4 v1, s[12:15], s47 offen offset:2048 lds
    buffer_load_dwordx4 v1, s[12:15], s47 offen offset:3072 lds
    s_add_u32 m0, s46, 8192
    s_add_u32 s47, s68, 8192
    buffer_load_dwordx4 v1, s[12:15], s47 offen offset:0 lds
    buffer_load_dwordx4 v1, s[12:15], s47 offen offset:1024 lds
    s_mov_b32 s70, 1
    s_waitcnt vmcnt(0)
L_pr0_1:
    s_waitcnt vmcnt(5) lgkmcnt(0)
    s_barrier
    s_setprio 2
    v_mov_b64 v[156:157], -1
    v_mov_b64 v[158:159], -1
    buffer_store_dwordx4 v[156:159], v29, s[12:15], s73 offen sc1
    buffer_store_dwordx4 v[156:159], v29, s[12:15], s73 offen offset:512 sc1
    s_mov_b32 exec_hi, 0
    buffer_store_dwordx4 v[156:159], v29, s[12:15], s74 offen sc1
    s_mov_b32 exec_hi, -1
    s_nop 0
L_ev0:
    ds_read_b128 v[88:91], v11 offset:30720
    s_mov_b64 exec, s[58:59]
    ds_read_b128 v[44:47], v13 offset:30720
    s_mov_b64 exec, -1
    v_exp_f32 v56, v56
    v_exp_f32 v57, v57
    v_exp_f32 v58, v58
    v_exp_f32 v59, v59
    v_exp_f32 v60, v60
    v_exp_f32 v61, v61
    v_exp_f32 v62, v62
    v_exp_f32 v63, v63
    v_mfma_f32_32x32x16_bf16 v[200:215], v[2:5], v[80:83], 0
    s_nop 0
    s_cbranch_execz L_pfret
    v_cvt_pk_bf16_f32 v84, v56, v57
    v_cvt_pk_bf16_f32 v85, v58, v59
    v_cvt_pk_bf16_f32 v86, v60, v61
    v_cvt_pk_bf16_f32 v87, v62, v63
    v_exp_f32 v64, v64
    v_exp_f32 v65, v65
    v_mfma_f32_32x32x16_bf16 v[200:215], v[6:9], v[84:87], v[200:215]
    v_exp_f32 v66, v66
    v_exp_f32 v67, v67
    v_exp_f32 v68, v68
    s_waitcnt lgkmcnt(1)
    v_mfma_f32_32x32x16_bf16 v[48:63], v[88:91], v[128:131], 0
    s_mov_b64 exec, s[62:63]
    ds_read_b128 v[2:5], v19 offset:30720
    ds_read_b128 v[6:9], v19 offset:31232
    s_mov_b64 exec, -1
    v_exp_f32 v69, v69
    v_exp_f32 v70, v70
    v_exp_f32 v71, v71
    v_cvt_pk_bf16_f32 v232, v64, v65
    v_cvt_pk_bf16_f32 v233, v66, v67
    s_waitcnt lgkmcnt(2)
    v_mfma_f32_32x32x8_bf16 v[48:63], v[44:45], v[144:145], v[48:63]
    v_cvt_pk_bf16_f32 v234, v68, v69
    v_cvt_pk_bf16_f32 v235, v70, v71
    s_bitcmp0_b32 1, s40
    s_cbranch_scc1 L_ev1
    s_add_u32 m0, s71, 81920
    s_nop 0
    buffer_load_dwordx4 v30, s[16:19], s45 offen offset:0 lds
    buffer_load_dwordx4 v31, s[16:19], s45 offen offset:1024 lds
    buffer_load_dwordx4 v32, s[16:19], s45 offen offset:2048 lds
    s_nop 2
L_ev1:
    ds_read_b128 v[96:99], v11 offset:31744
    v_exp_f32 v72, v72
    v_exp_f32 v73, v73
    v_exp_f32 v74, v74
    v_exp_f32 v75, v75
    v_exp_f32 v76, v76
    v_exp_f32 v77, v77
    v_exp_f32 v78, v78
    v_exp_f32 v79, v79
    v_mfma_f32_32x32x16_bf16 v[216:231], v[92:95], v[232:235], 0
    s_nop 0
    s_cbranch_execz L_pfret
    v_cvt_pk_bf16_f32 v236, v72, v73
    v_cvt_pk_bf16_f32 v237, v74, v75
    v_cvt_pk_bf16_f32 v238, v76, v77
    v_cvt_pk_bf16_f32 v239, v78, v79
    v_exp_f32 v48, v48
    v_exp_f32 v49, v49
    v_mfma_f32_32x32x16_bf16 v[216:231], v[100:103], v[236:239], v[216:231]
    s_cmp_eq_u32 s67, 0
    s_cbranch_scc1 L_early
    v_exp_f32 v50, v50
    v_exp_f32 v51, v51
    v_exp_f32 v52, v52
    s_waitcnt lgkmcnt(0)
    v_mfma_f32_32x32x16_bf16 v[64:79], v[96:99], v[136:139], 0
    s_mov_b64 exec, s[62:63]
    ds_read_b128 v[92:95], v21 offset:30720
    ds_read_b128 v[100:103], v21 offset:31232
    s_mov_b64 exec, -1
    v_exp_f32 v53, v53
    v_exp_f32 v54, v54
    v_exp_f32 v55, v55
    v_cvt_pk_bf16_f32 v80, v48, v49
    v_cvt_pk_bf16_f32 v81, v50, v51
    v_mfma_f32_32x32x8_bf16 v[64:79], v[46:47], v[146:147], v[64:79]
    v_cvt_pk_bf16_f32 v82, v52, v53
    v_cvt_pk_bf16_f32 v83, v54, v55
    s_bitcmp0_b32 3, s40
    s_cbranch_scc1 L_ev2
    s_bitcmp0_b32 1, s40
    s_cbranch_scc1 L_ev2_0
    s_add_u32 m0, s71, 81920
    s_nop 0
    buffer_load_dwordx4 v33, s[16:19], s45 offen offset:3072 lds
    s_add_u32 m0, s71, 82944
    s_nop 0
    buffer_load_dwordx4 v34, s[16:19], s45 offen offset:3072 lds
    s_branch L_ev2
L_ev2_0:
    s_cmp_lg_u32 s70, 0
    s_cbranch_scc1 L_pr1_2
    s_mov_b32 s48, 100000
L_pr1_2_lp:
    s_waitcnt vmcnt(0)
    v_min_u32 v254, v254, v255
    s_nop 0
    v_readfirstlane_b32 s46, v254
    s_nop 0
    s_cbranch_execz L_pfret
    buffer_load_dwordx2 v[254:255], off, s[12:15], s69 sc1
    s_sub_u32 s48, s48, 1
    s_cmp_eq_u32 s48, 0
    s_cselect_b32 s46, 1, s46
    s_cmp_eq_u32 s46, 0
    s_cbranch_scc1 L_pr1_2_lp
    s_mul_i32 s46, s36, 10240
    s_add_u32 m0, s46, 0
    s_add_u32 s47, s68, 0
    buffer_load_dwordx4 v1, s[12:15], s47 offen offset:0 lds
    buffer_load_dwordx4 v1, s[12:15], s47 offen offset:1024 lds
    buffer_load_dwordx4 v1, s[12:15], s47 offen offset:2048 lds
    buffer_load_dwordx4 v1, s[12:15], s47 offen offset:3072 lds
    s_add_u32 m0, s46, 4096
    s_add_u32 s47, s68, 4096
    buffer_load_dwordx4 v1, s[12:15], s47 offen offset:0 lds
    buffer_load_dwordx4 v1, s[12:15], s47 offen offset:1024 lds
    buffer_load_dwordx4 v1, s[12:15], s47 offen offset:2048 lds
    buffer_load_dwordx4 v1, s[12:15], s47 offen offset:3072 lds
    s_add_u32 m0, s46, 8192
    s_add_u32 s47, s68, 8192
    buffer_load_dwordx4 v1, s[12:15], s47 offen offset:0 lds
    buffer_load_dwordx4 v1, s[12:15], s47 offen offset:1024 lds
    s_mov_b32 s70, 1
    s_waitcnt vmcnt(0)
L_pr1_2:
    s_waitcnt vmcnt(5) lgkmcnt(0)
    s_barrier
    s_setprio 2
    v_mov_b64 v[156:157], -1
    v_mov_b64 v[158:159], -1
    buffer_store_dwordx4 v[156:159], v29, s[12:15], s73 offen sc1
    buffer_store_dwordx4 v[156:159], v29, s[12:15], s73 offen offset:512 sc1
    s_mov_b32 exec_hi, 0
    buffer_store_dwordx4 v[156:159], v29, s[12:15], s74 offen sc1
    s_mov_b32 exec_hi, -1
    s_nop 0
L_ev2:
    ds_read_b128 v[88:91], v11 offset:20480
    s_mov_b64 exec, s[58:59]
    ds_read_b128 v[40:43], v13 offset:20480
    s_mov_b64 exec, -1
    v_exp_f32 v56, v56
    v_exp_f32 v57, v57
    s_cbranch_execz L_pfret
    v_exp_f32 v58, v58
    v_exp_f32 v59, v59
    v_exp_f32 v60, v60
    v_exp_f32 v61, v61
    v_exp_f32 v62, v62
    v_exp_f32 v63, v63
    v_mfma_f32_32x32x16_bf16 v[200:215], v[2:5], v[80:83], v[200:215]
    v_cvt_pk_bf16_f32 v84, v56, v57
    v_cvt_pk_bf16_f32 v85, v58, v59
    v_cvt_pk_bf16_f32 v86, v60, v61
    v_cvt_pk_bf16_f32 v87, v62, v63
    v_exp_f32 v64, v64
    v_exp_f32 v65, v65
    v_mfma_f32_32x32x16_bf16 v[200:215], v[6:9], v[84:87], v[200:215]
    v_exp_f32 v66, v66
    v_exp_f32 v67, v67
    v_exp_f32 v68, v68
    s_waitcnt lgkmcnt(1)
    v_mfma_f32_32x32x16_bf16 v[48:63], v[88:91], v[128:131], 0
    s_mov_b64 exec, s[62:63]
    ds_read_b128 v[2:5], v19 offset:20480
    ds_read_b128 v[6:9], v19 offset:20992
    s_mov_b64 exec, -1
    v_exp_f32 v69, v69
    v_exp_f32 v70, v70
    v_exp_f32 v71, v71
    v_cvt_pk_bf16_f32 v232, v64, v65
    v_cvt_pk_bf16_f32 v233, v66, v67
    s_waitcnt lgkmcnt(2)
    v_mfma_f32_32x32x8_bf16 v[48:63], v[40:41], v[144:145], v[48:63]
    v_cvt_pk_bf16_f32 v234, v68, v69
    v_cvt_pk_bf16_f32 v235, v70, v71
    s_bitcmp0_b32 2, s40
    s_cbranch_scc1 L_ev3
    s_add_u32 m0, s71, 81920
    s_nop 0
    buffer_load_dwordx4 v30, s[16:19], s45 offen offset:0 lds
    buffer_load_dwordx4 v31, s[16:19], s45 offen offset:1024 lds
    buffer_load_dwordx4 v32, s[16:19], s45 offen offset:2048 lds
    s_nop 2
L_ev3:
    ds_read_b128 v[96:99], v11 offset:21504
    v_exp_f32 v72, v72
    v_exp_f32 v73, v73
    v_exp_f32 v74, v74
    s_cbranch_execz L_pfret
    v_exp_f32 v75, v75
    v_exp_f32 v76, v76
    v_exp_f32 v77, v77
    v_exp_f32 v78, v78
    v_exp_f32 v79, v79
    v_mfma_f32_32x32x16_bf16 v[216:231], v[92:95], v[232:235], v[216:231]
    v_cvt_pk_bf16_f32 v236, v72, v73
    v_cvt_pk_bf16_f32 v237, v74, v75
    v_cvt_pk_bf16_f32 v238, v76, v77
    v_cvt_pk_bf16_f32 v239, v78, v79
    v_exp_f32 v48, v48
    v_exp_f32 v49, v49
    v_mfma_f32_32x32x16_bf16 v[216:231], v[100:103], v[236:239], v[216:231]
    s_cmp_eq_u32 s67, 1
    s_cbranch_scc1 L_early
    v_exp_f32 v50, v50
    v_exp_f32 v51, v51
    v_exp_f32 v52, v52
    s_waitcnt lgkmcnt(0)
    v_mfma_f32_32x32x16_bf16 v[64:79], v[96:99], v[136:139], 0
    s_mov_b64 exec, s[62:63]
    ds_read_b128 v[92:95], v21 offset:20480
    ds_read_b128 v[100:103], v21 offset:20992
    s_mov_b64 exec, -1
    v_exp_f32 v53, v53
    v_exp_f32 v54, v54
    v_exp_f32 v55, v55
    v_cvt_pk_bf16_f32 v80, v48, v49
    v_cvt_pk_bf16_f32 v81, v50, v51
    v_mfma_f32_32x32x8_bf16 v[64:79], v[42:43], v[146:147], v[64:79]
    v_cvt_pk_bf16_f32 v82, v52, v53
    v_cvt_pk_bf16_f32 v83, v54, v55
    s_bitcmp0_b32 6, s40
    s_cbranch_scc1 L_ev4
    s_bitcmp0_b32 2, s40
    s_cbranch_scc1 L_ev4_0
    s_add_u32 m0, s71, 81920
    s_nop 0
    buffer_load_dwordx4 v33, s[16:19], s45 offen offset:3072 lds
    s_add_u32 m0, s71, 82944
    s_nop 0
    buffer_load_dwordx4 v34, s[16:19], s45 offen offset:3072 lds
    s_branch L_ev4
L_ev4_0:
    s_cmp_lg_u32 s70, 0
    s_cbranch_scc1 L_pr2_3
    s_cbranch_execz L_pfret
    s_mov_b32 s48, 100000
L_pr2_3_lp:
    s_waitcnt vmcnt(0)
    v_min_u32 v254, v254, v255
    s_nop 0
    v_readfirstlane_b32 s46, v254
    buffer_load_dwordx2 v[254:255], off, s[12:15], s69 sc1
    s_sub_u32 s48, s48, 1
    s_cmp_eq_u32 s48, 0
    s_cselect_b32 s46, 1, s46
    s_cmp_eq_u32 s46, 0
    s_cbranch_scc1 L_pr2_3_lp
    s_mul_i32 s46, s36, 10240
    s_add_u32 m0, s46, 0
    s_add_u32 s47, s68, 0
    buffer_load_dwordx4 v1, s[12:15], s47 offen offset:0 lds
    buffer_load_dwordx4 v1, s[12:15], s47 offen offset:1024 lds
    buffer_load_dwordx4 v1, s[12:15], s47 offen offset:2048 lds
    buffer_load_dwordx4 v1, s[12:15], s47 offen offset:3072 lds
    s_add_u32 m0, s46, 4096
    s_add_u32 s47, s68, 4096
    buffer_load_dwordx4 v1, s[12:15], s47 offen offset:0 lds
    buffer_load_dwordx4 v1, s[12:15], s47 offen offset:1024 lds
    buffer_load_dwordx4 v1, s[12:15], s47 offen offset:2048 lds
    buffer_load_dwordx4 v1, s[12:15], s47 offen offset:3072 lds
    s_add_u32 m0, s46, 8192
    s_add_u32 s47, s68, 8192
    buffer_load_dwordx4 v1, s[12:15], s47 offen offset:0 lds
    buffer_load_dwordx4 v1, s[12:15], s47 offen offset:1024 lds
    s_mov_b32 s70, 1
    s_waitcnt vmcnt(0)
L_pr2_3:
    s_waitcnt vmcnt(5) lgkmcnt(0)
    s_barrier
    s_setprio 1
    v_mov_b64 v[156:157], -1
    v_mov_b64 v[158:159], -1
    buffer_store_dwordx4 v[156:159], v29, s[12:15], s73 offen sc1
    buffer_store_dwordx4 v[156:159], v29, s[12:15], s73 offen offset:512 sc1
    s_mov_b32 exec_hi, 0
    buffer_store_dwordx4 v[156:159], v29, s[12:15], s74 offen sc1
    s_mov_b32 exec_hi, -1
    s_nop 0
L_ev4:
    ds_read_b128 v[88:91], v11 offset:10240
    s_cbranch_execz L_pfret
    s_mov_b64 exec, s[58:59]
    ds_read_b128 v[44:47], v13 offset:10240
    s_mov_b64 exec, -1
    v_exp_f32 v56, v56
    v_exp_f32 v57, v57
    v_exp_f32 v58, v58
    v_exp_f32 v59, v59
    v_exp_f32 v60, v60
    v_exp_f32 v61, v61
    v_exp_f32 v62, v62
    v_exp_f32 v63, v63
    v_mfma_f32_32x32x16_bf16 v[200:215], v[2:5], v[80:83], v[200:215]
    v_cvt_pk_bf16_f32 v84, v56, v57
    v_cvt_pk_bf16_f32 v85, v58, v59
    v_cvt_pk_bf16_f32 v86, v60, v61
    v_cvt_pk_bf16_f32 v87, v62, v63
    v_exp_f32 v64, v64
    v_exp_f32 v65, v65
    v_mfma_f32_32x32x16_bf16 v[200:215], v[6:9], v[84:87], v[200:215]
    v_exp_f32 v66, v66
    v_exp_f32 v67, v67
    v_exp_f32 v68, v68
    s_waitcnt lgkmcnt(1)
    v_mfma_f32_32x32x16_bf16 v[48:63], v[88:91], v[128:131], 0
    s_mov_b64 exec, s[62:63]
    ds_read_b128 v[2:5], v19 offset:10240
    ds_read_b128 v[6:9], v19 offset:10752
    s_mov_b64 exec, -1
    v_exp_f32 v69, v69
    v_exp_f32 v70, v70
    v_exp_f32 v71, v71
    v_cvt_pk_bf16_f32 v232, v64, v65
    v_cvt_pk_bf16_f32 v233, v66, v67
    s_waitcnt lgkmcnt(2)
    v_mfma_f32_32x32x8_bf16 v[48:63], v[44:45], v[144:145], v[48:63]
    v_cvt_pk_bf16_f32 v234, v68, v69
    v_cvt_pk_bf16_f32 v235, v70, v71
    s_bitcmp0_b32 4, s40
    s_cbranch_scc1 L_ev5
    s_add_u32 m0, s71, 81920
    s_nop 0
    buffer_load_dwordx4 v30, s[16:19], s45 offen offset:0 lds
    buffer_load_dwordx4 v31, s[16:19], s45 offen offset:1024 lds
    buffer_load_dwordx4 v32, s[16:19], s45 offen offset:2048 lds
    s_cbranch_execz L_pfret
    s_nop 2
L_ev5:
    ds_read_b128 v[96:99], v11 offset:11264
    v_exp_f32 v72, v72
    v_exp_f32 v73, v73
    v_exp_f32 v74, v74
    v_exp_f32 v75, v75
    v_exp_f32 v76, v76
    v_exp_f32 v77, v77
    v_exp_f32 v78, v78
    v_exp_f32 v79, v79
    v_mfma_f32_32x32x16_bf16 v[216:231], v[92:95], v[232:235], v[216:231]
    v_cvt_pk_bf16_f32 v236, v72, v73
    v_cvt_pk_bf16_f32 v237, v74, v75
    v_cvt_pk_bf16_f32 v238, v76, v77
    v_cvt_pk_bf16_f32 v239, v78, v79
    v_exp_f32 v48, v48
    v_exp_f32 v49, v49
    v_mfma_f32_32x32x16_bf16 v[216:231], v[100:103], v[236:239], v[216:231]
    s_cmp_eq_u32 s67, 2
    s_cbranch_scc1 L_early
    v_exp_f32 v50, v50
    v_exp_f32 v51, v51
    v_exp_f32 v52, v52
    s_waitcnt lgkmcnt(0)
    v_mfma_f32_32x32x16_bf16 v[64:79], v[96:99], v[136:139], 0
    s_mov_b64 exec, s[62:63]
    ds_read_b128 v[92:95], v21 offset:10240
    ds_read_b128 v[100:103], v21 offset:10752
    s_mov_b64 exec, -1
    v_exp_f32 v53, v53
    v_exp_f32 v54, v54
    v_exp_f32 v55, v55
    v_cvt_pk_bf16_f32 v80, v48, v49
    v_cvt_pk_bf16_f32 v81, v50, v51
    v_mfma_f32_32x32x8_bf16 v[64:79], v[46:47], v[146:147], v[64:79]
    v_cvt_pk_bf16_f32 v82, v52, v53
    v_cvt_pk_bf16_f32 v83, v54, v55
    s_bitcmp0_b32 12, s40
    s_cbranch_scc1 L_ev6
    s_bitcmp0_b32 4, s40
    s_cbranch_scc1 L_ev6_0
    s_add_u32 m0, s71, 81920
    s_nop 0
    buffer_load_dwordx4 v33, s[16:19], s45 offen offset:3072 lds
    s_add_u32 m0, s71, 82944
    s_cbranch_execz L_pfret
    s_nop 0
    buffer_load_dwordx4 v34, s[16:19], s45 offen offset:3072 lds
    s_branch L_ev6
L_ev6_0:
    s_cmp_lg_u32 s70, 0
    s_cbranch_scc1 L_pr3_4
    s_mov_b32 s48, 100000
L_pr3_4_lp:
    s_waitcnt vmcnt(0)
    v_min_u32 v254, v254, v255
    s_nop 0
    v_readfirstlane_b32 s46, v254
    buffer_load_dwordx2 v[254:255], off, s[12:15], s69 sc1
    s_sub_u32 s48, s48, 1
    s_cmp_eq_u32 s48, 0
    s_cselect_b32 s46, 1, s46
    s_cmp_eq_u32 s46, 0
    s_cbranch_scc1 L_pr3_4_lp
    s_mul_i32 s46, s36, 10240
    s_add_u32 m0, s46, 0
    s_add_u32 s47, s68, 0
    buffer_load_dwordx4 v1, s[12:15], s47 offen offset:0 lds
    buffer_load_dwordx4 v1, s[12:15], s47 offen offset:1024 lds
    buffer_load_dwordx4 v1, s[12:15], s47 offen offset:2048 lds
    buffer_load_dwordx4 v1, s[12:15], s47 offen offset:3072 lds
    s_add_u32 m0, s46, 4096
    s_add_u32 s47, s68, 4096
    buffer_load_dwordx4 v1, s[12:15], s47 offen offset:0 lds
    buffer_load_dwordx4 v1, s[12:15], s47 offen offset:1024 lds
    buffer_load_dwordx4 v1, s[12:15], s47 offen offset:2048 lds
    buffer_load_dwordx4 v1, s[12:15], s47 offen offset:3072 lds
    s_add_u32 m0, s46, 8192
    s_add_u32 s47, s68, 8192
    buffer_load_dwordx4 v1, s[12:15], s47 offen offset:0 lds
    buffer_load_dwordx4 v1, s[12:15], s47 offen offset:1024 lds
    s_mov_b32 s70, 1
    s_waitcnt vmcnt(0)
L_pr3_4:
    s_waitcnt vmcnt(5) lgkmcnt(0)
    s_barrier
    s_setprio 1
    v_mov_b64 v[156:157], -1
    v_mov_b64 v[158:159], -1
    buffer_store_dwordx4 v[156:159], v29, s[12:15], s73 offen sc1
    buffer_store_dwordx4 v[156:159], v29, s[12:15], s73 offen offset:512 sc1
    s_mov_b32 exec_hi, 0
    s_cbranch_execz L_pfret
    buffer_store_dwordx4 v[156:159], v29, s[12:15], s74 offen sc1
    s_mov_b32 exec_hi, -1
    s_nop 0
L_ev6:
    ds_read_b128 v[88:91], v11 offset:0
    s_mov_b64 exec, s[58:59]
    ds_read_b128 v[40:43], v13 offset:0
    s_mov_b64 exec, -1
    v_exp_f32 v56, v56
    v_exp_f32 v57, v57
    v_exp_f32 v58, v58
    v_exp_f32 v59, v59
    v_exp_f32 v60, v60
    v_exp_f32 v61, v61
    v_exp_f32 v62, v62
    v_exp_f32 v63, v63
    v_mfma_f32_32x32x16_bf16 v[200:215], v[2:5], v[80:83], v[200:215]
    v_cvt_pk_bf16_f32 v84, v56, v57
    v_cvt_pk_bf16_f32 v85, v58, v59
    v_cvt_pk_bf16_f32 v86, v60, v61
    v_cvt_pk_bf16_f32 v87, v62, v63
    v_exp_f32 v64, v64
    v_exp_f32 v65, v65
    v_mfma_f32_32x32x16_bf16 v[200:215], v[6:9], v[84:87], v[200:215]
    v_exp_f32 v66, v66
    v_exp_f32 v67, v67
    v_exp_f32 v68, v68
    s_waitcnt lgkmcnt(1)
    v_mfma_f32_32x32x16_bf16 v[48:63], v[88:91], v[128:131], 0
    s_mov_b64 exec, s[62:63]
    ds_read_b128 v[2:5], v19 offset:0
    ds_read_b128 v[6:9], v19 offset:512
    s_mov_b64 exec, -1
    v_exp_f32 v69, v69
    v_exp_f32 v70, v70
    v_exp_f32 v71, v71
    v_cvt_pk_bf16_f32 v232, v64, v65
    v_cvt_pk_bf16_f32 v233, v66, v67
    s_waitcnt lgkmcnt(2)
    v_mfma_f32_32x32x8_bf16 v[48:63], v[40:41], v[144:145], v[48:63]
    v_cvt_pk_bf16_f32 v234, v68, v69
    v_cvt_pk_bf16_f32 v235, v70, v71
    s_bitcmp0_b32 8, s40
    s_cbranch_scc1 L_ev7
    s_add_u32 m0, s71, 81920
    s_nop 0
    s_cbranch_execz L_pfret
    buffer_load_dwordx4 v30, s[16:19], s45 offen offset:0 lds
    buffer_load_dwordx4 v31, s[16:19], s45 offen offset:1024 lds
    buffer_load_dwordx4 v32, s[16:19], s45 offen offset:2048 lds
    s_nop 2
L_ev7:
    ds_read_b128 v[96:99], v11 offset:1024
    v_exp_f32 v72, v72
    v_exp_f32 v73, v73
    v_exp_f32 v74, v74
    v_exp_f32 v75, v75
    v_exp_f32 v76, v76
    v_exp_f32 v77, v77
    v_exp_f32 v78, v78
    v_exp_f32 v79, v79
    v_mfma_f32_32x32x16_bf16 v[216:231], v[92:95], v[232:235], v[216:231]
    v_cvt_pk_bf16_f32 v236, v72, v73
    v_cvt_pk_bf16_f32 v237, v74, v75
    v_cvt_pk_bf16_f32 v238, v76, v77
    v_cvt_pk_bf16_f32 v239, v78, v79
    v_exp_f32 v48, v48
    v_exp_f32 v49, v49
    v_mfma_f32_32x32x16_bf16 v[216:231], v[100:103], v[236:239], v[216:231]
    s_cmp_eq_u32 s67, 3
    s_cbranch_scc1 L_early
    v_exp_f32 v50, v50
    v_exp_f32 v51, v51
    v_exp_f32 v52, v52
    s_waitcnt lgkmcnt(0)
    v_mfma_f32_32x32x16_bf16 v[64:79], v[96:99], v[136:139], 0
    s_mov_b64 exec, s[62:63]
    ds_read_b128 v[92:95], v21 offset:0
    ds_read_b128 v[100:103], v21 offset:512
    s_mov_b64 exec, -1
    v_exp_f32 v53, v53
    v_exp_f32 v54, v54
    v_exp_f32 v55, v55
    v_cvt_pk_bf16_f32 v80, v48, v49
    v_cvt_pk_bf16_f32 v81, v50, v51
    v_mfma_f32_32x32x8_bf16 v[64:79], v[42:43], v[146:147], v[64:79]
    v_cvt_pk_bf16_f32 v82, v52, v53
    v_cvt_pk_bf16_f32 v83, v54, v55
    s_bitcmp0_b32 13, s40
    s_cbranch_scc1 L_ev8
    s_bitcmp0_b32 5, s40
    s_cbranch_scc1 L_ev8_0
    s_waitcnt lgkmcnt(0)
    s_cbranch_execz L_pfret
    s_barrier
    s_waitcnt vmcnt(5)
    v_lshlrev_b32 v160, 10, v0
    v_mov_b32 v161, 1
    s_mov_b64 exec, 0xff
    s_bitcmp1_b32 s3, 0
    s_cbranch_scc0 L_h1c1
    buffer_store_dword v161, v160, s[12:15], s76 offen offset:256
    s_branch L_h1d1
L_h1c1:
    buffer_store_dword v161, v160, s[12:15], s76 offen offset:256 sc1
L_h1d1:
    s_mov_b64 exec, -1
    s_mov_b32 m0, s101
    s_mov_b64 exec, s[58:59]
    buffer_load_dwordx4 v32, s[16:19], s77 offen offset:2048 lds
    s_mov_b64 exec, -1
    s_mul_i32 s49, s41, 3072
    s_add_u32 m0, s49, s101
    s_nop 0
    buffer_load_dwordx4 v252, s[16:19], s77 offen lds
    buffer_load_dwordx4 v253, s[16:19], s77 offen offset:1024 lds
    s_branch L_ev8
L_ev8_0:
    s_add_u32 m0, s71, 81920
    s_nop 0
    buffer_load_dwordx4 v33, s[16:19], s45 offen offset:3072 lds
    s_add_u32 m0, s71, 82944
    s_nop 0
    buffer_load_dwordx4 v34, s[16:19], s45 offen offset:3072 lds
    s_nop 1
L_ev8:
    ds_read_b128 v[88:91], v10 offset:30720
    s_mov_b64 exec, s[58:59]
    ds_read_b128 v[44:47], v12 offset:30720
    s_mov_b64 exec, -1
    v_exp_f32 v56, v56
    v_exp_f32 v57, v57
    v_exp_f32 v58, v58
    v_exp_f32 v59, v59
    v_exp_f32 v60, v60
    v_exp_f32 v61, v61
    v_exp_f32 v62, v62
    v_exp_f32 v63, v63
    v_mfma_f32_32x32x16_bf16 v[200:215], v[2:5], v[80:83], v[200:215]
    v_cvt_pk_bf16_f32 v84, v56, v57
    v_cvt_pk_bf16_f32 v85, v58, v59
    v_cvt_pk_bf16_f32 v86, v60, v61
    v_cvt_pk_bf16_f32 v87, v62, v63
    s_cbranch_execz L_pfret
    v_exp_f32 v64, v64
    v_exp_f32 v65, v65
    v_mfma_f32_32x32x16_bf16 v[200:215], v[6:9], v[84:87], v[200:215]
    v_exp_f32 v66, v66
    v_exp_f32 v67, v67
    v_exp_f32 v68, v68
    s_waitcnt lgkmcnt(1)
    v_mfma_f32_32x32x16_bf16 v[48:63], v[88:91], v[128:131], 0
    s_mov_b64 exec, s[62:63]
    ds_read_b128 v[2:5], v18 offset:30720
    ds_read_b128 v[6:9], v18 offset:31232
    s_mov_b64 exec, -1
    v_exp_f32 v69, v69
    v_exp_f32 v70, v70
    v_exp_f32 v71, v71
    v_cvt_pk_bf16_f32 v232, v64, v65
    v_cvt_pk_bf16_f32 v233, v66, v67
    s_waitcnt lgkmcnt(2)
    v_mfma_f32_32x32x8_bf16 v[48:63], v[44:45], v[144:145], v[48:63]
    v_cvt_pk_bf16_f32 v234, v68, v69
    v_cvt_pk_bf16_f32 v235, v70, v71
    ds_read_b128 v[96:99], v10 offset:31744
    v_exp_f32 v72, v72
    v_exp_f32 v73, v73
    v_exp_f32 v74, v74
    v_exp_f32 v75, v75
    v_exp_f32 v76, v76
    v_exp_f32 v77, v77
    v_exp_f32 v78, v78
    v_exp_f32 v79, v79
    v_mfma_f32_32x32x16_bf16 v[216:231], v[92:95], v[232:235], v[216:231]
    v_cvt_pk_bf16_f32 v236, v72, v73
    v_cvt_pk_bf16_f32 v237, v74, v75
    v_cvt_pk_bf16_f32 v238, v76, v77
    v_cvt_pk_bf16_f32 v239, v78, v79
    v_exp_f32 v48, v48
    v_exp_f32 v49, v49
    v_mfma_f32_32x32x16_bf16 v[216:231], v[100:103], v[236:239], v[216:231]
    s_cmp_eq_u32 s67, 4
    s_cbranch_scc1 L_early2
    v_exp_f32 v50, v50
    v_exp_f32 v51, v51
    v_exp_f32 v52, v52
    s_waitcnt lgkmcnt(0)
    v_mfma_f32_32x32x16_bf16 v[64:79], v[96:99], v[136:139], 0
    s_mov_b64 exec, s[62:63]
    s_cbranch_execz L_pfret
    ds_read_b128 v[92:95], v20 offset:30720
    ds_read_b128 v[100:103], v20 offset:31232
    s_mov_b64 exec, -1
    v_exp_f32 v53, v53
    v_exp_f32 v54, v54
    v_exp_f32 v55, v55
    v_cvt_pk_bf16_f32 v80, v48, v49
    v_cvt_pk_bf16_f32 v81, v50, v51
    v_mfma_f32_32x32x8_bf16 v[64:79], v[46:47], v[146:147], v[64:79]
    v_cvt_pk_bf16_f32 v82, v52, v53
    v_cvt_pk_bf16_f32 v83, v54, v55
    s_bitcmp0_b32 14, s40
    s_cbranch_scc1 L_ev10
    s_bitcmp0_b32 10, s40
    s_cbranch_scc1 L_ev10_0
    s_waitcnt lgkmcnt(0)
    s_barrier
    s_waitcnt vmcnt(5)
    v_lshlrev_b32 v160, 10, v0
    v_mov_b32 v161, 1
    s_mov_b64 exec, 0xff
    s_bitcmp1_b32 s3, 0
    s_cbranch_scc0 L_h1c2
    buffer_store_dword v161, v160, s[12:15], s76 offen offset:256
    s_branch L_h1d2
L_h1c2:
    buffer_store_dword v161, v160, s[12:15], s76 offen offset:256 sc1
L_h1d2:
    s_mov_b64 exec, -1
    s_mov_b32 m0, s101
    s_mov_b64 exec, s[58:59]
    buffer_load_dwordx4 v32, s[16:19], s77 offen offset:2048 lds
    s_mov_b64 exec, -1
    s_mul_i32 s49, s41, 3072
    s_add_u32 m0, s49, s101
    s_nop 0
    buffer_load_dwordx4 v252, s[16:19], s77 offen lds
    buffer_load_dwordx4 v253, s[16:19], s77 offen offset:1024 lds
    s_branch L_ev10
L_ev10_0:
    s_waitcnt vmcnt(0)
    s_barrier
    s_nop 5
L_ev10:
    ds_read_b128 v[88:91], v10 offset:20480
    s_mov_b64 exec, s[58:59]
    ds_read_b128 v[40:43], v12 offset:20480
    s_mov_b64 exec, -1
    v_exp_f32 v56, v56
    v_exp_f32 v57, v57
    v_exp_f32 v58, v58
    s_cbranch_execz L_pfret
    v_exp_f32 v59, v59
    v_exp_f32 v60, v60
    v_exp_f32 v61, v61
    v_exp_f32 v62, v62
    v_exp_f32 v63, v63
    v_mfma_f32_32x32x16_bf16 v[200:215], v[2:5], v[80:83], v[200:215]
    v_cvt_pk_bf16_f32 v84, v56, v57
    v_cvt_pk_bf16_f32 v85, v58, v59
    v_cvt_pk_bf16_f32 v86, v60, v61
    v_cvt_pk_bf16_f32 v87, v62, v63
    v_exp_f32 v64, v64
    v_exp_f32 v65, v65
    v_mfma_f32_32x32x16_bf16 v[200:215], v[6:9], v[84:87], v[200:215]
    v_exp_f32 v66, v66
    v_exp_f32 v67, v67
    v_exp_f32 v68, v68
    s_waitcnt lgkmcnt(1)
    v_mfma_f32_32x32x16_bf16 v[48:63], v[88:91], v[128:131], 0
    s_mov_b64 exec, s[62:63]
    ds_read_b128 v[2:5], v18 offset:20480
    ds_read_b128 v[6:9], v18 offset:20992
    s_mov_b64 exec, -1
    v_exp_f32 v69, v69
    v_exp_f32 v70, v70
    v_exp_f32 v71, v71
    v_cvt_pk_bf16_f32 v232, v64, v65
    v_cvt_pk_bf16_f32 v233, v66, v67
    s_waitcnt lgkmcnt(2)
    v_mfma_f32_32x32x8_bf16 v[48:63], v[40:41], v[144:145], v[48:63]
    v_cvt_pk_bf16_f32 v234, v68, v69
    v_cvt_pk_bf16_f32 v235, v70, v71
    ds_read_b128 v[96:99], v10 offset:21504
    v_exp_f32 v72, v72
    v_exp_f32 v73, v73
    v_exp_f32 v74, v74
    v_exp_f32 v75, v75
    v_exp_f32 v76, v76
    v_exp_f32 v77, v77
    v_exp_f32 v78, v78
    v_exp_f32 v79, v79
    v_mfma_f32_32x32x16_bf16 v[216:231], v[92:95], v[232:235], v[216:231]
    v_cvt_pk_bf16_f32 v236, v72, v73
    v_cvt_pk_bf16_f32 v237, v74, v75
    v_cvt_pk_bf16_f32 v238, v76, v77
    s_cbranch_execz L_pfret
    v_cvt_pk_bf16_f32 v239, v78, v79
    v_exp_f32 v48, v48
    v_exp_f32 v49, v49
    v_mfma_f32_32x32x16_bf16 v[216:231], v[100:103], v[236:239], v[216:231]
    s_cmp_eq_u32 s67, 5
    s_cbranch_scc1 L_early2
    v_exp_f32 v50, v50
    v_exp_f32 v51, v51
    v_exp_f32 v52, v52
    s_waitcnt lgkmcnt(0)
    v_mfma_f32_32x32x16_bf16 v[64:79], v[96:99], v[136:139], 0
    s_mov_b64 exec, s[62:63]
    ds_read_b128 v[92:95], v20 offset:20480
    ds_read_b128 v[100:103], v20 offset:20992
    s_mov_b64 exec, -1
    v_exp_f32 v53, v53
    v_exp_f32 v54, v54
    v_exp_f32 v55, v55
    v_cvt_pk_bf16_f32 v80, v48, v49
    v_cvt_pk_bf16_f32 v81, v50, v51
    v_mfma_f32_32x32x8_bf16 v[64:79], v[42:43], v[146:147], v[64:79]
    v_cvt_pk_bf16_f32 v82, v52, v53
    v_cvt_pk_bf16_f32 v83, v54, v55
    s_bitcmp0_b32 8, s40
    s_cbranch_scc1 L_ev12
    s_waitcnt vmcnt(0)
    s_barrier
    s_nop 5
L_ev12:
    ds_read_b128 v[88:91], v10 offset:10240
    s_mov_b64 exec, s[58:59]
    ds_read_b128 v[44:47], v12 offset:10240
    s_mov_b64 exec, -1
    v_exp_f32 v56, v56
    v_exp_f32 v57, v57
    v_exp_f32 v58, v58
    v_exp_f32 v59, v59
    v_exp_f32 v60, v60
    v_exp_f32 v61, v61
    v_exp_f32 v62, v62
    v_exp_f32 v63, v63
    v_mfma_f32_32x32x16_bf16 v[200:215], v[2:5], v[80:83], v[200:215]
    v_cvt_pk_bf16_f32 v84, v56, v57
    v_cvt_pk_bf16_f32 v85, v58, v59
    v_cvt_pk_bf16_f32 v86, v60, v61
    v_cvt_pk_bf16_f32 v87, v62, v63
    v_exp_f32 v64, v64
    s_cbranch_execz L_pfret
    v_exp_f32 v65, v65
    v_mfma_f32_32x32x16_bf16 v[200:215], v[6:9], v[84:87], v[200:215]
    v_exp_f32 v66, v66
    v_exp_f32 v67, v67
    v_exp_f32 v68, v68
    s_waitcnt lgkmcnt(1)
    v_mfma_f32_32x32x16_bf16 v[48:63], v[88:91], v[128:131], 0
    s_mov_b64 exec, s[62:63]
    ds_read_b128 v[2:5], v18 offset:10240
    ds_read_b128 v[6:9], v18 offset:10752
    s_mov_b64 exec, -1
    v_exp_f32 v69, v69
    v_exp_f32 v70, v70
    v_exp_f32 v71, v71
    v_cvt_pk_bf16_f32 v232, v64, v65
    v_cvt_pk_bf16_f32 v233, v66, v67
    s_waitcnt lgkmcnt(2)
    v_mfma_f32_32x32x8_bf16 v[48:63], v[44:45], v[144:145], v[48:63]
    v_cvt_pk_bf16_f32 v234, v68, v69
    v_cvt_pk_bf16_f32 v235, v70, v71
    ds_read_b128 v[96:99], v10 offset:11264
    v_exp_f32 v72, v72
    v_exp_f32 v73, v73
    v_exp_f32 v74, v74
    v_exp_f32 v75, v75
    v_exp_f32 v76, v76
    v_exp_f32 v77, v77
    v_exp_f32 v78, v78
    v_exp_f32 v79, v79
    v_mfma_f32_32x32x16_bf16 v[216:231], v[92:95], v[232:235], v[216:231]
    v_cvt_pk_bf16_f32 v236, v72, v73
    v_cvt_pk_bf16_f32 v237, v74, v75
    v_cvt_pk_bf16_f32 v238, v76, v77
    v_cvt_pk_bf16_f32 v239, v78, v79
    v_exp_f32 v48, v48
    v_exp_f32 v49, v49
    v_mfma_f32_32x32x16_bf16 v[216:231], v[100:103], v[236:239], v[216:231]
    s_cmp_eq_u32 s67, 6
    s_cbranch_scc1 L_early3
    v_exp_f32 v50, v50
    v_exp_f32 v51, v51
    v_exp_f32 v52, v52
    s_waitcnt lgkmcnt(0)
    v_mfma_f32_32x32x16_bf16 v[64:79], v[96:99], v[136:139], 0
    s_mov_b64 exec, s[62:63]
    s_nop 0
    s_cbranch_execz L_pfret
    ds_read_b128 v[92:95], v20 offset:10240
    ds_read_b128 v[100:103], v20 offset:10752
    s_mov_b64 exec, -1
    v_exp_f32 v53, v53
    v_exp_f32 v54, v54
    v_exp_f32 v55, v55
    v_cvt_pk_bf16_f32 v80, v48, v49
    v_cvt_pk_bf16_f32 v81, v50, v51
    v_mfma_f32_32x32x8_bf16 v[64:79], v[46:47], v[146:147], v[64:79]
    v_cvt_pk_bf16_f32 v82, v52, v53
    v_cvt_pk_bf16_f32 v83, v54, v55
    ds_read_b128 v[88:91], v10 offset:0
    s_mov_b64 exec, s[58:59]
    ds_read_b128 v[40:43], v12 offset:0
    s_mov_b64 exec, -1
    v_exp_f32 v56, v56
    v_exp_f32 v57, v57
    v_exp_f32 v58, v58
    v_exp_f32 v59, v59
    v_exp_f32 v60, v60
    v_exp_f32 v61, v61
    v_exp_f32 v62, v62
    v_exp_f32 v63, v63
    v_mfma_f32_32x32x16_bf16 v[200:215], v[2:5], v[80:83], v[200:215]
    v_cvt_pk_bf16_f32 v84, v56, v57
    v_cvt_pk_bf16_f32 v85, v58, v59
    v_cvt_pk_bf16_f32 v86, v60, v61
    v_cvt_pk_bf16_f32 v87, v62, v63
    v_exp_f32 v64, v64
    v_exp_f32 v65, v65
    v_mfma_f32_32x32x16_bf16 v[200:215], v[6:9], v[84:87], v[200:215]
    v_exp_f32 v66, v66
    v_exp_f32 v67, v67
    v_exp_f32 v68, v68
    s_waitcnt lgkmcnt(1)
    v_mfma_f32_32x32x16_bf16 v[48:63], v[88:91], v[128:131], v[184:199]
    s_mov_b64 exec, s[62:63]
    ds_read_b128 v[2:5], v18 offset:0
    ds_read_b128 v[6:9], v18 offset:512
    s_mov_b64 exec, -1
    v_exp_f32 v69, v69
    v_exp_f32 v70, v70
    v_exp_f32 v71, v71
    v_cvt_pk_bf16_f32 v232, v64, v65
    s_cbranch_execz L_pfret
    v_cvt_pk_bf16_f32 v233, v66, v67
    s_waitcnt lgkmcnt(2)
    v_mfma_f32_32x32x8_bf16 v[48:63], v[40:41], v[144:145], v[48:63]
    v_cvt_pk_bf16_f32 v234, v68, v69
    v_cvt_pk_bf16_f32 v235, v70, v71
    ds_read_b128 v[96:99], v10 offset:1024
    v_exp_f32 v72, v72
    v_exp_f32 v73, v73
    v_exp_f32 v74, v74
    v_exp_f32 v75, v75
    v_exp_f32 v76, v76
    v_exp_f32 v77, v77
    v_exp_f32 v78, v78
    v_exp_f32 v79, v79
    v_mfma_f32_32x32x16_bf16 v[216:231], v[92:95], v[232:235], v[216:231]
    v_cvt_pk_bf16_f32 v236, v72, v73
    v_cvt_pk_bf16_f32 v237, v74, v75
    v_cvt_pk_bf16_f32 v238, v76, v77
    v_cvt_pk_bf16_f32 v239, v78, v79
    v_exp_f32 v48, v48
    v_exp_f32 v49, v49
    v_mfma_f32_32x32x16_bf16 v[216:231], v[100:103], v[236:239], v[216:231]
    s_cmp_eq_u32 s67, 7
    s_cbranch_scc1 L_early3
    v_exp_f32 v50, v50
    v_exp_f32 v51, v51
    v_exp_f32 v52, v52
    s_waitcnt lgkmcnt(0)
    v_mfma_f32_32x32x16_bf16 v[64:79], v[96:99], v[136:139], v[184:199]
    s_mov_b64 exec, s[62:63]
    ds_read_b128 v[92:95], v20 offset:0
    ds_read_b128 v[100:103], v20 offset:512
    s_mov_b64 exec, -1
    v_exp_f32 v53, v53
    v_exp_f32 v54, v54
    v_exp_f32 v55, v55
    v_cvt_pk_bf16_f32 v80, v48, v49
    v_cvt_pk_bf16_f32 v81, v50, v51
    v_mfma_f32_32x32x8_bf16 v[64:79], v[42:43], v[146:147], v[64:79]
    v_cvt_pk_bf16_f32 v82, v52, v53
    v_cvt_pk_bf16_f32 v83, v54, v55
    s_bitcmp0_b32 3, s40
    s_cbranch_scc1 L_ev16
    s_waitcnt vmcnt(0)
    s_cbranch_execz L_pfret
    s_barrier
    s_nop 5
L_ev16:
    v_exp_f32 v56, v56
    v_exp_f32 v57, v57
    v_exp_f32 v58, v58
    v_exp_f32 v59, v59
    v_exp_f32 v60, v60
    v_exp_f32 v61, v61
    v_exp_f32 v62, v62
    v_exp_f32 v63, v63
    v_mfma_f32_32x32x16_bf16 v[200:215], v[2:5], v[80:83], v[200:215]
    s_lshl_b32 s57, s72, 2
    v_add_u32 v244, s57, v0
    s_lshl_b32 s57, s40, 6
    v_and_b32 v244, 15, v244
    s_add_u32 s57, s64, s57
    v_lshlrev_b32 v244, 2, v244
    s_mov_b64 exec, 0xffff
    buffer_load_dword v245, v244, s[12:15], s57 offen offset:256 sc1
    s_mov_b64 exec, -1
    v_cvt_pk_bf16_f32 v84, v56, v57
    v_cvt_pk_bf16_f32 v85, v58, v59
    v_cvt_pk_bf16_f32 v86, v60, v61
    v_cvt_pk_bf16_f32 v87, v62, v63
    v_exp_f32 v64, v64
    v_exp_f32 v65, v65
    v_mfma_f32_32x32x16_bf16 v[200:215], v[6:9], v[84:87], v[200:215]
    v_exp_f32 v66, v66
    v_exp_f32 v67, v67
    v_exp_f32 v68, v68
    v_exp_f32 v69, v69
    v_exp_f32 v70, v70
    v_exp_f32 v71, v71
    v_cvt_pk_bf16_f32 v232, v64, v65
    v_cvt_pk_bf16_f32 v233, v66, v67
    v_cvt_pk_bf16_f32 v234, v68, v69
    v_cvt_pk_bf16_f32 v235, v70, v71
    v_exp_f32 v72, v72
    v_exp_f32 v73, v73
    v_exp_f32 v74, v74
    v_exp_f32 v75, v75
    v_exp_f32 v76, v76
    v_exp_f32 v77, v77
    v_exp_f32 v78, v78
    v_exp_f32 v79, v79
    s_waitcnt lgkmcnt(1)
    v_mfma_f32_32x32x16_bf16 v[216:231], v[92:95], v[232:235], v[216:231]
    v_cvt_pk_bf16_f32 v236, v72, v73
    s_nop 0
    s_cbranch_execz L_pfret
    v_cvt_pk_bf16_f32 v237, v74, v75
    v_cvt_pk_bf16_f32 v238, v76, v77
    v_cvt_pk_bf16_f32 v239, v78, v79
    s_waitcnt lgkmcnt(0)
    s_nop 0
    v_mfma_f32_32x32x16_bf16 v[216:231], v[100:103], v[236:239], v[216:231]
L_bfin:
    s_setprio 3
    v_rcp_f32 v148, v212
    s_nop 9
    v_rcp_f32 v150, v228
    v_add_f32 v152, v212, v228
    v_add_f32 v153, v148, v150
    v_add_f32 v152, v152, v153
    v_cmp_ngt_f32 vcc, 1602224128, v152
    s_cbranch_vccnz L_fallback
L_bnorm:
    v_pk_mul_f32 v[200:201], v[200:201], v[148:149] op_sel_hi:[1,0]
    v_pk_mul_f32 v[202:203], v[202:203], v[148:149] op_sel_hi:[1,0]
    v_pk_mul_f32 v[204:205], v[204:205], v[148:149] op_sel_hi:[1,0]
    v_pk_mul_f32 v[206:207], v[206:207], v[148:149] op_sel_hi:[1,0]
    v_pk_mul_f32 v[208:209], v[208:209], v[148:149] op_sel_hi:[1,0]
    v_pk_mul_f32 v[210:211], v[210:211], v[148:149] op_sel_hi:[1,0]
    v_cvt_pk_bf16_f32 v112, v200, v201
    v_cvt_pk_bf16_f32 v113, v202, v203
    v_cvt_pk_bf16_f32 v114, v204, v205
    v_cvt_pk_bf16_f32 v115, v206, v207
    v_cvt_pk_bf16_f32 v120, v208, v209
    v_cvt_pk_bf16_f32 v121, v210, v211
    v_pk_mul_f32 v[216:217], v[216:217], v[150:151] op_sel_hi:[1,0]
    v_pk_mul_f32 v[218:219], v[218:219], v[150:151] op_sel_hi:[1,0]
    v_pk_mul_f32 v[220:221], v[220:221], v[150:151] op_sel_hi:[1,0]
    v_pk_mul_f32 v[222:223], v[222:223], v[150:151] op_sel_hi:[1,0]
    v_pk_mul_f32 v[224:225], v[224:225], v[150:151] op_sel_hi:[1,0]
    v_pk_mul_f32 v[226:227], v[226:227], v[150:151] op_sel_hi:[1,0]
    v_cvt_pk_bf16_f32 v116, v216, v217
    v_cvt_pk_bf16_f32 v117, v218, v219
    v_cvt_pk_bf16_f32 v118, v220, v221
    s_nop 0
    s_cbranch_execz L_pfret
    v_cvt_pk_bf16_f32 v119, v222, v223
    v_cvt_pk_bf16_f32 v122, v224, v225
    v_cvt_pk_bf16_f32 v123, v226, v227
    s_nop 1
L_tail:
    v_min_u32 v112, -2, v112
    v_min_u32 v113, -2, v113
    v_min_u32 v114, -2, v114
    v_min_u32 v115, -2, v115
    buffer_store_dwordx4 v[112:115], v29, s[12:15], s73 offen sc1
    v_min_u32 v116, -2, v116
    v_min_u32 v117, -2, v117
    v_min_u32 v118, -2, v118
    v_min_u32 v119, -2, v119
    buffer_store_dwordx4 v[116:119], v29, s[12:15], s73 offen offset:512 sc1
    v_min_u32 v120, -2, v120
    v_min_u32 v121, -2, v121
    v_min_u32 v122, -2, v122
    v_min_u32 v123, -2, v123
    v_lshlrev_b32 v2, 10, v0
    s_mov_b32 exec_hi, 0
    buffer_store_dwordx4 v[120:123], v29, s[12:15], s74 offen sc1
    s_mov_b32 exec_lo, 0xff
    s_bitcmp1_b32 s3, 0
    s_cbranch_scc0 L_hc
    buffer_store_dword v26, v2, s[12:15], s76 offen offset:256
    s_branch L_hd
L_hc:
    buffer_store_dword v26, v2, s[12:15], s76 offen offset:256 sc1
L_hd:
    s_mov_b64 exec, -1
    s_setprio 0
    v_add_u32 v8, 4096, v1
    s_lshl_b32 s53, s40, 1
    s_add_u32 s53, s53, s41
    s_sub_u32 s55, s42, s39
    s_add_u32 s55, s55, s53
    s_mul_i32 s55, s55, 20480
    s_add_u32 s55, s55, 6291456
    s_lshl_b32 s46, s38, 3
    s_add_u32 s53, s53, s46
    s_mov_b32 s50, 0
    s_mov_b32 s51, -2
    s_mov_b32 s52, 40000
    s_mov_b32 s56, 0
    s_movk_i32 s54, 57
    s_waitcnt vmcnt(4)
    s_cmp_lg_u32 s37, 0
    s_cbranch_scc1 L_tnb
    s_barrier
L_tnb:
    v_cmp_gt_u32 vcc, 2, v245
    v_cmp_eq_u32 s[46:47], 0, v245
    s_cbranch_execz L_pfret
    s_and_b32 vcc_hi, vcc_lo, 0xfff0
    s_and_b32 s46, s46, 0xffff
    s_or_b32 vcc_hi, vcc_hi, s46
    s_cbranch_scc1 L_tpoll
L_tgo:
    s_bfe_u32 s46, s54, 131072
    s_add_u32 s46, s46, s72
    s_and_b32 s46, s46, 3
    s_mul_i32 s46, s46, 5120
    s_add_u32 s46, s46, s55
    buffer_load_dwordx4 v[60:63], v1, s[12:15], s46 offen offset:0 sc1
    buffer_load_dwordx4 v[64:67], v1, s[12:15], s46 offen offset:1024 sc1
    buffer_load_dwordx4 v[68:71], v1, s[12:15], s46 offen offset:2048 sc1
    buffer_load_dwordx4 v[72:75], v1, s[12:15], s46 offen offset:3072 sc1
    buffer_load_dwordx4 v[76:79], v8, s[12:15], s46 offen sc1
    s_bfe_u32 s47, s54, 131074
    s_add_u32 s47, s47, s72
    s_and_b32 s47, s47, 3
    s_mul_i32 s47, s47, 5120
    s_add_u32 s47, s47, s55
    s_bfe_u32 s48, s54, 131076
    s_add_u32 s48, s48, s72
    s_and_b32 s48, s48, 3
    s_mul_i32 s48, s48, 5120
    s_add_u32 s48, s48, s55
    s_bfe_u32 s49, s54, 131078
    s_add_u32 s49, s49, s72
    s_and_b32 s49, s49, 3
    s_mul_i32 s49, s49, 5120
    s_add_u32 s49, s49, s55
    s_bfe_u32 s45, s54, 131072
    s_mul_i32 s45, s45, 25600
    v_add_u32 v36, s45, v35
    v_add_u32 v38, s45, v37
    ds_read_b64_tr_b16 v[144:145], v36 offset:0
    ds_read_b64_tr_b16 v[146:147], v36 offset:1280
    ds_read_b64_tr_b16 v[148:149], v36 offset:32
    ds_read_b64_tr_b16 v[150:151], v36 offset:1312
    ds_read_b64_tr_b16 v[152:153], v36 offset:64
    ds_read_b64_tr_b16 v[154:155], v36 offset:1344
    s_nop 0
    s_cbranch_execz L_pfret
    ds_read_b64_tr_b16 v[156:157], v36 offset:96
    ds_read_b64_tr_b16 v[158:159], v36 offset:1376
    ds_read_b64_tr_b16 v[160:161], v36 offset:128
    ds_read_b64_tr_b16 v[162:163], v36 offset:1408
    ds_read_b64_tr_b16 v[164:165], v36 offset:6400
    ds_read_b64_tr_b16 v[166:167], v36 offset:7680
    ds_read_b64_tr_b16 v[168:169], v36 offset:6432
    ds_read_b64_tr_b16 v[170:171], v36 offset:7712
    ds_read_b64_tr_b16 v[172:173], v36 offset:6464
    ds_read_b64_tr_b16 v[174:175], v36 offset:7744
    ds_read_b64_tr_b16 v[176:177], v36 offset:6496
    ds_read_b64_tr_b16 v[178:179], v36 offset:7776
    ds_read_b64_tr_b16 v[180:181], v36 offset:6528
    ds_read_b64_tr_b16 v[182:183], v36 offset:7808
    ds_read_b64_tr_b16 v[184:185], v36 offset:12800
    ds_read_b64_tr_b16 v[186:187], v36 offset:14080
    ds_read_b64_tr_b16 v[188:189], v36 offset:12832
    ds_read_b64_tr_b16 v[190:191], v36 offset:14112
    ds_read_b64_tr_b16 v[192:193], v36 offset:12864
    ds_read_b64_tr_b16 v[194:195], v36 offset:14144
    ds_read_b64_tr_b16 v[196:197], v36 offset:12896
    ds_read_b64_tr_b16 v[198:199], v36 offset:14176
    ds_read_b64_tr_b16 v[200:201], v36 offset:12928
    ds_read_b64_tr_b16 v[202:203], v36 offset:14208
    ds_read_b64_tr_b16 v[204:205], v36 offset:19200
    ds_read_b64_tr_b16 v[206:207], v36 offset:20480
    ds_read_b64_tr_b16 v[208:209], v36 offset:19232
    ds_read_b64_tr_b16 v[210:211], v36 offset:20512
    ds_read_b64_tr_b16 v[212:213], v36 offset:19264
    ds_read_b64_tr_b16 v[214:215], v36 offset:20544
    ds_read_b64_tr_b16 v[216:217], v36 offset:19296
    s_nop 0
    s_cbranch_execz L_pfret
    ds_read_b64_tr_b16 v[218:219], v36 offset:20576
    ds_read_b64_tr_b16 v[220:221], v36 offset:19328
    ds_read_b64_tr_b16 v[222:223], v36 offset:20608
    ds_read_b64_tr_b16 v[224:225], v38 offset:0
    ds_read_b64_tr_b16 v[226:227], v38 offset:3200
    ds_read_b64_tr_b16 v[228:229], v38 offset:32
    ds_read_b64_tr_b16 v[230:231], v38 offset:3232
    ds_read_b64_tr_b16 v[232:233], v38 offset:64
    ds_read_b64_tr_b16 v[234:235], v38 offset:3264
    ds_read_b64_tr_b16 v[236:237], v38 offset:96
    ds_read_b64_tr_b16 v[238:239], v38 offset:3296
    ds_read_b64_tr_b16 v[240:241], v38 offset:128
    ds_read_b64_tr_b16 v[242:243], v38 offset:3328
    v_mov_b64 v[40:41], 0
    v_mov_b64 v[42:43], 0
    v_mov_b64 v[44:45], 0
    v_mov_b64 v[46:47], 0
    v_mov_b64 v[48:49], 0
    v_mov_b64 v[50:51], 0
    v_mov_b64 v[52:53], 0
    v_mov_b64 v[54:55], 0
    v_mov_b64 v[56:57], 0
    v_mov_b64 v[58:59], 0
    v_and_b32 v2, 15, v0
    v_mul_u32_u24 v2, 2560, v2
    v_lshrrev_b32 v3, 4, v0
    v_lshl_add_u32 v4, v3, 3, v2
    v_bfe_u32 v5, v0, 4, 1
    v_lshl_add_u32 v2, v5, 5, v2
    v_lshrrev_b32 v3, 5, v0
    v_lshl_add_u32 v2, v3, 4, v2
    s_mul_i32 s53, s53, 40960
    s_mul_i32 vcc_hi, s37, 1280
    s_add_u32 s53, s53, vcc_hi
    s_mul_i32 vcc_hi, s39, 160
    s_add_u32 s53, s53, vcc_hi
L_tw0:
    s_waitcnt vmcnt(0)
    buffer_load_dwordx4 v[80:83], v1, s[12:15], s47 offen offset:0 sc1
    buffer_load_dwordx4 v[84:87], v1, s[12:15], s47 offen offset:1024 sc1
    s_nop 0
    s_cbranch_execz L_pfret
    buffer_load_dwordx4 v[88:91], v1, s[12:15], s47 offen offset:2048 sc1
    buffer_load_dwordx4 v[92:95], v1, s[12:15], s47 offen offset:3072 sc1
    buffer_load_dwordx4 v[96:99], v8, s[12:15], s47 offen sc1
L_tv0:
    s_bfe_u32 s45, s54, 131074
    s_mul_i32 s45, s45, 25600
    v_add_u32 v36, s45, v35
    v_add_u32 v38, s45, v37
    v_max3_u32 v6, v60, v61, v62
    v_max3_u32 v7, v63, v64, v65
    v_max3_u32 v6, v6, v66, v67
    v_max3_u32 v7, v7, v68, v69
    v_max3_u32 v6, v6, v70, v71
    v_max3_u32 v7, v7, v72, v73
    v_max3_u32 v6, v6, v74, v75
    v_max3_u32 v7, v7, v76, v77
    v_max3_u32 v6, v6, v78, v79
    v_max_u32 v6, v6, v7
    v_cmp_lt_u32 vcc, s51, v6
    s_cbranch_vccnz L_tf0
    s_and_b32 s50, s50, 14
    s_waitcnt lgkmcnt(15)
    v_mfma_f32_16x16x32_bf16 v[40:43], v[144:147], v[60:63], v[40:43]
    ds_read_b64_tr_b16 v[144:145], v36 offset:0
    ds_read_b64_tr_b16 v[146:147], v36 offset:1280
    v_mfma_f32_16x16x32_bf16 v[44:47], v[148:151], v[60:63], v[44:47]
    ds_read_b64_tr_b16 v[148:149], v36 offset:32
    ds_read_b64_tr_b16 v[150:151], v36 offset:1312
    v_mfma_f32_16x16x32_bf16 v[48:51], v[152:155], v[60:63], v[48:51]
    ds_read_b64_tr_b16 v[152:153], v36 offset:64
    ds_read_b64_tr_b16 v[154:155], v36 offset:1344
    v_mfma_f32_16x16x32_bf16 v[52:55], v[156:159], v[60:63], v[52:55]
    ds_read_b64_tr_b16 v[156:157], v36 offset:96
    ds_read_b64_tr_b16 v[158:159], v36 offset:1376
    v_mfma_f32_16x16x32_bf16 v[56:59], v[160:163], v[60:63], v[56:59]
    ds_read_b64_tr_b16 v[160:161], v36 offset:128
    s_cbranch_execz L_pfret
    ds_read_b64_tr_b16 v[162:163], v36 offset:1408
    v_mfma_f32_16x16x32_bf16 v[40:43], v[164:167], v[64:67], v[40:43]
    ds_read_b64_tr_b16 v[164:165], v36 offset:6400
    ds_read_b64_tr_b16 v[166:167], v36 offset:7680
    v_mfma_f32_16x16x32_bf16 v[44:47], v[168:171], v[64:67], v[44:47]
    ds_read_b64_tr_b16 v[168:169], v36 offset:6432
    ds_read_b64_tr_b16 v[170:171], v36 offset:7712
    v_mfma_f32_16x16x32_bf16 v[48:51], v[172:175], v[64:67], v[48:51]
    ds_read_b64_tr_b16 v[172:173], v36 offset:6464
    ds_read_b64_tr_b16 v[174:175], v36 offset:7744
    v_mfma_f32_16x16x32_bf16 v[52:55], v[176:179], v[64:67], v[52:55]
    ds_read_b64_tr_b16 v[176:177], v36 offset:6496
    ds_read_b64_tr_b16 v[178:179], v36 offset:7776
    v_mfma_f32_16x16x32_bf16 v[56:59], v[180:183], v[64:67], v[56:59]
    ds_read_b64_tr_b16 v[180:181], v36 offset:6528
    ds_read_b64_tr_b16 v[182:183], v36 offset:7808
    v_mfma_f32_16x16x32_bf16 v[40:43], v[184:187], v[68:71], v[40:43]
    ds_read_b64_tr_b16 v[184:185], v36 offset:12800
    ds_read_b64_tr_b16 v[186:187], v36 offset:14080
    v_mfma_f32_16x16x32_bf16 v[44:47], v[188:191], v[68:71], v[44:47]
    ds_read_b64_tr_b16 v[188:189], v36 offset:12832
    ds_read_b64_tr_b16 v[190:191], v36 offset:14112
    v_mfma_f32_16x16x32_bf16 v[48:51], v[192:195], v[68:71], v[48:51]
    ds_read_b64_tr_b16 v[192:193], v36 offset:12864
    ds_read_b64_tr_b16 v[194:195], v36 offset:14144
    v_mfma_f32_16x16x32_bf16 v[52:55], v[196:199], v[68:71], v[52:55]
    ds_read_b64_tr_b16 v[196:197], v36 offset:12896
    ds_read_b64_tr_b16 v[198:199], v36 offset:14176
    v_mfma_f32_16x16x32_bf16 v[56:59], v[200:203], v[68:71], v[56:59]
    ds_read_b64_tr_b16 v[200:201], v36 offset:12928
    ds_read_b64_tr_b16 v[202:203], v36 offset:14208
    s_nop 0
    s_cbranch_execz L_pfret
    v_mfma_f32_16x16x32_bf16 v[40:43], v[204:207], v[72:75], v[40:43]
    ds_read_b64_tr_b16 v[204:205], v36 offset:19200
    ds_read_b64_tr_b16 v[206:207], v36 offset:20480
    v_mfma_f32_16x16x32_bf16 v[44:47], v[208:211], v[72:75], v[44:47]
    ds_read_b64_tr_b16 v[208:209], v36 offset:19232
    ds_read_b64_tr_b16 v[210:211], v36 offset:20512
    s_waitcnt lgkmcnt(15)
    v_mfma_f32_16x16x32_bf16 v[48:51], v[212:215], v[72:75], v[48:51]
    ds_read_b64_tr_b16 v[212:213], v36 offset:19264
    ds_read_b64_tr_b16 v[214:215], v36 offset:20544
    v_mfma_f32_16x16x32_bf16 v[52:55], v[216:219], v[72:75], v[52:55]
    ds_read_b64_tr_b16 v[216:217], v36 offset:19296
    ds_read_b64_tr_b16 v[218:219], v36 offset:20576
    v_mfma_f32_16x16x32_bf16 v[56:59], v[220:223], v[72:75], v[56:59]
    ds_read_b64_tr_b16 v[220:221], v36 offset:19328
    ds_read_b64_tr_b16 v[222:223], v36 offset:20608
    v_mfma_f32_16x16x32_bf16 v[40:43], v[224:227], v[76:79], v[40:43]
    ds_read_b64_tr_b16 v[224:225], v38 offset:0
    ds_read_b64_tr_b16 v[226:227], v38 offset:3200
    v_mfma_f32_16x16x32_bf16 v[44:47], v[228:231], v[76:79], v[44:47]
    ds_read_b64_tr_b16 v[228:229], v38 offset:32
    ds_read_b64_tr_b16 v[230:231], v38 offset:3232
    v_mfma_f32_16x16x32_bf16 v[48:51], v[232:235], v[76:79], v[48:51]
    ds_read_b64_tr_b16 v[232:233], v38 offset:64
    ds_read_b64_tr_b16 v[234:235], v38 offset:3264
    v_mfma_f32_16x16x32_bf16 v[52:55], v[236:239], v[76:79], v[52:55]
    ds_read_b64_tr_b16 v[236:237], v38 offset:96
    ds_read_b64_tr_b16 v[238:239], v38 offset:3296
    v_mfma_f32_16x16x32_bf16 v[56:59], v[240:243], v[76:79], v[56:59]
    ds_read_b64_tr_b16 v[240:241], v38 offset:128
    ds_read_b64_tr_b16 v[242:243], v38 offset:3328
    s_cmp_lg_u32 s56, 0
    s_cbranch_scc1 L_tc1
L_tw1:
    s_cbranch_execz L_pfret
    s_waitcnt vmcnt(0)
    buffer_load_dwordx4 v[124:127], v1, s[12:15], s48 offen offset:0 sc1
    buffer_load_dwordx4 v[128:131], v1, s[12:15], s48 offen offset:1024 sc1
    buffer_load_dwordx4 v[132:135], v1, s[12:15], s48 offen offset:2048 sc1
    buffer_load_dwordx4 v[136:139], v1, s[12:15], s48 offen offset:3072 sc1
    buffer_load_dwordx4 v[140:143], v8, s[12:15], s48 offen sc1
L_tv1:
    s_bfe_u32 s45, s54, 131076
    s_mul_i32 s45, s45, 25600
    v_add_u32 v36, s45, v35
    v_add_u32 v38, s45, v37
    v_max3_u32 v6, v80, v81, v82
    v_max3_u32 v7, v83, v84, v85
    v_max3_u32 v6, v6, v86, v87
    v_max3_u32 v7, v7, v88, v89
    v_max3_u32 v6, v6, v90, v91
    v_max3_u32 v7, v7, v92, v93
    v_max3_u32 v6, v6, v94, v95
    v_max3_u32 v7, v7, v96, v97
    v_max3_u32 v6, v6, v98, v99
    v_max_u32 v6, v6, v7
    v_cmp_lt_u32 vcc, s51, v6
    s_cbranch_vccnz L_tf1
    s_and_b32 s50, s50, 13
    s_waitcnt lgkmcnt(15)
    v_mfma_f32_16x16x32_bf16 v[40:43], v[144:147], v[80:83], v[40:43]
    ds_read_b64_tr_b16 v[144:145], v36 offset:0
    ds_read_b64_tr_b16 v[146:147], v36 offset:1280
    v_mfma_f32_16x16x32_bf16 v[44:47], v[148:151], v[80:83], v[44:47]
    ds_read_b64_tr_b16 v[148:149], v36 offset:32
    ds_read_b64_tr_b16 v[150:151], v36 offset:1312
    v_mfma_f32_16x16x32_bf16 v[48:51], v[152:155], v[80:83], v[48:51]
    ds_read_b64_tr_b16 v[152:153], v36 offset:64
    ds_read_b64_tr_b16 v[154:155], v36 offset:1344
    v_mfma_f32_16x16x32_bf16 v[52:55], v[156:159], v[80:83], v[52:55]
    ds_read_b64_tr_b16 v[156:157], v36 offset:96
    s_nop 0
    s_cbranch_execz L_pfret
    ds_read_b64_tr_b16 v[158:159], v36 offset:1376
    v_mfma_f32_16x16x32_bf16 v[56:59], v[160:163], v[80:83], v[56:59]
    ds_read_b64_tr_b16 v[160:161], v36 offset:128
    ds_read_b64_tr_b16 v[162:163], v36 offset:1408
    v_mfma_f32_16x16x32_bf16 v[40:43], v[164:167], v[84:87], v[40:43]
    ds_read_b64_tr_b16 v[164:165], v36 offset:6400
    ds_read_b64_tr_b16 v[166:167], v36 offset:7680
    v_mfma_f32_16x16x32_bf16 v[44:47], v[168:171], v[84:87], v[44:47]
    ds_read_b64_tr_b16 v[168:169], v36 offset:6432
    ds_read_b64_tr_b16 v[170:171], v36 offset:7712
    v_mfma_f32_16x16x32_bf16 v[48:51], v[172:175], v[84:87], v[48:51]
    ds_read_b64_tr_b16 v[172:173], v36 offset:6464
    ds_read_b64_tr_b16 v[174:175], v36 offset:7744
    v_mfma_f32_16x16x32_bf16 v[52:55], v[176:179], v[84:87], v[52:55]
    ds_read_b64_tr_b16 v[176:177], v36 offset:6496
    ds_read_b64_tr_b16 v[178:179], v36 offset:7776
    v_mfma_f32_16x16x32_bf16 v[56:59], v[180:183], v[84:87], v[56:59]
    ds_read_b64_tr_b16 v[180:181], v36 offset:6528
    ds_read_b64_tr_b16 v[182:183], v36 offset:7808
    v_mfma_f32_16x16x32_bf16 v[40:43], v[184:187], v[88:91], v[40:43]
    ds_read_b64_tr_b16 v[184:185], v36 offset:12800
    ds_read_b64_tr_b16 v[186:187], v36 offset:14080
    v_mfma_f32_16x16x32_bf16 v[44:47], v[188:191], v[88:91], v[44:47]
    ds_read_b64_tr_b16 v[188:189], v36 offset:12832
    ds_read_b64_tr_b16 v[190:191], v36 offset:14112
    v_mfma_f32_16x16x32_bf16 v[48:51], v[192:195], v[88:91], v[48:51]
    ds_read_b64_tr_b16 v[192:193], v36 offset:12864
    ds_read_b64_tr_b16 v[194:195], v36 offset:14144
    v_mfma_f32_16x16x32_bf16 v[52:55], v[196:199], v[88:91], v[52:55]
    ds_read_b64_tr_b16 v[196:197], v36 offset:12896
    ds_read_b64_tr_b16 v[198:199], v36 offset:14176
    s_nop 0
    s_cbranch_execz L_pfret
    v_mfma_f32_16x16x32_bf16 v[56:59], v[200:203], v[88:91], v[56:59]
    ds_read_b64_tr_b16 v[200:201], v36 offset:12928
    ds_read_b64_tr_b16 v[202:203], v36 offset:14208
    v_mfma_f32_16x16x32_bf16 v[40:43], v[204:207], v[92:95], v[40:43]
    ds_read_b64_tr_b16 v[204:205], v36 offset:19200
    ds_read_b64_tr_b16 v[206:207], v36 offset:20480
    v_mfma_f32_16x16x32_bf16 v[44:47], v[208:211], v[92:95], v[44:47]
    ds_read_b64_tr_b16 v[208:209], v36 offset:19232
    ds_read_b64_tr_b16 v[210:211], v36 offset:20512
    s_waitcnt lgkmcnt(15)
    v_mfma_f32_16x16x32_bf16 v[48:51], v[212:215], v[92:95], v[48:51]
    ds_read_b64_tr_b16 v[212:213], v36 offset:19264
    ds_read_b64_tr_b16 v[214:215], v36 offset:20544
    v_mfma_f32_16x16x32_bf16 v[52:55], v[216:219], v[92:95], v[52:55]
    ds_read_b64_tr_b16 v[216:217], v36 offset:19296
    ds_read_b64_tr_b16 v[218:219], v36 offset:20576
    v_mfma_f32_16x16x32_bf16 v[56:59], v[220:223], v[92:95], v[56:59]
    ds_read_b64_tr_b16 v[220:221], v36 offset:19328
    ds_read_b64_tr_b16 v[222:223], v36 offset:20608
    v_mfma_f32_16x16x32_bf16 v[40:43], v[224:227], v[96:99], v[40:43]
    ds_read_b64_tr_b16 v[224:225], v38 offset:0
    ds_read_b64_tr_b16 v[226:227], v38 offset:3200
    v_mfma_f32_16x16x32_bf16 v[44:47], v[228:231], v[96:99], v[44:47]
    ds_read_b64_tr_b16 v[228:229], v38 offset:32
    ds_read_b64_tr_b16 v[230:231], v38 offset:3232
    v_mfma_f32_16x16x32_bf16 v[48:51], v[232:235], v[96:99], v[48:51]
    ds_read_b64_tr_b16 v[232:233], v38 offset:64
    ds_read_b64_tr_b16 v[234:235], v38 offset:3264
    v_mfma_f32_16x16x32_bf16 v[52:55], v[236:239], v[96:99], v[52:55]
    ds_read_b64_tr_b16 v[236:237], v38 offset:96
    ds_read_b64_tr_b16 v[238:239], v38 offset:3296
    v_mfma_f32_16x16x32_bf16 v[56:59], v[240:243], v[96:99], v[56:59]
    s_cbranch_execz L_pfret
    ds_read_b64_tr_b16 v[240:241], v38 offset:128
    ds_read_b64_tr_b16 v[242:243], v38 offset:3328
    s_cmp_lg_u32 s56, 0
    s_cbranch_scc1 L_tc2
L_tw2:
    s_waitcnt vmcnt(0)
    buffer_load_dwordx4 v[100:103], v1, s[12:15], s49 offen offset:0 sc1
    buffer_load_dwordx4 v[104:107], v1, s[12:15], s49 offen offset:1024 sc1
    buffer_load_dwordx4 v[108:111], v1, s[12:15], s49 offen offset:2048 sc1
    buffer_load_dwordx4 v[112:115], v1, s[12:15], s49 offen offset:3072 sc1
    buffer_load_dwordx4 v[116:119], v8, s[12:15], s49 offen sc1
L_tv2:
    s_bfe_u32 s45, s54, 131078
    s_mul_i32 s45, s45, 25600
    v_add_u32 v36, s45, v35
    v_add_u32 v38, s45, v37
    v_max3_u32 v6, v124, v125, v126
    v_max3_u32 v7, v127, v128, v129
    v_max3_u32 v6, v6, v130, v131
    v_max3_u32 v7, v7, v132, v133
    v_max3_u32 v6, v6, v134, v135
    v_max3_u32 v7, v7, v136, v137
    v_max3_u32 v6, v6, v138, v139
    v_max3_u32 v7, v7, v140, v141
    v_max3_u32 v6, v6, v142, v143
    v_max_u32 v6, v6, v7
    v_cmp_lt_u32 vcc, s51, v6
    s_cbranch_vccnz L_tf2
    s_and_b32 s50, s50, 11
    s_waitcnt lgkmcnt(15)
    v_mfma_f32_16x16x32_bf16 v[40:43], v[144:147], v[124:127], v[40:43]
    ds_read_b64_tr_b16 v[144:145], v36 offset:0
    ds_read_b64_tr_b16 v[146:147], v36 offset:1280
    v_mfma_f32_16x16x32_bf16 v[44:47], v[148:151], v[124:127], v[44:47]
    ds_read_b64_tr_b16 v[148:149], v36 offset:32
    ds_read_b64_tr_b16 v[150:151], v36 offset:1312
    v_mfma_f32_16x16x32_bf16 v[48:51], v[152:155], v[124:127], v[48:51]
    ds_read_b64_tr_b16 v[152:153], v36 offset:64
    s_nop 0
    s_cbranch_execz L_pfret
    ds_read_b64_tr_b16 v[154:155], v36 offset:1344
    v_mfma_f32_16x16x32_bf16 v[52:55], v[156:159], v[124:127], v[52:55]
    ds_read_b64_tr_b16 v[156:157], v36 offset:96
    ds_read_b64_tr_b16 v[158:159], v36 offset:1376
    v_mfma_f32_16x16x32_bf16 v[56:59], v[160:163], v[124:127], v[56:59]
    ds_read_b64_tr_b16 v[160:161], v36 offset:128
    ds_read_b64_tr_b16 v[162:163], v36 offset:1408
    v_mfma_f32_16x16x32_bf16 v[40:43], v[164:167], v[128:131], v[40:43]
    ds_read_b64_tr_b16 v[164:165], v36 offset:6400
    ds_read_b64_tr_b16 v[166:167], v36 offset:7680
    v_mfma_f32_16x16x32_bf16 v[44:47], v[168:171], v[128:131], v[44:47]
    ds_read_b64_tr_b16 v[168:169], v36 offset:6432
    ds_read_b64_tr_b16 v[170:171], v36 offset:7712
    v_mfma_f32_16x16x32_bf16 v[48:51], v[172:175], v[128:131], v[48:51]
    ds_read_b64_tr_b16 v[172:173], v36 offset:6464
    ds_read_b64_tr_b16 v[174:175], v36 offset:7744
    v_mfma_f32_16x16x32_bf16 v[52:55], v[176:179], v[128:131], v[52:55]
    ds_read_b64_tr_b16 v[176:177], v36 offset:6496
    ds_read_b64_tr_b16 v[178:179], v36 offset:7776
    v_mfma_f32_16x16x32_bf16 v[56:59], v[180:183], v[128:131], v[56:59]
    ds_read_b64_tr_b16 v[180:181], v36 offset:6528
    ds_read_b64_tr_b16 v[182:183], v36 offset:7808
    v_mfma_f32_16x16x32_bf16 v[40:43], v[184:187], v[132:135], v[40:43]
    ds_read_b64_tr_b16 v[184:185], v36 offset:12800
    ds_read_b64_tr_b16 v[186:187], v36 offset:14080
    v_mfma_f32_16x16x32_bf16 v[44:47], v[188:191], v[132:135], v[44:47]
    ds_read_b64_tr_b16 v[188:189], v36 offset:12832
    ds_read_b64_tr_b16 v[190:191], v36 offset:14112
    v_mfma_f32_16x16x32_bf16 v[48:51], v[192:195], v[132:135], v[48:51]
    ds_read_b64_tr_b16 v[192:193], v36 offset:12864
    ds_read_b64_tr_b16 v[194:195], v36 offset:14144
    s_nop 0
    s_cbranch_execz L_pfret
    v_mfma_f32_16x16x32_bf16 v[52:55], v[196:199], v[132:135], v[52:55]
    ds_read_b64_tr_b16 v[196:197], v36 offset:12896
    ds_read_b64_tr_b16 v[198:199], v36 offset:14176
    v_mfma_f32_16x16x32_bf16 v[56:59], v[200:203], v[132:135], v[56:59]
    ds_read_b64_tr_b16 v[200:201], v36 offset:12928
    ds_read_b64_tr_b16 v[202:203], v36 offset:14208
    v_mfma_f32_16x16x32_bf16 v[40:43], v[204:207], v[136:139], v[40:43]
    ds_read_b64_tr_b16 v[204:205], v36 offset:19200
    ds_read_b64_tr_b16 v[206:207], v36 offset:20480
    v_mfma_f32_16x16x32_bf16 v[44:47], v[208:211], v[136:139], v[44:47]
    ds_read_b64_tr_b16 v[208:209], v36 offset:19232
    ds_read_b64_tr_b16 v[210:211], v36 offset:20512
    s_waitcnt lgkmcnt(15)
    v_mfma_f32_16x16x32_bf16 v[48:51], v[212:215], v[136:139], v[48:51]
    ds_read_b64_tr_b16 v[212:213], v36 offset:19264
    ds_read_b64_tr_b16 v[214:215], v36 offset:20544
    v_mfma_f32_16x16x32_bf16 v[52:55], v[216:219], v[136:139], v[52:55]
    ds_read_b64_tr_b16 v[216:217], v36 offset:19296
    ds_read_b64_tr_b16 v[218:219], v36 offset:20576
    v_mfma_f32_16x16x32_bf16 v[56:59], v[220:223], v[136:139], v[56:59]
    ds_read_b64_tr_b16 v[220:221], v36 offset:19328
    ds_read_b64_tr_b16 v[222:223], v36 offset:20608
    v_mfma_f32_16x16x32_bf16 v[40:43], v[224:227], v[140:143], v[40:43]
    ds_read_b64_tr_b16 v[224:225], v38 offset:0
    ds_read_b64_tr_b16 v[226:227], v38 offset:3200
    v_mfma_f32_16x16x32_bf16 v[44:47], v[228:231], v[140:143], v[44:47]
    ds_read_b64_tr_b16 v[228:229], v38 offset:32
    ds_read_b64_tr_b16 v[230:231], v38 offset:3232
    v_mfma_f32_16x16x32_bf16 v[48:51], v[232:235], v[140:143], v[48:51]
    ds_read_b64_tr_b16 v[232:233], v38 offset:64
    ds_read_b64_tr_b16 v[234:235], v38 offset:3264
    v_mfma_f32_16x16x32_bf16 v[52:55], v[236:239], v[140:143], v[52:55]
    s_cbranch_execz L_pfret
    ds_read_b64_tr_b16 v[236:237], v38 offset:96
    ds_read_b64_tr_b16 v[238:239], v38 offset:3296
    v_mfma_f32_16x16x32_bf16 v[56:59], v[240:243], v[140:143], v[56:59]
    ds_read_b64_tr_b16 v[240:241], v38 offset:128
    ds_read_b64_tr_b16 v[242:243], v38 offset:3328
    s_cmp_lg_u32 s56, 0
    s_cbranch_scc1 L_tc3
L_tw3:
    s_waitcnt vmcnt(0)
L_tv3:
    v_max3_u32 v6, v100, v101, v102
    v_max3_u32 v7, v103, v104, v105
    v_max3_u32 v6, v6, v106, v107
    v_max3_u32 v7, v7, v108, v109
    v_max3_u32 v6, v6, v110, v111
    v_max3_u32 v7, v7, v112, v113
    v_max3_u32 v6, v6, v114, v115
    v_max3_u32 v7, v7, v116, v117
    v_max3_u32 v6, v6, v118, v119
    v_max_u32 v6, v6, v7
    v_cmp_lt_u32 vcc, s51, v6
    s_cbranch_vccnz L_tf3
    s_and_b32 s50, s50, 7
    s_waitcnt lgkmcnt(15)
    v_mfma_f32_16x16x32_bf16 v[40:43], v[144:147], v[100:103], v[40:43]
    v_mfma_f32_16x16x32_bf16 v[44:47], v[148:151], v[100:103], v[44:47]
    v_mfma_f32_16x16x32_bf16 v[48:51], v[152:155], v[100:103], v[48:51]
    v_mfma_f32_16x16x32_bf16 v[52:55], v[156:159], v[100:103], v[52:55]
    v_mfma_f32_16x16x32_bf16 v[56:59], v[160:163], v[100:103], v[56:59]
    v_mfma_f32_16x16x32_bf16 v[40:43], v[164:167], v[104:107], v[40:43]
    v_mfma_f32_16x16x32_bf16 v[44:47], v[168:171], v[104:107], v[44:47]
    v_mfma_f32_16x16x32_bf16 v[48:51], v[172:175], v[104:107], v[48:51]
    v_mfma_f32_16x16x32_bf16 v[52:55], v[176:179], v[104:107], v[52:55]
    v_mfma_f32_16x16x32_bf16 v[56:59], v[180:183], v[104:107], v[56:59]
    v_mfma_f32_16x16x32_bf16 v[40:43], v[184:187], v[108:111], v[40:43]
    v_mfma_f32_16x16x32_bf16 v[44:47], v[188:191], v[108:111], v[44:47]
    v_mfma_f32_16x16x32_bf16 v[48:51], v[192:195], v[108:111], v[48:51]
    s_nop 0
    s_cbranch_execz L_pfret
    v_mfma_f32_16x16x32_bf16 v[52:55], v[196:199], v[108:111], v[52:55]
    v_mfma_f32_16x16x32_bf16 v[56:59], v[200:203], v[108:111], v[56:59]
    v_mfma_f32_16x16x32_bf16 v[40:43], v[204:207], v[112:115], v[40:43]
    v_mfma_f32_16x16x32_bf16 v[44:47], v[208:211], v[112:115], v[44:47]
    s_waitcnt lgkmcnt(14)
    v_mfma_f32_16x16x32_bf16 v[48:51], v[212:215], v[112:115], v[48:51]
    s_waitcnt lgkmcnt(12)
    v_mfma_f32_16x16x32_bf16 v[52:55], v[216:219], v[112:115], v[52:55]
    s_waitcnt lgkmcnt(10)
    v_mfma_f32_16x16x32_bf16 v[56:59], v[220:223], v[112:115], v[56:59]
    s_waitcnt lgkmcnt(8)
    v_mfma_f32_16x16x32_bf16 v[40:43], v[224:227], v[116:119], v[40:43]
    s_waitcnt lgkmcnt(6)
    v_mfma_f32_16x16x32_bf16 v[44:47], v[228:231], v[116:119], v[44:47]
    s_waitcnt lgkmcnt(4)
    v_mfma_f32_16x16x32_bf16 v[48:51], v[232:235], v[116:119], v[48:51]
    s_waitcnt lgkmcnt(2)
    v_mfma_f32_16x16x32_bf16 v[52:55], v[236:239], v[116:119], v[52:55]
    s_waitcnt lgkmcnt(0)
    v_mfma_f32_16x16x32_bf16 v[56:59], v[240:243], v[116:119], v[56:59]
L_tc4:
    s_cmp_lg_u32 s50, 0
    s_cbranch_scc1 L_tloop
    s_nop 5
    v_cvt_pk_bf16_f32 v60, v40, v41
    v_cvt_pk_bf16_f32 v61, v42, v43
    v_cvt_pk_bf16_f32 v62, v44, v45
    v_cvt_pk_bf16_f32 v63, v46, v47
    v_cvt_pk_bf16_f32 v64, v48, v49
    v_cvt_pk_bf16_f32 v65, v50, v51
    v_cvt_pk_bf16_f32 v66, v52, v53
    v_cvt_pk_bf16_f32 v67, v54, v55
    v_cvt_pk_bf16_f32 v68, v56, v57
    v_cvt_pk_bf16_f32 v69, v58, v59
    v_permlane16_swap_b32 v60, v62
    v_permlane16_swap_b32 v61, v63
    v_permlane16_swap_b32 v64, v66
    v_permlane16_swap_b32 v65, v67
    buffer_store_dwordx2 v[68:69], v4, s[20:23], s53 offen offset:128 nt
    buffer_store_dwordx4 v[60:63], v2, s[20:23], s53 offen offset:0 nt
    s_cbranch_execz L_pfret
    buffer_store_dwordx4 v[64:67], v2, s[20:23], s53 offen offset:64 nt
    s_endpgm
L_tpoll:
    s_and_b32 vcc_lo, vcc_lo, 0xffff
    s_bcnt1_i32_b32 s45, vcc_lo
    s_and_b32 s46, s46, 0xffff
    s_cselect_b32 s45, 16, s45
    s_cmp_le_u32 s45, 4
    s_cbranch_scc1 L_tperm
    s_mov_b64 exec, 0xffff
    buffer_load_dword v245, v244, s[12:15], s57 offen offset:256 sc1
    s_mov_b64 exec, -1
    s_sub_u32 s52, s52, 1
    s_waitcnt vmcnt(0)
    v_cmp_gt_u32 vcc, 2, v245
    v_cmp_eq_u32 s[46:47], 0, v245
    s_cmp_lg_u32 s52, 0
    s_nop 3
    s_cbranch_scc1 L_tpoll
L_tperm:
    s_mov_b32 s54, 0
    s_mov_b32 s43, 0
    s_mov_b32 s52, 40000
    s_and_b32 vcc_hi, vcc_lo, 240
    s_cselect_b32 s45, 0, 1
    s_cselect_b32 s77, 0, 2
    s_lshl_b32 s45, s45, s43
    s_or_b32 s54, s54, s45
    s_add_u32 s43, s43, s77
    s_and_b32 vcc_hi, vcc_lo, 3840
    s_cselect_b32 s45, 0, 2
    s_cselect_b32 s77, 0, 2
    s_lshl_b32 s45, s45, s43
    s_or_b32 s54, s54, s45
    s_add_u32 s43, s43, s77
    s_and_b32 vcc_hi, vcc_lo, 61440
    s_cselect_b32 s45, 0, 3
    s_cselect_b32 s77, 0, 2
    s_lshl_b32 s45, s45, s43
    s_or_b32 s54, s54, s45
    s_add_u32 s43, s43, s77
    s_and_b32 vcc_hi, vcc_lo, 15
    s_cselect_b32 s77, 0, 2
    s_add_u32 s43, s43, s77
    s_and_b32 vcc_hi, vcc_lo, 240
    s_cselect_b32 s45, 1, 0
    s_cselect_b32 s77, 2, 0
    s_lshl_b32 s45, s45, s43
    s_or_b32 s54, s54, s45
    s_add_u32 s43, s43, s77
    s_and_b32 vcc_hi, vcc_lo, 3840
    s_cselect_b32 s45, 2, 0
    s_cselect_b32 s77, 2, 0
    s_cbranch_execz L_pfret
    s_lshl_b32 s45, s45, s43
    s_or_b32 s54, s54, s45
    s_add_u32 s43, s43, s77
    s_and_b32 vcc_hi, vcc_lo, 61440
    s_cselect_b32 s45, 3, 0
    s_cselect_b32 s77, 2, 0
    s_lshl_b32 s45, s45, s43
    s_or_b32 s54, s54, s45
    s_add_u32 s43, s43, s77
    s_and_b32 vcc_hi, vcc_lo, 15
    s_cselect_b32 s77, 2, 0
    s_add_u32 s43, s43, s77
    s_branch L_tgo
L_tf0:
    buffer_load_dwordx4 v[60:63], v1, s[12:15], s46 offen offset:0 sc1
    buffer_load_dwordx4 v[64:67], v1, s[12:15], s46 offen offset:1024 sc1
    buffer_load_dwordx4 v[68:71], v1, s[12:15], s46 offen offset:2048 sc1
    buffer_load_dwordx4 v[72:75], v1, s[12:15], s46 offen offset:3072 sc1
    buffer_load_dwordx4 v[76:79], v8, s[12:15], s46 offen sc1
    s_or_b32 s50, s50, 1
    s_cmp_lg_u32 s56, 0
    s_cbranch_scc1 L_tc1
    s_waitcnt lgkmcnt(0)
    ds_read_b64_tr_b16 v[144:145], v36 offset:0
    ds_read_b64_tr_b16 v[146:147], v36 offset:1280
    ds_read_b64_tr_b16 v[148:149], v36 offset:32
    ds_read_b64_tr_b16 v[150:151], v36 offset:1312
    ds_read_b64_tr_b16 v[152:153], v36 offset:64
    ds_read_b64_tr_b16 v[154:155], v36 offset:1344
    ds_read_b64_tr_b16 v[156:157], v36 offset:96
    ds_read_b64_tr_b16 v[158:159], v36 offset:1376
    ds_read_b64_tr_b16 v[160:161], v36 offset:128
    ds_read_b64_tr_b16 v[162:163], v36 offset:1408
    ds_read_b64_tr_b16 v[164:165], v36 offset:6400
    ds_read_b64_tr_b16 v[166:167], v36 offset:7680
    ds_read_b64_tr_b16 v[168:169], v36 offset:6432
    ds_read_b64_tr_b16 v[170:171], v36 offset:7712
    ds_read_b64_tr_b16 v[172:173], v36 offset:6464
    ds_read_b64_tr_b16 v[174:175], v36 offset:7744
    ds_read_b64_tr_b16 v[176:177], v36 offset:6496
    s_nop 0
    s_cbranch_execz L_pfret
    ds_read_b64_tr_b16 v[178:179], v36 offset:7776
    ds_read_b64_tr_b16 v[180:181], v36 offset:6528
    ds_read_b64_tr_b16 v[182:183], v36 offset:7808
    ds_read_b64_tr_b16 v[184:185], v36 offset:12800
    ds_read_b64_tr_b16 v[186:187], v36 offset:14080
    ds_read_b64_tr_b16 v[188:189], v36 offset:12832
    ds_read_b64_tr_b16 v[190:191], v36 offset:14112
    ds_read_b64_tr_b16 v[192:193], v36 offset:12864
    ds_read_b64_tr_b16 v[194:195], v36 offset:14144
    ds_read_b64_tr_b16 v[196:197], v36 offset:12896
    ds_read_b64_tr_b16 v[198:199], v36 offset:14176
    ds_read_b64_tr_b16 v[200:201], v36 offset:12928
    ds_read_b64_tr_b16 v[202:203], v36 offset:14208
    ds_read_b64_tr_b16 v[204:205], v36 offset:19200
    ds_read_b64_tr_b16 v[206:207], v36 offset:20480
    ds_read_b64_tr_b16 v[208:209], v36 offset:19232
    ds_read_b64_tr_b16 v[210:211], v36 offset:20512
    ds_read_b64_tr_b16 v[212:213], v36 offset:19264
    ds_read_b64_tr_b16 v[214:215], v36 offset:20544
    ds_read_b64_tr_b16 v[216:217], v36 offset:19296
    ds_read_b64_tr_b16 v[218:219], v36 offset:20576
    ds_read_b64_tr_b16 v[220:221], v36 offset:19328
    ds_read_b64_tr_b16 v[222:223], v36 offset:20608
    ds_read_b64_tr_b16 v[224:225], v38 offset:0
    ds_read_b64_tr_b16 v[226:227], v38 offset:3200
    ds_read_b64_tr_b16 v[228:229], v38 offset:32
    ds_read_b64_tr_b16 v[230:231], v38 offset:3232
    ds_read_b64_tr_b16 v[232:233], v38 offset:64
    ds_read_b64_tr_b16 v[234:235], v38 offset:3264
    ds_read_b64_tr_b16 v[236:237], v38 offset:96
    ds_read_b64_tr_b16 v[238:239], v38 offset:3296
    s_nop 0
    s_cbranch_execz L_pfret
    ds_read_b64_tr_b16 v[240:241], v38 offset:128
    ds_read_b64_tr_b16 v[242:243], v38 offset:3328
    s_branch L_tw1
L_tf1:
    buffer_load_dwordx4 v[80:83], v1, s[12:15], s47 offen offset:0 sc1
    buffer_load_dwordx4 v[84:87], v1, s[12:15], s47 offen offset:1024 sc1
    buffer_load_dwordx4 v[88:91], v1, s[12:15], s47 offen offset:2048 sc1
    buffer_load_dwordx4 v[92:95], v1, s[12:15], s47 offen offset:3072 sc1
    buffer_load_dwordx4 v[96:99], v8, s[12:15], s47 offen sc1
    s_or_b32 s50, s50, 2
    s_cmp_lg_u32 s56, 0
    s_cbranch_scc1 L_tc2
    s_waitcnt lgkmcnt(0)
    ds_read_b64_tr_b16 v[144:145], v36 offset:0
    ds_read_b64_tr_b16 v[146:147], v36 offset:1280
    ds_read_b64_tr_b16 v[148:149], v36 offset:32
    ds_read_b64_tr_b16 v[150:151], v36 offset:1312
    ds_read_b64_tr_b16 v[152:153], v36 offset:64
    ds_read_b64_tr_b16 v[154:155], v36 offset:1344
    ds_read_b64_tr_b16 v[156:157], v36 offset:96
    ds_read_b64_tr_b16 v[158:159], v36 offset:1376
    ds_read_b64_tr_b16 v[160:161], v36 offset:128
    ds_read_b64_tr_b16 v[162:163], v36 offset:1408
    ds_read_b64_tr_b16 v[164:165], v36 offset:6400
    ds_read_b64_tr_b16 v[166:167], v36 offset:7680
    ds_read_b64_tr_b16 v[168:169], v36 offset:6432
    ds_read_b64_tr_b16 v[170:171], v36 offset:7712
    ds_read_b64_tr_b16 v[172:173], v36 offset:6464
    ds_read_b64_tr_b16 v[174:175], v36 offset:7744
    ds_read_b64_tr_b16 v[176:177], v36 offset:6496
    ds_read_b64_tr_b16 v[178:179], v36 offset:7776
    ds_read_b64_tr_b16 v[180:181], v36 offset:6528
    ds_read_b64_tr_b16 v[182:183], v36 offset:7808
    ds_read_b64_tr_b16 v[184:185], v36 offset:12800
    ds_read_b64_tr_b16 v[186:187], v36 offset:14080
    s_cbranch_execz L_pfret
    ds_read_b64_tr_b16 v[188:189], v36 offset:12832
    ds_read_b64_tr_b16 v[190:191], v36 offset:14112
    ds_read_b64_tr_b16 v[192:193], v36 offset:12864
    ds_read_b64_tr_b16 v[194:195], v36 offset:14144
    ds_read_b64_tr_b16 v[196:197], v36 offset:12896
    ds_read_b64_tr_b16 v[198:199], v36 offset:14176
    ds_read_b64_tr_b16 v[200:201], v36 offset:12928
    ds_read_b64_tr_b16 v[202:203], v36 offset:14208
    ds_read_b64_tr_b16 v[204:205], v36 offset:19200
    ds_read_b64_tr_b16 v[206:207], v36 offset:20480
    ds_read_b64_tr_b16 v[208:209], v36 offset:19232
    ds_read_b64_tr_b16 v[210:211], v36 offset:20512
    ds_read_b64_tr_b16 v[212:213], v36 offset:19264
    ds_read_b64_tr_b16 v[214:215], v36 offset:20544
    ds_read_b64_tr_b16 v[216:217], v36 offset:19296
    ds_read_b64_tr_b16 v[218:219], v36 offset:20576
    ds_read_b64_tr_b16 v[220:221], v36 offset:19328
    ds_read_b64_tr_b16 v[222:223], v36 offset:20608
    ds_read_b64_tr_b16 v[224:225], v38 offset:0
    ds_read_b64_tr_b16 v[226:227], v38 offset:3200
    ds_read_b64_tr_b16 v[228:229], v38 offset:32
    ds_read_b64_tr_b16 v[230:231], v38 offset:3232
    ds_read_b64_tr_b16 v[232:233], v38 offset:64
    ds_read_b64_tr_b16 v[234:235], v38 offset:3264
    ds_read_b64_tr_b16 v[236:237], v38 offset:96
    ds_read_b64_tr_b16 v[238:239], v38 offset:3296
    ds_read_b64_tr_b16 v[240:241], v38 offset:128
    ds_read_b64_tr_b16 v[242:243], v38 offset:3328
    s_branch L_tw2
L_tf2:
    buffer_load_dwordx4 v[124:127], v1, s[12:15], s48 offen offset:0 sc1
    buffer_load_dwordx4 v[128:131], v1, s[12:15], s48 offen offset:1024 sc1
    buffer_load_dwordx4 v[132:135], v1, s[12:15], s48 offen offset:2048 sc1
    s_cbranch_execz L_pfret
    buffer_load_dwordx4 v[136:139], v1, s[12:15], s48 offen offset:3072 sc1
    buffer_load_dwordx4 v[140:143], v8, s[12:15], s48 offen sc1
    s_or_b32 s50, s50, 4
    s_cmp_lg_u32 s56, 0
    s_cbranch_scc1 L_tc3
    s_waitcnt lgkmcnt(0)
    ds_read_b64_tr_b16 v[144:145], v36 offset:0
    ds_read_b64_tr_b16 v[146:147], v36 offset:1280
    ds_read_b64_tr_b16 v[148:149], v36 offset:32
    ds_read_b64_tr_b16 v[150:151], v36 offset:1312
    ds_read_b64_tr_b16 v[152:153], v36 offset:64
    ds_read_b64_tr_b16 v[154:155], v36 offset:1344
    ds_read_b64_tr_b16 v[156:157], v36 offset:96
    ds_read_b64_tr_b16 v[158:159], v36 offset:1376
    ds_read_b64_tr_b16 v[160:161], v36 offset:128
    ds_read_b64_tr_b16 v[162:163], v36 offset:1408
    ds_read_b64_tr_b16 v[164:165], v36 offset:6400
    ds_read_b64_tr_b16 v[166:167], v36 offset:7680
    ds_read_b64_tr_b16 v[168:169], v36 offset:6432
    ds_read_b64_tr_b16 v[170:171], v36 offset:7712
    ds_read_b64_tr_b16 v[172:173], v36 offset:6464
    ds_read_b64_tr_b16 v[174:175], v36 offset:7744
    ds_read_b64_tr_b16 v[176:177], v36 offset:6496
    ds_read_b64_tr_b16 v[178:179], v36 offset:7776
    ds_read_b64_tr_b16 v[180:181], v36 offset:6528
    ds_read_b64_tr_b16 v[182:183], v36 offset:7808
    ds_read_b64_tr_b16 v[184:185], v36 offset:12800
    ds_read_b64_tr_b16 v[186:187], v36 offset:14080
    ds_read_b64_tr_b16 v[188:189], v36 offset:12832
    ds_read_b64_tr_b16 v[190:191], v36 offset:14112
    ds_read_b64_tr_b16 v[192:193], v36 offset:12864
    ds_read_b64_tr_b16 v[194:195], v36 offset:14144
    ds_read_b64_tr_b16 v[196:197], v36 offset:12896
    s_nop 0
    s_cbranch_execz L_pfret
    ds_read_b64_tr_b16 v[198:199], v36 offset:14176
    ds_read_b64_tr_b16 v[200:201], v36 offset:12928
    ds_read_b64_tr_b16 v[202:203], v36 offset:14208
    ds_read_b64_tr_b16 v[204:205], v36 offset:19200
    ds_read_b64_tr_b16 v[206:207], v36 offset:20480
    ds_read_b64_tr_b16 v[208:209], v36 offset:19232
    ds_read_b64_tr_b16 v[210:211], v36 offset:20512
    ds_read_b64_tr_b16 v[212:213], v36 offset:19264
    ds_read_b64_tr_b16 v[214:215], v36 offset:20544
    ds_read_b64_tr_b16 v[216:217], v36 offset:19296
    ds_read_b64_tr_b16 v[218:219], v36 offset:20576
    ds_read_b64_tr_b16 v[220:221], v36 offset:19328
    ds_read_b64_tr_b16 v[222:223], v36 offset:20608
    ds_read_b64_tr_b16 v[224:225], v38 offset:0
    ds_read_b64_tr_b16 v[226:227], v38 offset:3200
    ds_read_b64_tr_b16 v[228:229], v38 offset:32
    ds_read_b64_tr_b16 v[230:231], v38 offset:3232
    ds_read_b64_tr_b16 v[232:233], v38 offset:64
    ds_read_b64_tr_b16 v[234:235], v38 offset:3264
    ds_read_b64_tr_b16 v[236:237], v38 offset:96
    ds_read_b64_tr_b16 v[238:239], v38 offset:3296
    ds_read_b64_tr_b16 v[240:241], v38 offset:128
    ds_read_b64_tr_b16 v[242:243], v38 offset:3328
    s_branch L_tw3
L_tf3:
    buffer_load_dwordx4 v[100:103], v1, s[12:15], s49 offen offset:0 sc1
    buffer_load_dwordx4 v[104:107], v1, s[12:15], s49 offen offset:1024 sc1
    buffer_load_dwordx4 v[108:111], v1, s[12:15], s49 offen offset:2048 sc1
    buffer_load_dwordx4 v[112:115], v1, s[12:15], s49 offen offset:3072 sc1
    buffer_load_dwordx4 v[116:119], v8, s[12:15], s49 offen sc1
    s_or_b32 s50, s50, 8
    s_branch L_tloop
L_tloop:
    s_mov_b32 s56, 1
    s_sub_u32 s52, s52, 1
    s_cmp_eq_u32 s52, 0
    s_cselect_b32 s51, -1, s51
L_tc0:
    s_cbranch_execz L_pfret
    s_bitcmp0_b32 s50, 0
    s_cbranch_scc1 L_tc1
    s_bfe_u32 s45, s54, 131072
    s_mul_i32 s45, s45, 25600
    v_add_u32 v36, s45, v35
    v_add_u32 v38, s45, v37
    s_waitcnt lgkmcnt(0)
    ds_read_b64_tr_b16 v[144:145], v36 offset:0
    ds_read_b64_tr_b16 v[146:147], v36 offset:1280
    ds_read_b64_tr_b16 v[148:149], v36 offset:32
    ds_read_b64_tr_b16 v[150:151], v36 offset:1312
    ds_read_b64_tr_b16 v[152:153], v36 offset:64
    ds_read_b64_tr_b16 v[154:155], v36 offset:1344
    ds_read_b64_tr_b16 v[156:157], v36 offset:96
    ds_read_b64_tr_b16 v[158:159], v36 offset:1376
    ds_read_b64_tr_b16 v[160:161], v36 offset:128
    ds_read_b64_tr_b16 v[162:163], v36 offset:1408
    ds_read_b64_tr_b16 v[164:165], v36 offset:6400
    ds_read_b64_tr_b16 v[166:167], v36 offset:7680
    ds_read_b64_tr_b16 v[168:169], v36 offset:6432
    ds_read_b64_tr_b16 v[170:171], v36 offset:7712
    ds_read_b64_tr_b16 v[172:173], v36 offset:6464
    ds_read_b64_tr_b16 v[174:175], v36 offset:7744
    ds_read_b64_tr_b16 v[176:177], v36 offset:6496
    ds_read_b64_tr_b16 v[178:179], v36 offset:7776
    ds_read_b64_tr_b16 v[180:181], v36 offset:6528
    ds_read_b64_tr_b16 v[182:183], v36 offset:7808
    ds_read_b64_tr_b16 v[184:185], v36 offset:12800
    ds_read_b64_tr_b16 v[186:187], v36 offset:14080
    ds_read_b64_tr_b16 v[188:189], v36 offset:12832
    ds_read_b64_tr_b16 v[190:191], v36 offset:14112
    ds_read_b64_tr_b16 v[192:193], v36 offset:12864
    ds_read_b64_tr_b16 v[194:195], v36 offset:14144
    ds_read_b64_tr_b16 v[196:197], v36 offset:12896
    s_cbranch_execz L_pfret
    ds_read_b64_tr_b16 v[198:199], v36 offset:14176
    ds_read_b64_tr_b16 v[200:201], v36 offset:12928
    ds_read_b64_tr_b16 v[202:203], v36 offset:14208
    ds_read_b64_tr_b16 v[204:205], v36 offset:19200
    ds_read_b64_tr_b16 v[206:207], v36 offset:20480
    ds_read_b64_tr_b16 v[208:209], v36 offset:19232
    ds_read_b64_tr_b16 v[210:211], v36 offset:20512
    ds_read_b64_tr_b16 v[212:213], v36 offset:19264
    ds_read_b64_tr_b16 v[214:215], v36 offset:20544
    ds_read_b64_tr_b16 v[216:217], v36 offset:19296
    ds_read_b64_tr_b16 v[218:219], v36 offset:20576
    ds_read_b64_tr_b16 v[220:221], v36 offset:19328
    ds_read_b64_tr_b16 v[222:223], v36 offset:20608
    ds_read_b64_tr_b16 v[224:225], v38 offset:0
    ds_read_b64_tr_b16 v[226:227], v38 offset:3200
    ds_read_b64_tr_b16 v[228:229], v38 offset:32
    ds_read_b64_tr_b16 v[230:231], v38 offset:3232
    ds_read_b64_tr_b16 v[232:233], v38 offset:64
    ds_read_b64_tr_b16 v[234:235], v38 offset:3264
    ds_read_b64_tr_b16 v[236:237], v38 offset:96
    ds_read_b64_tr_b16 v[238:239], v38 offset:3296
    ds_read_b64_tr_b16 v[240:241], v38 offset:128
    ds_read_b64_tr_b16 v[242:243], v38 offset:3328
    s_waitcnt vmcnt(0)
    s_branch L_tv0
L_tc1:
    s_bitcmp0_b32 s50, 1
    s_cbranch_scc1 L_tc2
    s_bfe_u32 s45, s54, 131074
    s_mul_i32 s45, s45, 25600
    v_add_u32 v36, s45, v35
    v_add_u32 v38, s45, v37
    s_waitcnt lgkmcnt(0)
    ds_read_b64_tr_b16 v[144:145], v36 offset:0
    ds_read_b64_tr_b16 v[146:147], v36 offset:1280
    ds_read_b64_tr_b16 v[148:149], v36 offset:32
    s_cbranch_execz L_pfret
    ds_read_b64_tr_b16 v[150:151], v36 offset:1312
    ds_read_b64_tr_b16 v[152:153], v36 offset:64
    ds_read_b64_tr_b16 v[154:155], v36 offset:1344
    ds_read_b64_tr_b16 v[156:157], v36 offset:96
    ds_read_b64_tr_b16 v[158:159], v36 offset:1376
    ds_read_b64_tr_b16 v[160:161], v36 offset:128
    ds_read_b64_tr_b16 v[162:163], v36 offset:1408
    ds_read_b64_tr_b16 v[164:165], v36 offset:6400
    ds_read_b64_tr_b16 v[166:167], v36 offset:7680
    ds_read_b64_tr_b16 v[168:169], v36 offset:6432
    ds_read_b64_tr_b16 v[170:171], v36 offset:7712
    ds_read_b64_tr_b16 v[172:173], v36 offset:6464
    ds_read_b64_tr_b16 v[174:175], v36 offset:7744
    ds_read_b64_tr_b16 v[176:177], v36 offset:6496
    ds_read_b64_tr_b16 v[178:179], v36 offset:7776
    ds_read_b64_tr_b16 v[180:181], v36 offset:6528
    ds_read_b64_tr_b16 v[182:183], v36 offset:7808
    ds_read_b64_tr_b16 v[184:185], v36 offset:12800
    ds_read_b64_tr_b16 v[186:187], v36 offset:14080
    ds_read_b64_tr_b16 v[188:189], v36 offset:12832
    ds_read_b64_tr_b16 v[190:191], v36 offset:14112
    ds_read_b64_tr_b16 v[192:193], v36 offset:12864
    ds_read_b64_tr_b16 v[194:195], v36 offset:14144
    ds_read_b64_tr_b16 v[196:197], v36 offset:12896
    ds_read_b64_tr_b16 v[198:199], v36 offset:14176
    ds_read_b64_tr_b16 v[200:201], v36 offset:12928
    ds_read_b64_tr_b16 v[202:203], v36 offset:14208
    ds_read_b64_tr_b16 v[204:205], v36 offset:19200
    ds_read_b64_tr_b16 v[206:207], v36 offset:20480
    ds_read_b64_tr_b16 v[208:209], v36 offset:19232
    ds_read_b64_tr_b16 v[210:211], v36 offset:20512
    s_nop 0
    s_cbranch_execz L_pfret
    ds_read_b64_tr_b16 v[212:213], v36 offset:19264
    ds_read_b64_tr_b16 v[214:215], v36 offset:20544
    ds_read_b64_tr_b16 v[216:217], v36 offset:19296
    ds_read_b64_tr_b16 v[218:219], v36 offset:20576
    ds_read_b64_tr_b16 v[220:221], v36 offset:19328
    ds_read_b64_tr_b16 v[222:223], v36 offset:20608
    ds_read_b64_tr_b16 v[224:225], v38 offset:0
    ds_read_b64_tr_b16 v[226:227], v38 offset:3200
    ds_read_b64_tr_b16 v[228:229], v38 offset:32
    ds_read_b64_tr_b16 v[230:231], v38 offset:3232
    ds_read_b64_tr_b16 v[232:233], v38 offset:64
    ds_read_b64_tr_b16 v[234:235], v38 offset:3264
    ds_read_b64_tr_b16 v[236:237], v38 offset:96
    ds_read_b64_tr_b16 v[238:239], v38 offset:3296
    ds_read_b64_tr_b16 v[240:241], v38 offset:128
    ds_read_b64_tr_b16 v[242:243], v38 offset:3328
    s_waitcnt vmcnt(0)
    s_branch L_tv1
L_tc2:
    s_bitcmp0_b32 s50, 2
    s_cbranch_scc1 L_tc3
    s_bfe_u32 s45, s54, 131076
    s_mul_i32 s45, s45, 25600
    v_add_u32 v36, s45, v35
    v_add_u32 v38, s45, v37
    s_waitcnt lgkmcnt(0)
    ds_read_b64_tr_b16 v[144:145], v36 offset:0
    ds_read_b64_tr_b16 v[146:147], v36 offset:1280
    ds_read_b64_tr_b16 v[148:149], v36 offset:32
    ds_read_b64_tr_b16 v[150:151], v36 offset:1312
    ds_read_b64_tr_b16 v[152:153], v36 offset:64
    ds_read_b64_tr_b16 v[154:155], v36 offset:1344
    ds_read_b64_tr_b16 v[156:157], v36 offset:96
    ds_read_b64_tr_b16 v[158:159], v36 offset:1376
    ds_read_b64_tr_b16 v[160:161], v36 offset:128
    ds_read_b64_tr_b16 v[162:163], v36 offset:1408
    s_cbranch_execz L_pfret
    ds_read_b64_tr_b16 v[164:165], v36 offset:6400
    ds_read_b64_tr_b16 v[166:167], v36 offset:7680
    ds_read_b64_tr_b16 v[168:169], v36 offset:6432
    ds_read_b64_tr_b16 v[170:171], v36 offset:7712
    ds_read_b64_tr_b16 v[172:173], v36 offset:6464
    ds_read_b64_tr_b16 v[174:175], v36 offset:7744
    ds_read_b64_tr_b16 v[176:177], v36 offset:6496
    ds_read_b64_tr_b16 v[178:179], v36 offset:7776
    ds_read_b64_tr_b16 v[180:181], v36 offset:6528
    ds_read_b64_tr_b16 v[182:183], v36 offset:7808
    ds_read_b64_tr_b16 v[184:185], v36 offset:12800
    ds_read_b64_tr_b16 v[186:187], v36 offset:14080
    ds_read_b64_tr_b16 v[188:189], v36 offset:12832
    ds_read_b64_tr_b16 v[190:191], v36 offset:14112
    ds_read_b64_tr_b16 v[192:193], v36 offset:12864
    ds_read_b64_tr_b16 v[194:195], v36 offset:14144
    ds_read_b64_tr_b16 v[196:197], v36 offset:12896
    ds_read_b64_tr_b16 v[198:199], v36 offset:14176
    ds_read_b64_tr_b16 v[200:201], v36 offset:12928
    ds_read_b64_tr_b16 v[202:203], v36 offset:14208
    ds_read_b64_tr_b16 v[204:205], v36 offset:19200
    ds_read_b64_tr_b16 v[206:207], v36 offset:20480
    ds_read_b64_tr_b16 v[208:209], v36 offset:19232
    ds_read_b64_tr_b16 v[210:211], v36 offset:20512
    ds_read_b64_tr_b16 v[212:213], v36 offset:19264
    ds_read_b64_tr_b16 v[214:215], v36 offset:20544
    ds_read_b64_tr_b16 v[216:217], v36 offset:19296
    ds_read_b64_tr_b16 v[218:219], v36 offset:20576
    ds_read_b64_tr_b16 v[220:221], v36 offset:19328
    ds_read_b64_tr_b16 v[222:223], v36 offset:20608
    ds_read_b64_tr_b16 v[224:225], v38 offset:0
    s_nop 0
    s_cbranch_execz L_pfret
    ds_read_b64_tr_b16 v[226:227], v38 offset:3200
    ds_read_b64_tr_b16 v[228:229], v38 offset:32
    ds_read_b64_tr_b16 v[230:231], v38 offset:3232
    ds_read_b64_tr_b16 v[232:233], v38 offset:64
    ds_read_b64_tr_b16 v[234:235], v38 offset:3264
    ds_read_b64_tr_b16 v[236:237], v38 offset:96
    ds_read_b64_tr_b16 v[238:239], v38 offset:3296
    ds_read_b64_tr_b16 v[240:241], v38 offset:128
    ds_read_b64_tr_b16 v[242:243], v38 offset:3328
    s_waitcnt vmcnt(0)
    s_branch L_tv2
L_tc3:
    s_bitcmp0_b32 s50, 3
    s_cbranch_scc1 L_tc4
    s_bfe_u32 s45, s54, 131078
    s_mul_i32 s45, s45, 25600
    v_add_u32 v36, s45, v35
    v_add_u32 v38, s45, v37
    s_waitcnt lgkmcnt(0)
    ds_read_b64_tr_b16 v[144:145], v36 offset:0
    ds_read_b64_tr_b16 v[146:147], v36 offset:1280
    ds_read_b64_tr_b16 v[148:149], v36 offset:32
    ds_read_b64_tr_b16 v[150:151], v36 offset:1312
    ds_read_b64_tr_b16 v[152:153], v36 offset:64
    ds_read_b64_tr_b16 v[154:155], v36 offset:1344
    ds_read_b64_tr_b16 v[156:157], v36 offset:96
    ds_read_b64_tr_b16 v[158:159], v36 offset:1376
    ds_read_b64_tr_b16 v[160:161], v36 offset:128
    ds_read_b64_tr_b16 v[162:163], v36 offset:1408
    ds_read_b64_tr_b16 v[164:165], v36 offset:6400
    ds_read_b64_tr_b16 v[166:167], v36 offset:7680
    ds_read_b64_tr_b16 v[168:169], v36 offset:6432
    ds_read_b64_tr_b16 v[170:171], v36 offset:7712
    ds_read_b64_tr_b16 v[172:173], v36 offset:6464
    ds_read_b64_tr_b16 v[174:175], v36 offset:7744
    ds_read_b64_tr_b16 v[176:177], v36 offset:6496
    s_cbranch_execz L_pfret
    ds_read_b64_tr_b16 v[178:179], v36 offset:7776
    ds_read_b64_tr_b16 v[180:181], v36 offset:6528
    ds_read_b64_tr_b16 v[182:183], v36 offset:7808
    ds_read_b64_tr_b16 v[184:185], v36 offset:12800
    ds_read_b64_tr_b16 v[186:187], v36 offset:14080
    ds_read_b64_tr_b16 v[188:189], v36 offset:12832
    ds_read_b64_tr_b16 v[190:191], v36 offset:14112
    ds_read_b64_tr_b16 v[192:193], v36 offset:12864
    ds_read_b64_tr_b16 v[194:195], v36 offset:14144
    ds_read_b64_tr_b16 v[196:197], v36 offset:12896
    ds_read_b64_tr_b16 v[198:199], v36 offset:14176
    ds_read_b64_tr_b16 v[200:201], v36 offset:12928
    ds_read_b64_tr_b16 v[202:203], v36 offset:14208
    ds_read_b64_tr_b16 v[204:205], v36 offset:19200
    ds_read_b64_tr_b16 v[206:207], v36 offset:20480
    ds_read_b64_tr_b16 v[208:209], v36 offset:19232
    ds_read_b64_tr_b16 v[210:211], v36 offset:20512
    ds_read_b64_tr_b16 v[212:213], v36 offset:19264
    ds_read_b64_tr_b16 v[214:215], v36 offset:20544
    ds_read_b64_tr_b16 v[216:217], v36 offset:19296
    ds_read_b64_tr_b16 v[218:219], v36 offset:20576
    ds_read_b64_tr_b16 v[220:221], v36 offset:19328
    ds_read_b64_tr_b16 v[222:223], v36 offset:20608
    ds_read_b64_tr_b16 v[224:225], v38 offset:0
    ds_read_b64_tr_b16 v[226:227], v38 offset:3200
    ds_read_b64_tr_b16 v[228:229], v38 offset:32
    ds_read_b64_tr_b16 v[230:231], v38 offset:3232
    ds_read_b64_tr_b16 v[232:233], v38 offset:64
    ds_read_b64_tr_b16 v[234:235], v38 offset:3264
    ds_read_b64_tr_b16 v[236:237], v38 offset:96
    ds_read_b64_tr_b16 v[238:239], v38 offset:3296
    s_nop 0
    s_cbranch_execz L_pfret
    ds_read_b64_tr_b16 v[240:241], v38 offset:128
    ds_read_b64_tr_b16 v[242:243], v38 offset:3328
    s_waitcnt vmcnt(0)
    s_branch L_tv3
L_early:
    s_add_u32 m0, s71, 81920
    s_nop 0
    buffer_load_dwordx4 v33, s[16:19], s45 offen offset:3072 lds
    s_add_u32 m0, s71, 82944
    s_nop 0
    buffer_load_dwordx4 v34, s[16:19], s45 offen offset:3072 lds
    s_waitcnt lgkmcnt(0)
    s_barrier
    s_mov_b32 m0, s101
    s_mov_b64 exec, s[58:59]
    buffer_load_dwordx4 v32, s[16:19], s77 offen offset:2048 lds
    s_mov_b64 exec, -1
    s_mul_i32 s49, s41, 3072
    s_add_u32 m0, s49, s101
    s_nop 0
    buffer_load_dwordx4 v252, s[16:19], s77 offen lds
    buffer_load_dwordx4 v253, s[16:19], s77 offen offset:1024 lds
L_early2:
    s_waitcnt vmcnt(0) lgkmcnt(0)
    s_barrier
L_early3:
    s_waitcnt vmcnt(0) lgkmcnt(0)
    s_lshl_b32 s57, s72, 2
    v_add_u32 v244, s57, v0
    s_lshl_b32 s57, s40, 6
    v_and_b32 v244, 15, v244
    s_add_u32 s57, s64, s57
    v_lshlrev_b32 v244, 2, v244
    s_mov_b64 exec, 0xffff
    buffer_load_dword v245, v244, s[12:15], s57 offen offset:256 sc1
    s_mov_b64 exec, -1
    s_branch L_bfin
L_apath:
    s_waitcnt lgkmcnt(0)
    v_bfe_u32 v92, v0, 2, 2
    v_and_b32 v93, 3, v0
    v_lshlrev_b32 v94, 3, v93
    v_and_b32 v95, 16, v0
    v_cmp_ne_u32 vcc, 0, v95
    s_nop 1
    v_cndmask_b32 v94, v94, 32, vcc
    v_mad_u32_u24 v94, v92, 40, v94
    s_mul_i32 s46, s41, 1600
    s_add_u32 s46, s46, 77824
    v_add_u32 v94, s46, v94
    s_cbranch_execz L_pfret
    v_lshrrev_b32 v96, 5, v0
    v_mul_u32_u24 v97, 320, v96
    v_add_u32 v97, v97, v94
    ds_read_b64_tr_b16 v[88:89], v94 offset:640
    ds_read_b64_tr_b16 v[90:91], v94 offset:1440
    ds_read_b64_tr_b16 v[80:81], v97 offset:0
    ds_read_b64_tr_b16 v[82:83], v97 offset:160
    ds_read_b64_tr_b16 v[84:85], v97 offset:800
    ds_read_b64_tr_b16 v[86:87], v97 offset:960
    s_mov_b32 s52, 0
    s_mov_b32 s53, -1
    s_mov_b32 s54, 1069066811
    s_mov_b32 s55, 1069066811
    v_and_b32 v98, 31, v0
    s_lshl_b32 s46, s36, 10
    v_add_u32 v100, s46, v1
    v_cmp_gt_u32 vcc, 6720, v100
    v_mov_b32 v101, 0x40000000
    s_nop 0
    v_cndmask_b32 v101, v101, v100, vcc
    s_lshl_b32 s47, s39, 17
    s_add_u32 s47, s47, 12582912
    s_waitcnt lgkmcnt(0)
    s_barrier
    ds_read_b128 v[248:251], v27 offset:4096
    ds_read_b128 v[232:235], v27 offset:0
    ds_read_b128 v[236:239], v27 offset:1024
    ds_read_b128 v[240:243], v27 offset:2048
    ds_read_b128 v[244:247], v27 offset:3072
    v_lshlrev_b32 v148, 10, v0
    v_mov_b32 v149, 1
    s_mov_b64 exec, 0xff
    s_bitcmp1_b32 s3, 0
    s_cbranch_scc0 L_h1c3
    buffer_store_dword v149, v148, s[12:15], s76 offen offset:256
    s_branch L_h1d3
L_h1c3:
    buffer_store_dword v149, v148, s[12:15], s76 offen offset:256 sc1
L_h1d3:
    s_mov_b64 exec, -1
    s_mov_b64 exec, s[60:61]
    v_mov_b64 v[88:89], 0
    v_mov_b64 v[90:91], 0
    s_mov_b64 exec, -1
    s_mov_b32 m0, s101
    s_mov_b64 exec, s[58:59]
    s_cbranch_execz L_pfret
    buffer_load_dwordx4 v32, s[16:19], s77 offen offset:2048 lds
    s_mov_b64 exec, -1
    s_mul_i32 s49, s41, 3072
    s_add_u32 m0, s49, s101
    s_nop 0
    buffer_load_dwordx4 v252, s[16:19], s77 offen lds
    buffer_load_dwordx4 v253, s[16:19], s77 offen offset:1024 lds
    v_min_u32 v102, 20, v98
    v_mad_u32_u24 v102, v96, 21, v102
    v_lshlrev_b32 v103, 3, v102
    v_lshlrev_b32 v102, 5, v102
    s_mul_i32 s46, s41, 3360
    s_add_u32 s46, s46, 49152
    v_add_u32 v102, s46, v102
    v_add_u32 v103, s46, v103
    s_waitcnt lgkmcnt(4)
    v_pk_add_f32 v[160:161], v[248:249], v[160:161]
    v_pk_add_f32 v[162:163], v[250:251], v[162:163]
    s_waitcnt lgkmcnt(3)
    v_pk_add_f32 v[128:129], v[232:233], v[128:129]
    v_pk_add_f32 v[130:131], v[234:235], v[130:131]
    v_cvt_pk_bf16_f32 v144, v160, v161
    v_cvt_pk_bf16_f32 v145, v162, v163
    s_waitcnt lgkmcnt(2)
    v_pk_add_f32 v[132:133], v[236:237], v[132:133]
    v_pk_add_f32 v[134:135], v[238:239], v[134:135]
    v_mov_b64 v[146:147], v[144:145]
    v_cvt_pk_bf16_f32 v128, v128, v129
    v_cvt_pk_bf16_f32 v129, v130, v131
    v_cvt_pk_bf16_f32 v130, v132, v133
    v_cvt_pk_bf16_f32 v131, v134, v135
    v_permlane32_swap_b32 v144, v146
    v_permlane32_swap_b32 v145, v147
    s_waitcnt lgkmcnt(1)
    v_pk_add_f32 v[136:137], v[240:241], v[136:137]
    v_pk_add_f32 v[138:139], v[242:243], v[138:139]
    v_permlane16_swap_b32 v128, v130
    v_permlane16_swap_b32 v129, v131
    v_permlane16_swap_b32 v144, v146
    v_permlane16_swap_b32 v145, v147
    s_waitcnt lgkmcnt(0)
    s_nop 0
    s_cbranch_execz L_pfret
    v_pk_add_f32 v[140:141], v[244:245], v[140:141]
    v_pk_add_f32 v[142:143], v[246:247], v[142:143]
    v_mfma_f32_32x32x16_bf16 v[48:63], v[80:83], v[128:131], 0
    v_mfma_f32_32x32x8_bf16 v[48:63], v[88:89], v[144:145], v[48:63]
    v_cvt_pk_bf16_f32 v136, v136, v137
    v_cvt_pk_bf16_f32 v137, v138, v139
    v_cvt_pk_bf16_f32 v138, v140, v141
    v_cvt_pk_bf16_f32 v139, v142, v143
    s_nop 0
    v_permlane16_swap_b32 v136, v138
    v_permlane16_swap_b32 v137, v139
    s_nop 1
    v_mfma_f32_32x32x16_bf16 v[64:79], v[84:87], v[136:139], 0
    v_mfma_f32_32x32x8_bf16 v[64:79], v[90:91], v[146:147], v[64:79]
    v_lshrrev_b32 v92, 3, v98
    v_lshl_add_u32 v92, v92, 2, v93
    v_bfe_u32 v94, v0, 2, 1
    v_xor_b32 v94, v94, v96
    v_lshl_add_u32 v92, v94, 4, v92
    v_and_b32 v94, 1, v0
    v_lshlrev_b32 v94, 4, v94
    v_mov_b32 v95, 0x3f80
    v_lshlrev_b32 v94, v94, v95
    v_lshrrev_b32 v92, 1, v92
    v_cmp_eq_u32 vcc, 0, v92
    s_nop 1
    v_cndmask_b32 v156, 0, v94, vcc
    v_cmp_eq_u32 vcc, 1, v92
    s_nop 1
    v_cndmask_b32 v157, 0, v94, vcc
    v_cmp_eq_u32 vcc, 2, v92
    s_nop 1
    v_cndmask_b32 v158, 0, v94, vcc
    v_cmp_eq_u32 vcc, 3, v92
    s_nop 1
    v_cndmask_b32 v159, 0, v94, vcc
    s_add_u32 m0, s71, 81920
    s_nop 0
    buffer_load_dwordx4 v33, s[16:19], s45 offen offset:3072 lds
    s_add_u32 m0, s71, 82944
    s_nop 0
    buffer_load_dwordx4 v34, s[16:19], s45 offen offset:3072 lds
    v_cndmask_b32 v56, v56, v58, s[52:53]
    s_nop 0
    s_cbranch_execz L_pfret
    v_cndmask_b32 v72, v72, v74, s[52:53]
    v_cndmask_b32 v57, v57, v59, s[52:53]
    v_cndmask_b32 v73, v73, v75, s[52:53]
    v_cvt_pk_bf16_f32 v48, 0, v48
    v_cvt_pk_bf16_f32 v64, 0, v64
    v_cvt_pk_bf16_f32 v49, 0, v49
    v_cvt_pk_bf16_f32 v65, 0, v65
    v_cvt_pk_bf16_f32 v50, 0, v50
    v_cvt_pk_bf16_f32 v66, 0, v66
    v_cvt_pk_bf16_f32 v51, 0, v51
    v_cvt_pk_bf16_f32 v67, 0, v67
    s_sub_u32 m0, 158720, s71
    s_nop 0
    buffer_load_dwordx4 v30, s[16:19], s43 offen offset:0 lds
    buffer_load_dwordx4 v31, s[16:19], s43 offen offset:1024 lds
    buffer_load_dwordx4 v32, s[16:19], s43 offen offset:2048 lds
    v_cvt_pk_bf16_f32 v52, 0, v52
    v_cvt_pk_bf16_f32 v68, 0, v68
    v_cvt_pk_bf16_f32 v53, 0, v53
    v_cvt_pk_bf16_f32 v69, 0, v69
    v_cvt_pk_bf16_f32 v54, 0, v54
    v_cvt_pk_bf16_f32 v70, 0, v70
    v_cvt_pk_bf16_f32 v55, 0, v55
    v_cvt_pk_bf16_f32 v71, 0, v71
    s_mov_b32 s50, 20000
    s_mov_b32 s51, -2
    s_waitcnt vmcnt(9)
L_apoll:
    v_max3_u32 v92, v104, v105, v106
    v_max3_u32 v97, v107, v112, v113
    v_max3_u32 v92, v92, v114, v115
    v_max3_u32 v97, v97, v120, v121
    v_max3_u32 v92, v92, v122, v123
    v_max3_u32 v97, v97, v124, v125
    s_cbranch_execz L_pfret
    v_max3_u32 v92, v92, v126, v127
    v_max3_u32 v97, v97, v200, v201
    v_max3_u32 v92, v92, v202, v203
    v_max3_u32 v97, v97, v44, v45
    v_max3_u32 v92, v92, v46, v47
    v_max3_u32 v97, v97, v108, v109
    v_max3_u32 v92, v92, v110, v111
    v_max3_u32 v97, v97, v116, v117
    v_max3_u32 v92, v92, v118, v119
    v_max3_u32 v97, v97, v168, v169
    v_max3_u32 v92, v92, v170, v171
    v_max3_u32 v97, v97, v172, v173
    v_max3_u32 v92, v92, v174, v175
    v_max3_u32 v97, v97, v176, v177
    v_max3_u32 v92, v92, v178, v179
    v_max3_u32 v97, v97, v180, v181
    v_max3_u32 v92, v92, v182, v183
    v_max3_u32 v97, v97, v184, v185
    v_max3_u32 v92, v92, v186, v187
    v_max3_u32 v97, v97, v188, v189
    v_max3_u32 v92, v92, v190, v191
    v_max3_u32 v97, v97, v192, v193
    v_max3_u32 v92, v92, v194, v195
    v_max3_u32 v97, v97, v196, v197
    v_max3_u32 v92, v92, v198, v199
    v_max_u32 v92, v92, v97
    v_cmp_lt_u32 vcc, s51, v92
    s_cbranch_vccz L_aok
    s_add_u32 s48, s47, 0
    buffer_load_dwordx4 v[104:107], v101, s[12:15], s48 offen sc1
    s_add_u32 s48, s47, 8192
    buffer_load_dwordx4 v[112:115], v101, s[12:15], s48 offen sc1
    s_add_u32 s48, s47, 16384
    s_nop 0
    s_cbranch_execz L_pfret
    buffer_load_dwordx4 v[120:123], v101, s[12:15], s48 offen sc1
    s_add_u32 s48, s47, 24576
    buffer_load_dwordx4 v[124:127], v101, s[12:15], s48 offen sc1
    s_add_u32 s48, s47, 32768
    buffer_load_dwordx4 v[200:203], v101, s[12:15], s48 offen sc1
    s_add_u32 s48, s47, 40960
    buffer_load_dwordx4 v[44:47], v101, s[12:15], s48 offen sc1
    s_add_u32 s48, s47, 49152
    buffer_load_dwordx4 v[108:111], v101, s[12:15], s48 offen sc1
    s_add_u32 s48, s47, 57344
    buffer_load_dwordx4 v[116:119], v101, s[12:15], s48 offen sc1
    s_add_u32 s48, s47, 65536
    buffer_load_dwordx4 v[168:171], v101, s[12:15], s48 offen sc1
    s_add_u32 s48, s47, 73728
    buffer_load_dwordx4 v[172:175], v101, s[12:15], s48 offen sc1
    s_add_u32 s48, s47, 81920
    buffer_load_dwordx4 v[176:179], v101, s[12:15], s48 offen sc1
    s_add_u32 s48, s47, 90112
    buffer_load_dwordx4 v[180:183], v101, s[12:15], s48 offen sc1
    s_add_u32 s48, s47, 98304
    buffer_load_dwordx4 v[184:187], v101, s[12:15], s48 offen sc1
    s_add_u32 s48, s47, 106496
    buffer_load_dwordx4 v[188:191], v101, s[12:15], s48 offen sc1
    s_add_u32 s48, s47, 114688
    buffer_load_dwordx4 v[192:195], v101, s[12:15], s48 offen sc1
    s_add_u32 s48, s47, 122880
    buffer_load_dwordx4 v[196:199], v101, s[12:15], s48 offen sc1
    s_sub_u32 s50, s50, 1
    s_cmp_eq_u32 s50, 0
    s_cselect_b32 s51, -1, s51
    s_waitcnt vmcnt(0)
    s_branch L_apoll
L_aok:
    v_mfma_f32_32x32x16_bf16 v[128:143], v[156:159], v[104:107], 0
    v_cvt_pk_bf16_f32 v56, 0, v56
    s_cbranch_execz L_pfret
    v_cvt_pk_bf16_f32 v72, 0, v72
    v_cvt_pk_bf16_f32 v57, 0, v57
    v_cvt_pk_bf16_f32 v73, 0, v73
    s_sub_u32 m0, 158720, s71
    s_nop 0
    buffer_load_dwordx4 v33, s[16:19], s43 offen offset:3072 lds
    s_sub_u32 m0, 159744, s71
    s_nop 0
    buffer_load_dwordx4 v34, s[16:19], s43 offen offset:3072 lds
    v_mfma_f32_32x32x16_bf16 v[128:143], v[156:159], v[112:115], v[128:143]
    v_max3_f32 v148, v48, v49, v50
    v_max3_f32 v152, v64, v65, v66
    v_max3_f32 v149, -v48, -v49, -v50
    v_max3_f32 v153, -v64, -v65, -v66
    v_mfma_f32_32x32x16_bf16 v[128:143], v[156:159], v[120:123], v[128:143]
    v_max3_f32 v148, v148, v51, v52
    v_max3_f32 v152, v152, v67, v68
    v_max3_f32 v149, v149, -v51, -v52
    v_max3_f32 v153, v153, -v67, -v68
    v_mfma_f32_32x32x16_bf16 v[128:143], v[156:159], v[124:127], v[128:143]
    v_max3_f32 v148, v148, v53, v54
    v_max3_f32 v152, v152, v69, v70
    v_max3_f32 v149, v149, -v53, -v54
    v_max3_f32 v153, v153, -v69, -v70
    v_mfma_f32_32x32x16_bf16 v[128:143], v[156:159], v[200:203], v[128:143]
    v_max3_f32 v148, v148, v55, v56
    v_max3_f32 v152, v152, v71, v72
    v_max3_f32 v149, v149, -v55, -v56
    v_max3_f32 v153, v153, -v71, -v72
    v_mfma_f32_32x32x16_bf16 v[128:143], v[156:159], v[44:47], v[128:143]
    v_max_f32 v148, v148, v57
    v_max_f32 v152, v152, v73
    v_max_f32 v149, v149, -v57
    s_nop 0
    s_cbranch_execz L_pfret
    v_max_f32 v153, v153, -v73
    v_mfma_f32_32x32x16_bf16 v[128:143], v[156:159], v[108:111], v[128:143]
    v_permlane32_swap_b32 v148, v149
    v_permlane32_swap_b32 v152, v153
    v_max_f32 v148, v148, v149
    v_max_f32 v152, v152, v153
    v_mfma_f32_32x32x16_bf16 v[128:143], v[156:159], v[116:119], v[128:143]
    v_mul_f32 v148, s54, -v148
    v_mul_f32 v152, s54, -v152
    v_mov_b32 v150, v148
    v_mov_b32 v154, v152
    v_mfma_f32_32x32x16_bf16 v[128:143], v[156:159], v[168:171], v[128:143]
    v_permlane32_swap_b32 v148, v150
    v_permlane32_swap_b32 v152, v154
    v_pk_fma_f32 v[204:205], v[48:49], s[54:55], v[148:149] op_sel_hi:[1,1,0]
    v_pk_fma_f32 v[224:225], v[64:65], s[54:55], v[152:153] op_sel_hi:[1,1,0]
    v_mfma_f32_32x32x16_bf16 v[128:143], v[156:159], v[172:175], v[128:143]
    v_pk_fma_f32 v[206:207], v[50:51], s[54:55], v[148:149] op_sel_hi:[1,1,0]
    v_pk_fma_f32 v[226:227], v[66:67], s[54:55], v[152:153] op_sel_hi:[1,1,0]
    v_pk_fma_f32 v[208:209], v[52:53], s[54:55], v[148:149] op_sel_hi:[1,1,0]
    v_pk_fma_f32 v[228:229], v[68:69], s[54:55], v[152:153] op_sel_hi:[1,1,0]
    v_mfma_f32_32x32x16_bf16 v[128:143], v[156:159], v[176:179], v[128:143]
    v_pk_fma_f32 v[210:211], v[54:55], s[54:55], v[148:149] op_sel_hi:[1,1,0]
    v_pk_fma_f32 v[230:231], v[70:71], s[54:55], v[152:153] op_sel_hi:[1,1,0]
    v_pk_fma_f32 v[212:213], v[56:57], s[54:55], v[148:149] op_sel_hi:[1,1,0]
    v_pk_fma_f32 v[232:233], v[72:73], s[54:55], v[152:153] op_sel_hi:[1,1,0]
    v_mfma_f32_32x32x16_bf16 v[128:143], v[156:159], v[180:183], v[128:143]
    v_pk_fma_f32 v[214:215], v[48:49], s[54:55], v[150:151] op_sel_hi:[1,1,0] neg_lo:[1,0,0] neg_hi:[1,0,0]
    v_pk_fma_f32 v[234:235], v[64:65], s[54:55], v[154:155] op_sel_hi:[1,1,0] neg_lo:[1,0,0] neg_hi:[1,0,0]
    v_pk_fma_f32 v[216:217], v[50:51], s[54:55], v[150:151] op_sel_hi:[1,1,0] neg_lo:[1,0,0] neg_hi:[1,0,0]
    v_pk_fma_f32 v[236:237], v[66:67], s[54:55], v[154:155] op_sel_hi:[1,1,0] neg_lo:[1,0,0] neg_hi:[1,0,0]
    v_mfma_f32_32x32x16_bf16 v[128:143], v[156:159], v[184:187], v[128:143]
    v_pk_fma_f32 v[218:219], v[52:53], s[54:55], v[150:151] op_sel_hi:[1,1,0] neg_lo:[1,0,0] neg_hi:[1,0,0]
    v_pk_fma_f32 v[238:239], v[68:69], s[54:55], v[154:155] op_sel_hi:[1,1,0] neg_lo:[1,0,0] neg_hi:[1,0,0]
    v_pk_fma_f32 v[220:221], v[54:55], s[54:55], v[150:151] op_sel_hi:[1,1,0] neg_lo:[1,0,0] neg_hi:[1,0,0]
    s_nop 0
    s_cbranch_execz L_pfret
    v_pk_fma_f32 v[240:241], v[70:71], s[54:55], v[154:155] op_sel_hi:[1,1,0] neg_lo:[1,0,0] neg_hi:[1,0,0]
    v_mfma_f32_32x32x16_bf16 v[128:143], v[156:159], v[188:191], v[128:143]
    v_pk_fma_f32 v[222:223], v[56:57], s[54:55], v[150:151] op_sel_hi:[1,1,0] neg_lo:[1,0,0] neg_hi:[1,0,0]
    v_pk_fma_f32 v[242:243], v[72:73], s[54:55], v[154:155] op_sel_hi:[1,1,0] neg_lo:[1,0,0] neg_hi:[1,0,0]
    v_exp_f32 v204, v204
    v_exp_f32 v224, v224
    v_mfma_f32_32x32x16_bf16 v[128:143], v[156:159], v[192:195], v[128:143]
    v_exp_f32 v205, v205
    v_exp_f32 v225, v225
    v_exp_f32 v206, v206
    v_exp_f32 v226, v226
    v_mfma_f32_32x32x16_bf16 v[128:143], v[156:159], v[196:199], v[128:143]
    v_exp_f32 v207, v207
    v_exp_f32 v227, v227
    v_exp_f32 v208, v208
    v_exp_f32 v228, v228
    v_exp_f32 v209, v209
    v_exp_f32 v229, v229
    v_exp_f32 v210, v210
    v_exp_f32 v230, v230
    v_exp_f32 v211, v211
    v_exp_f32 v231, v231
    v_exp_f32 v212, v212
    v_exp_f32 v232, v232
    v_exp_f32 v213, v213
    v_exp_f32 v233, v233
    v_cvt_pk_bf16_f32 v128, v128, v129
    v_cvt_pk_bf16_f32 v129, v130, v131
    v_cvt_pk_bf16_f32 v130, v132, v133
    v_cvt_pk_bf16_f32 v131, v134, v135
    ds_write_b128 v100, v[128:131] offset:49152
    v_exp_f32 v214, v214
    v_exp_f32 v234, v234
    v_exp_f32 v215, v215
    v_exp_f32 v235, v235
    v_exp_f32 v216, v216
    v_exp_f32 v236, v236
    v_exp_f32 v217, v217
    v_exp_f32 v237, v237
    v_exp_f32 v218, v218
    v_exp_f32 v238, v238
    v_exp_f32 v219, v219
    v_exp_f32 v239, v239
    v_exp_f32 v220, v220
    v_exp_f32 v240, v240
    v_exp_f32 v221, v221
    v_exp_f32 v241, v241
    v_exp_f32 v222, v222
    v_exp_f32 v242, v242
    v_exp_f32 v223, v223
    v_exp_f32 v243, v243
    s_nop 0
    s_cbranch_execz L_pfret
    v_pk_add_f32 v[148:149], v[204:205], v[206:207]
    v_pk_add_f32 v[152:153], v[224:225], v[226:227]
    v_pk_add_f32 v[150:151], v[214:215], v[216:217]
    v_pk_add_f32 v[154:155], v[234:235], v[236:237]
    v_pk_add_f32 v[148:149], v[148:149], v[208:209]
    v_pk_add_f32 v[152:153], v[152:153], v[228:229]
    s_waitcnt lgkmcnt(0)
    s_barrier
    ds_read_b128 v[168:171], v102 offset:0
    ds_read_b128 v[172:175], v102 offset:16
    ds_read_b64 v[176:177], v103 offset:1344
    ds_read_b128 v[180:183], v102 offset:1680
    ds_read_b128 v[184:187], v102 offset:1696
    ds_read_b64 v[188:189], v103 offset:3024
    s_lshl_b32 s57, s72, 2
    v_add_u32 v244, s57, v0
    s_lshl_b32 s57, s40, 6
    v_and_b32 v244, 15, v244
    s_add_u32 s57, s64, s57
    v_lshlrev_b32 v244, 2, v244
    s_mov_b64 exec, 0xffff
    buffer_load_dword v245, v244, s[12:15], s57 offen offset:256 sc1
    s_mov_b64 exec, -1
    v_pk_add_f32 v[150:151], v[150:151], v[218:219]
    v_pk_add_f32 v[154:155], v[154:155], v[238:239]
    v_pk_add_f32 v[148:149], v[148:149], v[210:211]
    v_pk_add_f32 v[152:153], v[152:153], v[230:231]
    v_pk_add_f32 v[150:151], v[150:151], v[220:221]
    v_pk_add_f32 v[154:155], v[154:155], v[240:241]
    v_pk_add_f32 v[148:149], v[148:149], v[212:213]
    v_pk_add_f32 v[152:153], v[152:153], v[232:233]
    v_pk_add_f32 v[150:151], v[150:151], v[222:223]
    v_pk_add_f32 v[154:155], v[154:155], v[242:243]
    v_add_f32 v148, v148, v149
    v_add_f32 v152, v152, v153
    v_add_f32 v150, v150, v151
    v_add_f32 v154, v154, v155
    s_nop 0
    v_permlane32_swap_b32 v148, v150
    s_cbranch_execz L_pfret
    v_permlane32_swap_b32 v152, v154
    v_add_f32 v148, v148, v150
    v_add_f32 v152, v152, v154
    v_rcp_f32 v148, v148
    v_rcp_f32 v152, v152
    v_mov_b32 v150, v148
    v_mov_b32 v154, v152
    s_nop 0
    v_permlane32_swap_b32 v148, v150
    v_permlane32_swap_b32 v152, v154
    v_pk_mul_f32 v[204:205], v[204:205], v[148:149] op_sel_hi:[1,0]
    v_pk_mul_f32 v[224:225], v[224:225], v[152:153] op_sel_hi:[1,0]
    v_pk_mul_f32 v[206:207], v[206:207], v[148:149] op_sel_hi:[1,0]
    v_pk_mul_f32 v[226:227], v[226:227], v[152:153] op_sel_hi:[1,0]
    v_pk_mul_f32 v[208:209], v[208:209], v[148:149] op_sel_hi:[1,0]
    v_pk_mul_f32 v[228:229], v[228:229], v[152:153] op_sel_hi:[1,0]
    v_pk_mul_f32 v[210:211], v[210:211], v[148:149] op_sel_hi:[1,0]
    v_pk_mul_f32 v[230:231], v[230:231], v[152:153] op_sel_hi:[1,0]
    v_pk_mul_f32 v[212:213], v[212:213], v[148:149] op_sel_hi:[1,0]
    v_pk_mul_f32 v[232:233], v[232:233], v[152:153] op_sel_hi:[1,0]
    v_pk_mul_f32 v[214:215], v[214:215], v[150:151] op_sel_hi:[1,0]
    v_pk_mul_f32 v[234:235], v[234:235], v[154:155] op_sel_hi:[1,0]
    v_pk_mul_f32 v[216:217], v[216:217], v[150:151] op_sel_hi:[1,0]
    v_pk_mul_f32 v[236:237], v[236:237], v[154:155] op_sel_hi:[1,0]
    v_pk_mul_f32 v[218:219], v[218:219], v[150:151] op_sel_hi:[1,0]
    v_pk_mul_f32 v[238:239], v[238:239], v[154:155] op_sel_hi:[1,0]
    v_pk_mul_f32 v[220:221], v[220:221], v[150:151] op_sel_hi:[1,0]
    v_pk_mul_f32 v[240:241], v[240:241], v[154:155] op_sel_hi:[1,0]
    v_pk_mul_f32 v[222:223], v[222:223], v[150:151] op_sel_hi:[1,0]
    v_pk_mul_f32 v[242:243], v[242:243], v[154:155] op_sel_hi:[1,0]
    v_cvt_pk_bf16_f32 v48, v204, v205
    v_cvt_pk_bf16_f32 v64, v224, v225
    v_cvt_pk_bf16_f32 v49, v206, v207
    v_cvt_pk_bf16_f32 v65, v226, v227
    v_cvt_pk_bf16_f32 v50, v208, v209
    v_cvt_pk_bf16_f32 v66, v228, v229
    s_nop 0
    s_cbranch_execz L_pfret
    v_cvt_pk_bf16_f32 v51, v210, v211
    v_cvt_pk_bf16_f32 v67, v230, v231
    v_cvt_pk_bf16_f32 v52, v212, v213
    v_cvt_pk_bf16_f32 v68, v232, v233
    v_cvt_pk_bf16_f32 v53, v214, v215
    v_cvt_pk_bf16_f32 v69, v234, v235
    v_cvt_pk_bf16_f32 v54, v216, v217
    v_cvt_pk_bf16_f32 v70, v236, v237
    v_cvt_pk_bf16_f32 v55, v218, v219
    v_cvt_pk_bf16_f32 v71, v238, v239
    v_cvt_pk_bf16_f32 v56, v220, v221
    v_cvt_pk_bf16_f32 v72, v240, v241
    v_cvt_pk_bf16_f32 v57, v222, v223
    v_cvt_pk_bf16_f32 v73, v242, v243
    s_waitcnt lgkmcnt(5)
    v_mfma_f32_32x32x16_bf16 v[200:215], v[168:171], v[48:51], 0
    s_waitcnt lgkmcnt(4)
    v_mfma_f32_32x32x16_bf16 v[200:215], v[172:175], v[52:55], v[200:215]
    s_waitcnt lgkmcnt(3)
    v_mfma_f32_32x32x8_bf16 v[200:215], v[176:177], v[56:57], v[200:215]
    s_waitcnt lgkmcnt(2)
    v_mfma_f32_32x32x16_bf16 v[216:231], v[180:183], v[64:67], 0
    s_waitcnt lgkmcnt(1)
    v_mfma_f32_32x32x16_bf16 v[216:231], v[184:187], v[68:71], v[216:231]
    s_waitcnt lgkmcnt(0)
    v_mfma_f32_32x32x8_bf16 v[216:231], v[188:189], v[72:73], v[216:231]
    s_nop 5
    v_cvt_pk_bf16_f32 v148, 0, v212
    v_cvt_pk_bf16_f32 v200, 0, v200
    v_cvt_pk_bf16_f32 v201, 0, v201
    v_cvt_pk_bf16_f32 v202, 0, v202
    v_cvt_pk_bf16_f32 v203, 0, v203
    v_add_f32 v148, 897988541, v148
    v_cvt_pk_bf16_f32 v204, 0, v204
    v_cvt_pk_bf16_f32 v205, 0, v205
    s_cbranch_execz L_pfret
    v_cvt_pk_bf16_f32 v206, 0, v206
    v_cvt_pk_bf16_f32 v207, 0, v207
    v_cvt_pk_bf16_f32 v148, 0, v148
    v_cvt_pk_bf16_f32 v208, 0, v208
    v_cvt_pk_bf16_f32 v209, 0, v209
    v_rcp_f32 v148, v148
    v_cvt_pk_bf16_f32 v210, 0, v210
    v_cvt_pk_bf16_f32 v211, 0, v211
    v_pk_mul_f32 v[200:201], v[200:201], v[148:149] op_sel_hi:[1,0]
    v_pk_mul_f32 v[202:203], v[202:203], v[148:149] op_sel_hi:[1,0]
    v_pk_mul_f32 v[204:205], v[204:205], v[148:149] op_sel_hi:[1,0]
    v_pk_mul_f32 v[206:207], v[206:207], v[148:149] op_sel_hi:[1,0]
    v_pk_mul_f32 v[208:209], v[208:209], v[148:149] op_sel_hi:[1,0]
    v_pk_mul_f32 v[210:211], v[210:211], v[148:149] op_sel_hi:[1,0]
    v_cvt_pk_bf16_f32 v112, v200, v201
    v_cvt_pk_bf16_f32 v113, v202, v203
    v_cvt_pk_bf16_f32 v114, v204, v205
    v_cvt_pk_bf16_f32 v115, v206, v207
    v_cvt_pk_bf16_f32 v120, v208, v209
    v_cvt_pk_bf16_f32 v121, v210, v211
    v_cvt_pk_bf16_f32 v150, 0, v228
    v_cvt_pk_bf16_f32 v216, 0, v216
    v_cvt_pk_bf16_f32 v217, 0, v217
    v_cvt_pk_bf16_f32 v218, 0, v218
    v_cvt_pk_bf16_f32 v219, 0, v219
    v_add_f32 v150, 897988541, v150
    v_cvt_pk_bf16_f32 v220, 0, v220
    v_cvt_pk_bf16_f32 v221, 0, v221
    v_cvt_pk_bf16_f32 v222, 0, v222
    v_cvt_pk_bf16_f32 v223, 0, v223
    v_cvt_pk_bf16_f32 v150, 0, v150
    v_cvt_pk_bf16_f32 v224, 0, v224
    s_cbranch_execz L_pfret
    v_cvt_pk_bf16_f32 v225, 0, v225
    v_rcp_f32 v150, v150
    v_cvt_pk_bf16_f32 v226, 0, v226
    v_cvt_pk_bf16_f32 v227, 0, v227
    v_pk_mul_f32 v[216:217], v[216:217], v[150:151] op_sel_hi:[1,0]
    v_pk_mul_f32 v[218:219], v[218:219], v[150:151] op_sel_hi:[1,0]
    v_pk_mul_f32 v[220:221], v[220:221], v[150:151] op_sel_hi:[1,0]
    v_pk_mul_f32 v[222:223], v[222:223], v[150:151] op_sel_hi:[1,0]
    v_pk_mul_f32 v[224:225], v[224:225], v[150:151] op_sel_hi:[1,0]
    v_pk_mul_f32 v[226:227], v[226:227], v[150:151] op_sel_hi:[1,0]
    v_cvt_pk_bf16_f32 v116, v216, v217
    v_cvt_pk_bf16_f32 v117, v218, v219
    v_cvt_pk_bf16_f32 v118, v220, v221
    v_cvt_pk_bf16_f32 v119, v222, v223
    v_cvt_pk_bf16_f32 v122, v224, v225
    v_cvt_pk_bf16_f32 v123, v226, v227
    s_nop 1
    s_branch L_tail
L_ains0:
    s_mov_b32 s50, 1065369472
    s_mov_b32 s51, 1065369472
    v_mov_b64 v[2:3], s[50:51]
    v_mov_b64 v[4:5], s[50:51]
    v_mov_b64 v[6:7], s[50:51]
    v_mov_b64 v[8:9], s[50:51]
    v_cvt_pk_bf16_f32 v88, v88, v89
    v_cvt_pk_bf16_f32 v89, v90, v91
    v_cvt_pk_bf16_f32 v90, v92, v93
    v_cvt_pk_bf16_f32 v91, v94, v95
    v_cvt_pk_bf16_f32 v96, v96, v97
    v_cvt_pk_bf16_f32 v97, v98, v99
    v_cvt_pk_bf16_f32 v98, v100, v101
    v_cvt_pk_bf16_f32 v99, v102, v103
    v_permlane16_swap_b32 v88, v90
    v_permlane16_swap_b32 v89, v91
    v_cvt_pk_bf16_f32 v104, v104, v105
    v_cvt_pk_bf16_f32 v105, v106, v107
    s_cbranch_execz L_pfret
    v_cvt_pk_bf16_f32 v106, v108, v109
    v_cvt_pk_bf16_f32 v107, v110, v111
    v_permlane16_swap_b32 v96, v98
    v_permlane16_swap_b32 v97, v99
    ds_write_b128 v28, v[88:91] offset:0
    v_cvt_pk_bf16_f32 v112, v112, v113
    v_cvt_pk_bf16_f32 v113, v114, v115
    v_cvt_pk_bf16_f32 v114, v116, v117
    v_cvt_pk_bf16_f32 v115, v118, v119
    v_permlane16_swap_b32 v104, v106
    v_permlane16_swap_b32 v105, v107
    ds_write_b128 v28, v[96:99] offset:1024
    v_cvt_pk_bf16_f32 v120, v120, v121
    v_cvt_pk_bf16_f32 v121, v122, v123
    v_cvt_pk_bf16_f32 v122, v124, v125
    v_cvt_pk_bf16_f32 v123, v126, v127
    v_permlane16_swap_b32 v112, v114
    v_permlane16_swap_b32 v113, v115
    ds_write_b128 v28, v[104:107] offset:2048
    v_permlane16_swap_b32 v120, v122
    v_permlane16_swap_b32 v121, v123
    ds_write_b128 v28, v[112:115] offset:3072
    ds_write_b128 v28, v[120:123] offset:4096
    s_branch L_aphi
L_ains1:
    s_mov_b32 s50, 1065369472
    s_mov_b32 s51, 1065369472
    v_mov_b64 v[2:3], s[50:51]
    v_mov_b64 v[4:5], s[50:51]
    v_mov_b64 v[6:7], s[50:51]
    v_mov_b64 v[8:9], s[50:51]
    v_cvt_pk_bf16_f32 v88, v88, v89
    v_cvt_pk_bf16_f32 v89, v90, v91
    v_cvt_pk_bf16_f32 v90, v92, v93
    v_cvt_pk_bf16_f32 v91, v94, v95
    v_cvt_pk_bf16_f32 v96, v96, v97
    v_cvt_pk_bf16_f32 v97, v98, v99
    v_cvt_pk_bf16_f32 v98, v100, v101
    v_cvt_pk_bf16_f32 v99, v102, v103
    s_cbranch_execz L_pfret
    v_permlane32_swap_b32 v88, v90
    v_permlane32_swap_b32 v89, v91
    v_cvt_pk_bf16_f32 v104, v104, v105
    v_cvt_pk_bf16_f32 v105, v106, v107
    v_cvt_pk_bf16_f32 v106, v108, v109
    v_cvt_pk_bf16_f32 v107, v110, v111
    v_permlane32_swap_b32 v96, v98
    v_permlane32_swap_b32 v97, v99
    ds_write_b128 v28, v[88:91] offset:0
    v_cvt_pk_bf16_f32 v112, v112, v113
    v_cvt_pk_bf16_f32 v113, v114, v115
    v_cvt_pk_bf16_f32 v114, v116, v117
    v_cvt_pk_bf16_f32 v115, v118, v119
    v_permlane32_swap_b32 v104, v106
    v_permlane32_swap_b32 v105, v107
    ds_write_b128 v28, v[96:99] offset:1024
    v_cvt_pk_bf16_f32 v120, v120, v121
    v_cvt_pk_bf16_f32 v121, v122, v123
    v_cvt_pk_bf16_f32 v122, v124, v125
    v_cvt_pk_bf16_f32 v123, v126, v127
    v_permlane32_swap_b32 v112, v114
    v_permlane32_swap_b32 v113, v115
    ds_write_b128 v28, v[104:107] offset:2048
    v_permlane32_swap_b32 v120, v122
    v_permlane32_swap_b32 v121, v123
    ds_write_b128 v28, v[112:115] offset:3072
    ds_write_b128 v28, v[120:123] offset:4096
L_aphi:
    v_mov_b64 v[160:161], -1
    v_mov_b64 v[162:163], -1
    v_bfe_u32 v80, v0, 2, 2
    v_and_b32 v81, 3, v0
    v_lshlrev_b32 v82, 3, v81
    v_and_b32 v83, 16, v0
    v_cmp_ne_u32 vcc, 0, v83
    s_nop 1
    v_cndmask_b32 v82, v82, 32, vcc
    v_mad_u32_u24 v82, v80, 40, v82
    s_mul_i32 s46, s41, 1600
    s_add_u32 s46, s46, 77824
    v_add_u32 v82, s46, v82
    v_lshrrev_b32 v84, 5, v0
    s_cbranch_execz L_pfret
    v_mul_u32_u24 v85, 320, v84
    v_add_u32 v85, v85, v82
    ds_read_b64_tr_b16 v[76:77], v82 offset:640
    ds_read_b64_tr_b16 v[78:79], v82 offset:1440
    ds_read_b64_tr_b16 v[68:69], v85 offset:0
    ds_read_b64_tr_b16 v[70:71], v85 offset:160
    ds_read_b64_tr_b16 v[72:73], v85 offset:800
    ds_read_b64_tr_b16 v[74:75], v85 offset:960
    s_mov_b32 s52, 0
    s_mov_b32 s53, -1
    s_mov_b32 s54, 1069066811
    s_mov_b32 s55, 1069066811
    buffer_store_dwordx4 v[160:163], v29, s[12:15], s73 offen sc1
    buffer_store_dwordx4 v[160:163], v29, s[12:15], s73 offen offset:512 sc1
    s_mov_b32 exec_hi, 0
    buffer_store_dwordx4 v[160:163], v29, s[12:15], s74 offen sc1
    s_mov_b32 exec_hi, -1
    v_mov_b64 v[92:93], s[50:51]
    v_mov_b64 v[94:95], s[50:51]
    v_mov_b64 v[100:101], s[50:51]
    v_mov_b64 v[102:103], s[50:51]
    v_mov_b64 v[40:41], 0
    v_mov_b64 v[42:43], 0
    v_and_b32 v86, 31, v0
    v_mul_u32_u24 v124, 96, v86
    v_mad_u32_u24 v124, v84, 48, v124
    s_mul_i32 s46, s41, 24576
    s_mul_i32 s47, s40, 3072
    s_add_u32 s46, s46, s47
    v_add_u32 v124, s46, v124
    s_mul_i32 s46, s41, 20480
    v_add_u32 v45, s46, v124
    s_waitcnt lgkmcnt(0)
    s_barrier
    ds_read_b128 v[88:91], v11 offset:40960
    s_mov_b64 exec, s[58:59]
    ds_read_b128 v[40:43], v13 offset:40960
    s_mov_b64 exec, -1
    ds_read_b128 v[96:99], v11 offset:41984
    s_mov_b64 exec, s[60:61]
    v_mov_b64 v[76:77], 0
    v_mov_b64 v[78:79], 0
    s_mov_b64 exec, -1
    s_cbranch_execz L_pfret
    s_lshr_b32 s46, s36, 1
    s_and_b32 s47, s36, 1
    v_lshl_add_u32 v125, v84, 2, v80
    v_mul_u32_u24 v125, 96, v125
    v_and_b32 v126, 1, v0
    v_mad_u32_u24 v125, v126, 48, v125
    v_add_u32 v125, v125, v83
    v_bfe_u32 v126, v0, 1, 1
    v_lshl_add_u32 v125, v126, 3, v125
    s_mul_i32 s48, s46, 12288
    s_cmp_eq_u32 s46, 3
    s_cselect_b32 s48, 57344, s48
    s_lshl_b32 s49, s47, 5
    s_add_u32 s48, s48, s49
    v_add_u32 v125, s48, v125
    s_waitcnt lgkmcnt(2)
    v_mfma_f32_32x32x16_bf16 v[128:143], v[68:71], v[88:91], 0
    s_waitcnt lgkmcnt(1)
    v_mfma_f32_32x32x8_bf16 v[128:143], v[76:77], v[40:41], v[128:143]
    s_waitcnt lgkmcnt(0)
    v_mfma_f32_32x32x16_bf16 v[144:159], v[72:75], v[96:99], 0
    v_mfma_f32_32x32x8_bf16 v[144:159], v[78:79], v[42:43], v[144:159]
    v_lshlrev_b32 v126, 4, v86
    v_lshl_add_u32 v126, v84, 8, v126
    s_lshl_b32 s48, s46, 10
    s_add_u32 s48, s48, 87040
    s_lshl_b32 s49, s46, 6
    s_add_u32 s49, s49, 90880
    v_mov_b32 v127, s49
    v_mov_b32 v87, s48
    v_cmp_gt_u32 vcc, 16, v86
    s_nop 1
    v_cndmask_b32 v127, v127, v87, vcc
    v_add_u32 v126, v126, v127
    s_mov_b64 exec, s[62:63]
    ds_read_b128 v[2:5], v126 offset:0
    ds_read_b128 v[6:9], v126 offset:512
    ds_read_b128 v[92:95], v126 offset:10240
    ds_read_b128 v[100:103], v126 offset:10752
    s_mov_b64 exec, -1
    v_min_u32 v127, 20, v86
    v_mad_u32_u24 v127, v84, 21, v127
    v_lshlrev_b32 v44, 3, v127
    v_lshlrev_b32 v127, 5, v127
    s_cbranch_execz L_pfret
    s_lshl_b32 s48, s39, 4
    s_add_u32 s48, s48, s38
    s_lshl_b32 s48, s48, 13
    s_mul_i32 s49, s46, 1680
    s_add_u32 s48, s48, s49
    s_add_u32 s48, s48, 12582912
    v_cndmask_b32 v136, v136, v138, s[52:53]
    v_cndmask_b32 v152, v152, v154, s[52:53]
    v_cndmask_b32 v137, v137, v139, s[52:53]
    v_cndmask_b32 v153, v153, v155, s[52:53]
    v_cvt_pk_bf16_f32 v128, 0, v128
    v_cvt_pk_bf16_f32 v144, 0, v144
    v_cvt_pk_bf16_f32 v129, 0, v129
    v_cvt_pk_bf16_f32 v145, 0, v145
    v_cvt_pk_bf16_f32 v130, 0, v130
    v_cvt_pk_bf16_f32 v146, 0, v146
    v_cvt_pk_bf16_f32 v131, 0, v131
    v_cvt_pk_bf16_f32 v147, 0, v147
    v_cvt_pk_bf16_f32 v132, 0, v132
    v_cvt_pk_bf16_f32 v148, 0, v148
    v_cvt_pk_bf16_f32 v133, 0, v133
    v_cvt_pk_bf16_f32 v149, 0, v149
    v_cvt_pk_bf16_f32 v134, 0, v134
    v_cvt_pk_bf16_f32 v150, 0, v150
    v_cvt_pk_bf16_f32 v135, 0, v135
    v_cvt_pk_bf16_f32 v151, 0, v151
    v_cvt_pk_bf16_f32 v136, 0, v136
    v_cvt_pk_bf16_f32 v152, 0, v152
    v_cvt_pk_bf16_f32 v137, 0, v137
    v_cvt_pk_bf16_f32 v153, 0, v153
    v_max3_f32 v160, v128, v129, v130
    v_max3_f32 v164, v144, v145, v146
    v_max3_f32 v161, -v128, -v129, -v130
    s_nop 0
    s_cbranch_execz L_pfret
    v_max3_f32 v165, -v144, -v145, -v146
    v_max3_f32 v160, v160, v131, v132
    v_max3_f32 v164, v164, v147, v148
    v_max3_f32 v161, v161, -v131, -v132
    v_max3_f32 v165, v165, -v147, -v148
    v_max3_f32 v160, v160, v133, v134
    v_max3_f32 v164, v164, v149, v150
    v_max3_f32 v161, v161, -v133, -v134
    v_max3_f32 v165, v165, -v149, -v150
    v_max3_f32 v160, v160, v135, v136
    v_max3_f32 v164, v164, v151, v152
    v_max3_f32 v161, v161, -v135, -v136
    v_max3_f32 v165, v165, -v151, -v152
    v_max_f32 v160, v160, v137
    v_max_f32 v164, v164, v153
    v_max_f32 v161, v161, -v137
    v_max_f32 v165, v165, -v153
    s_nop 0
    v_permlane32_swap_b32 v160, v161
    v_permlane32_swap_b32 v164, v165
    v_max_f32 v160, v160, v161
    v_max_f32 v164, v164, v165
    v_mul_f32 v160, s54, -v160
    v_mul_f32 v164, s54, -v164
    v_mov_b32 v162, v160
    v_mov_b32 v166, v164
    s_nop 0
    v_permlane32_swap_b32 v160, v162
    v_permlane32_swap_b32 v164, v166
    v_pk_fma_f32 v[68:69], v[128:129], s[54:55], v[160:161] op_sel_hi:[1,1,0]
    v_pk_fma_f32 v[104:105], v[144:145], s[54:55], v[164:165] op_sel_hi:[1,1,0]
    v_pk_fma_f32 v[70:71], v[130:131], s[54:55], v[160:161] op_sel_hi:[1,1,0]
    v_pk_fma_f32 v[106:107], v[146:147], s[54:55], v[164:165] op_sel_hi:[1,1,0]
    v_pk_fma_f32 v[72:73], v[132:133], s[54:55], v[160:161] op_sel_hi:[1,1,0]
    v_pk_fma_f32 v[108:109], v[148:149], s[54:55], v[164:165] op_sel_hi:[1,1,0]
    v_pk_fma_f32 v[74:75], v[134:135], s[54:55], v[160:161] op_sel_hi:[1,1,0]
    v_pk_fma_f32 v[110:111], v[150:151], s[54:55], v[164:165] op_sel_hi:[1,1,0]
    s_nop 0
    s_cbranch_execz L_pfret
    v_pk_fma_f32 v[76:77], v[136:137], s[54:55], v[160:161] op_sel_hi:[1,1,0]
    v_pk_fma_f32 v[112:113], v[152:153], s[54:55], v[164:165] op_sel_hi:[1,1,0]
    v_pk_fma_f32 v[78:79], v[128:129], s[54:55], v[162:163] op_sel_hi:[1,1,0] neg_lo:[1,0,0] neg_hi:[1,0,0]
    v_pk_fma_f32 v[114:115], v[144:145], s[54:55], v[166:167] op_sel_hi:[1,1,0] neg_lo:[1,0,0] neg_hi:[1,0,0]
    v_pk_fma_f32 v[80:81], v[130:131], s[54:55], v[162:163] op_sel_hi:[1,1,0] neg_lo:[1,0,0] neg_hi:[1,0,0]
    v_pk_fma_f32 v[116:117], v[146:147], s[54:55], v[166:167] op_sel_hi:[1,1,0] neg_lo:[1,0,0] neg_hi:[1,0,0]
    v_pk_fma_f32 v[82:83], v[132:133], s[54:55], v[162:163] op_sel_hi:[1,1,0] neg_lo:[1,0,0] neg_hi:[1,0,0]
    v_pk_fma_f32 v[118:119], v[148:149], s[54:55], v[166:167] op_sel_hi:[1,1,0] neg_lo:[1,0,0] neg_hi:[1,0,0]
    v_pk_fma_f32 v[84:85], v[134:135], s[54:55], v[162:163] op_sel_hi:[1,1,0] neg_lo:[1,0,0] neg_hi:[1,0,0]
    v_pk_fma_f32 v[120:121], v[150:151], s[54:55], v[166:167] op_sel_hi:[1,1,0] neg_lo:[1,0,0] neg_hi:[1,0,0]
    v_pk_fma_f32 v[86:87], v[136:137], s[54:55], v[162:163] op_sel_hi:[1,1,0] neg_lo:[1,0,0] neg_hi:[1,0,0]
    v_pk_fma_f32 v[122:123], v[152:153], s[54:55], v[166:167] op_sel_hi:[1,1,0] neg_lo:[1,0,0] neg_hi:[1,0,0]
    v_exp_f32 v68, v68
    v_exp_f32 v104, v104
    v_exp_f32 v69, v69
    v_exp_f32 v105, v105
    v_exp_f32 v70, v70
    v_exp_f32 v106, v106
    v_exp_f32 v71, v71
    v_exp_f32 v107, v107
    v_exp_f32 v72, v72
    v_exp_f32 v108, v108
    v_exp_f32 v73, v73
    v_exp_f32 v109, v109
    v_exp_f32 v74, v74
    v_exp_f32 v110, v110
    v_exp_f32 v75, v75
    v_exp_f32 v111, v111
    v_exp_f32 v76, v76
    v_exp_f32 v112, v112
    v_exp_f32 v77, v77
    v_exp_f32 v113, v113
    v_exp_f32 v78, v78
    v_exp_f32 v114, v114
    v_exp_f32 v79, v79
    v_exp_f32 v115, v115
    v_exp_f32 v80, v80
    v_exp_f32 v116, v116
    v_exp_f32 v81, v81
    v_exp_f32 v117, v117
    v_exp_f32 v82, v82
    v_exp_f32 v118, v118
    v_exp_f32 v83, v83
    v_exp_f32 v119, v119
    v_exp_f32 v84, v84
    v_exp_f32 v120, v120
    v_exp_f32 v85, v85
    v_exp_f32 v121, v121
    v_exp_f32 v86, v86
    v_exp_f32 v122, v122
    v_exp_f32 v87, v87
    s_cbranch_execz L_pfret
    v_exp_f32 v123, v123
    v_pk_add_f32 v[160:161], v[68:69], v[70:71]
    v_pk_add_f32 v[164:165], v[104:105], v[106:107]
    v_pk_add_f32 v[162:163], v[78:79], v[80:81]
    v_pk_add_f32 v[166:167], v[114:115], v[116:117]
    v_pk_add_f32 v[160:161], v[160:161], v[72:73]
    v_pk_add_f32 v[164:165], v[164:165], v[108:109]
    v_pk_add_f32 v[162:163], v[162:163], v[82:83]
    v_pk_add_f32 v[166:167], v[166:167], v[118:119]
    v_pk_add_f32 v[160:161], v[160:161], v[74:75]
    v_pk_add_f32 v[164:165], v[164:165], v[110:111]
    v_pk_add_f32 v[162:163], v[162:163], v[84:85]
    v_pk_add_f32 v[166:167], v[166:167], v[120:121]
    v_pk_add_f32 v[160:161], v[160:161], v[76:77]
    v_pk_add_f32 v[164:165], v[164:165], v[112:113]
    v_pk_add_f32 v[162:163], v[162:163], v[86:87]
    v_pk_add_f32 v[166:167], v[166:167], v[122:123]
    v_add_f32 v160, v160, v161
    v_add_f32 v164, v164, v165
    v_add_f32 v162, v162, v163
    v_add_f32 v166, v166, v167
    s_nop 0
    v_permlane32_swap_b32 v160, v162
    v_permlane32_swap_b32 v164, v166
    v_add_f32 v160, v160, v162
    v_add_f32 v164, v164, v166
    v_rcp_f32 v160, v160
    v_rcp_f32 v164, v164
    v_mov_b32 v162, v160
    v_mov_b32 v166, v164
    s_nop 0
    v_permlane32_swap_b32 v160, v162
    v_permlane32_swap_b32 v164, v166
    v_pk_mul_f32 v[68:69], v[68:69], v[160:161] op_sel_hi:[1,0]
    v_pk_mul_f32 v[104:105], v[104:105], v[164:165] op_sel_hi:[1,0]
    v_pk_mul_f32 v[70:71], v[70:71], v[160:161] op_sel_hi:[1,0]
    v_pk_mul_f32 v[106:107], v[106:107], v[164:165] op_sel_hi:[1,0]
    v_pk_mul_f32 v[72:73], v[72:73], v[160:161] op_sel_hi:[1,0]
    v_pk_mul_f32 v[108:109], v[108:109], v[164:165] op_sel_hi:[1,0]
    v_pk_mul_f32 v[74:75], v[74:75], v[160:161] op_sel_hi:[1,0]
    s_cbranch_execz L_pfret
    v_pk_mul_f32 v[110:111], v[110:111], v[164:165] op_sel_hi:[1,0]
    v_pk_mul_f32 v[76:77], v[76:77], v[160:161] op_sel_hi:[1,0]
    v_pk_mul_f32 v[112:113], v[112:113], v[164:165] op_sel_hi:[1,0]
    v_pk_mul_f32 v[78:79], v[78:79], v[162:163] op_sel_hi:[1,0]
    v_pk_mul_f32 v[114:115], v[114:115], v[166:167] op_sel_hi:[1,0]
    v_pk_mul_f32 v[80:81], v[80:81], v[162:163] op_sel_hi:[1,0]
    v_pk_mul_f32 v[116:117], v[116:117], v[166:167] op_sel_hi:[1,0]
    v_pk_mul_f32 v[82:83], v[82:83], v[162:163] op_sel_hi:[1,0]
    v_pk_mul_f32 v[118:119], v[118:119], v[166:167] op_sel_hi:[1,0]
    v_pk_mul_f32 v[84:85], v[84:85], v[162:163] op_sel_hi:[1,0]
    v_pk_mul_f32 v[120:121], v[120:121], v[166:167] op_sel_hi:[1,0]
    v_pk_mul_f32 v[86:87], v[86:87], v[162:163] op_sel_hi:[1,0]
    v_pk_mul_f32 v[122:123], v[122:123], v[166:167] op_sel_hi:[1,0]
    v_cvt_pk_bf16_f32 v128, v68, v69
    v_cvt_pk_bf16_f32 v144, v104, v105
    v_cvt_pk_bf16_f32 v129, v70, v71
    v_cvt_pk_bf16_f32 v145, v106, v107
    v_cvt_pk_bf16_f32 v130, v72, v73
    v_cvt_pk_bf16_f32 v146, v108, v109
    v_cvt_pk_bf16_f32 v131, v74, v75
    v_cvt_pk_bf16_f32 v147, v110, v111
    v_cvt_pk_bf16_f32 v132, v76, v77
    v_cvt_pk_bf16_f32 v148, v112, v113
    v_cvt_pk_bf16_f32 v133, v78, v79
    v_cvt_pk_bf16_f32 v149, v114, v115
    v_cvt_pk_bf16_f32 v134, v80, v81
    v_cvt_pk_bf16_f32 v150, v116, v117
    v_cvt_pk_bf16_f32 v135, v82, v83
    v_cvt_pk_bf16_f32 v151, v118, v119
    v_cvt_pk_bf16_f32 v136, v84, v85
    v_cvt_pk_bf16_f32 v152, v120, v121
    s_nop 0
    s_cbranch_execz L_pfret
    v_cvt_pk_bf16_f32 v137, v86, v87
    v_cvt_pk_bf16_f32 v153, v122, v123
    ds_write_b128 v124, v[128:131] offset:0
    ds_write_b128 v124, v[132:135] offset:16
    ds_write_b64 v124, v[136:137] offset:32
    ds_write_b128 v45, v[144:147] offset:12288
    ds_write_b128 v45, v[148:151] offset:12304
    ds_write_b64 v45, v[152:153] offset:12320
    s_waitcnt lgkmcnt(0)
    s_barrier
    ds_read_b64_tr_b16 v[68:69], v125 offset:0
    ds_read_b64_tr_b16 v[70:71], v125 offset:768
    ds_read_b64_tr_b16 v[72:73], v125 offset:1536
    ds_read_b64_tr_b16 v[74:75], v125 offset:2304
    ds_read_b64_tr_b16 v[76:77], v125 offset:3072
    ds_read_b64_tr_b16 v[78:79], v125 offset:3840
    ds_read_b64_tr_b16 v[80:81], v125 offset:4608
    ds_read_b64_tr_b16 v[82:83], v125 offset:5376
    ds_read_b64_tr_b16 v[84:85], v125 offset:6144
    ds_read_b64_tr_b16 v[86:87], v125 offset:6912
    ds_read_b64_tr_b16 v[104:105], v125 offset:7680
    ds_read_b64_tr_b16 v[106:107], v125 offset:8448
    ds_read_b64_tr_b16 v[108:109], v125 offset:9216
    ds_read_b64_tr_b16 v[110:111], v125 offset:9984
    ds_read_b64_tr_b16 v[112:113], v125 offset:10752
    ds_read_b64_tr_b16 v[114:115], v125 offset:11520
    s_waitcnt lgkmcnt(14)
    v_mfma_f32_32x32x16_bf16 v[128:143], v[68:71], v[2:5], 0
    s_waitcnt lgkmcnt(12)
    v_mfma_f32_32x32x16_bf16 v[128:143], v[72:75], v[6:9], v[128:143]
    s_mov_b64 exec, s[62:63]
    ds_read_b128 v[2:5], v126 offset:20480
    ds_read_b128 v[6:9], v126 offset:20992
    s_mov_b64 exec, -1
    s_waitcnt lgkmcnt(12)
    s_cbranch_execz L_pfret
    v_mfma_f32_32x32x16_bf16 v[128:143], v[76:79], v[92:95], v[128:143]
    s_waitcnt lgkmcnt(10)
    v_mfma_f32_32x32x16_bf16 v[128:143], v[80:83], v[100:103], v[128:143]
    s_mov_b64 exec, s[62:63]
    ds_read_b128 v[92:95], v126 offset:30720
    ds_read_b128 v[100:103], v126 offset:31232
    s_mov_b64 exec, -1
    s_waitcnt lgkmcnt(3)
    v_mfma_f32_32x32x16_bf16 v[128:143], v[84:87], v[2:5], v[128:143]
    s_waitcnt lgkmcnt(2)
    v_mfma_f32_32x32x16_bf16 v[128:143], v[104:107], v[6:9], v[128:143]
    s_waitcnt lgkmcnt(1)
    v_mfma_f32_32x32x16_bf16 v[128:143], v[108:111], v[92:95], v[128:143]
    s_waitcnt lgkmcnt(0)
    v_mfma_f32_32x32x16_bf16 v[128:143], v[112:115], v[100:103], v[128:143]
    s_lshl_b32 s49, s36, 10
    v_add_u32 v39, s49, v1
    v_cmp_gt_u32 vcc, 6720, v39
    v_mov_b32 v124, 0x40000000
    s_nop 0
    v_cndmask_b32 v39, v124, v39, vcc
    s_lshl_b32 s0, s39, 17
    s_add_u32 s0, s0, 12582912
    s_mul_i32 s43, s72, 5
    s_add_u32 s43, s43, 19
    s_sub_u32 s43, s43, s36
    s_sub_u32 s52, s43, 20
    s_cselect_b32 s43, s43, s52
    s_mul_i32 s43, s43, 40960
    s_mul_i32 s45, s72, 5
    s_add_u32 s45, s45, 4
    s_add_u32 s45, s45, s36
    s_sub_u32 s52, s45, 20
    s_cselect_b32 s45, s45, s52
    s_mul_i32 s45, s45, 40960
    v_add_u32 v28, 69632, v1
    s_waitcnt vmcnt(0) lgkmcnt(0)
    s_barrier
    s_mov_b64 vcc, 0
    s_cmp_lg_u32 s47, 0
    s_cselect_b32 s49, 0x40000000, 0
    s_cselect_b64 s[50:51], -1, 0
    v_add_u32 v45, s49, v127
    v_cndmask_b32 v44, v127, v44, s[50:51]
    v_cvt_pk_bf16_f32 v120, v128, v129
    v_cvt_pk_bf16_f32 v121, v130, v131
    s_nop 0
    s_cbranch_execz L_pfret
    v_cvt_pk_bf16_f32 v122, v132, v133
    v_cvt_pk_bf16_f32 v123, v134, v135
    v_cvt_pk_bf16_f32 v124, v136, v137
    v_cvt_pk_bf16_f32 v125, v138, v139
    v_cvt_pk_bf16_f32 v126, v140, v141
    v_cvt_pk_bf16_f32 v127, v142, v143
    v_min_u32 v120, -2, v120
    v_min_u32 v121, -2, v121
    v_min_u32 v122, -2, v122
    v_min_u32 v123, -2, v123
    v_min_u32 v124, -2, v124
    v_min_u32 v125, -2, v125
    v_min_u32 v126, -2, v126
    v_min_u32 v127, -2, v127
    s_cmp_lg_u32 s41, 0
    s_nop 0
    s_cbranch_scc1 L_aret1
    s_branch L_aret0
L_pfend:
L_fallback:
    s_lshl_b32 s46, s38, 2
    s_add_u32 s46, s46, s40
    s_mul_i32 s46, s46, 10240
    s_mul_i32 s47, s39, 655360
    s_add_u32 s46, s46, s47
    s_mul_i32 s47, s40, 10240
    v_subrev_u32 v155, s47, v10
    v_subrev_u32 v156, s47, v12
    v_subrev_u32 v154, s47, v18
    s_mov_b64 exec, s[60:61]
    v_mov_b64 v[144:145], 0
    s_mov_b64 exec, -1
    s_sub_u32 s48, s46, 0
    buffer_load_dwordx4 v[88:91], v155, s[12:15], s48 offen offset:0 sc1
    s_mov_b64 exec, s[58:59]
    buffer_load_dwordx4 v[40:43], v156, s[12:15], s48 offen sc1
    s_mov_b64 exec, -1
    s_waitcnt vmcnt(1)
    v_mfma_f32_32x32x16_bf16 v[48:63], v[88:91], v[128:131], v[168:183]
    s_waitcnt vmcnt(0)
    v_mfma_f32_32x32x8_bf16 v[48:63], v[40:41], v[144:145], v[48:63]
    s_nop 11
    v_max_f32 v158, v48, v49
    v_max3_f32 v158, v158, v50, v51
    v_max3_f32 v158, v158, v52, v53
    v_max3_f32 v158, v158, v54, v55
    v_max3_f32 v158, v158, v56, v57
    v_max3_f32 v158, v158, v58, v59
    v_max3_f32 v158, v158, v60, v61
    v_max3_f32 v158, v158, v62, v63
    s_nop 1
    s_cmp_eq_u32 s67, 0
    s_cbranch_scc1 L_fb00
    s_sub_u32 s48, s46, 10240
    buffer_load_dwordx4 v[88:91], v155, s[12:15], s48 offen offset:0 sc1
    s_mov_b64 exec, s[58:59]
    buffer_load_dwordx4 v[40:43], v156, s[12:15], s48 offen sc1
    s_mov_b64 exec, -1
    s_waitcnt vmcnt(1)
    v_mfma_f32_32x32x16_bf16 v[48:63], v[88:91], v[128:131], 0
    s_waitcnt vmcnt(0)
    v_mfma_f32_32x32x8_bf16 v[48:63], v[40:41], v[144:145], v[48:63]
    s_nop 11
    v_max3_f32 v158, v158, v48, v49
    v_max3_f32 v158, v158, v50, v51
    v_max3_f32 v158, v158, v52, v53
    v_max3_f32 v158, v158, v54, v55
    v_max3_f32 v158, v158, v56, v57
    v_max3_f32 v158, v158, v58, v59
    v_max3_f32 v158, v158, v60, v61
    v_max3_f32 v158, v158, v62, v63
    s_nop 1
    s_cmp_eq_u32 s67, 1
    s_cbranch_scc1 L_fb00
    s_sub_u32 s48, s46, 20480
    buffer_load_dwordx4 v[88:91], v155, s[12:15], s48 offen offset:0 sc1
    s_mov_b64 exec, s[58:59]
    buffer_load_dwordx4 v[40:43], v156, s[12:15], s48 offen sc1
    s_mov_b64 exec, -1
    s_waitcnt vmcnt(1)
    v_mfma_f32_32x32x16_bf16 v[48:63], v[88:91], v[128:131], 0
    s_waitcnt vmcnt(0)
    v_mfma_f32_32x32x8_bf16 v[48:63], v[40:41], v[144:145], v[48:63]
    s_nop 11
    v_max3_f32 v158, v158, v48, v49
    v_max3_f32 v158, v158, v50, v51
    v_max3_f32 v158, v158, v52, v53
    v_max3_f32 v158, v158, v54, v55
    v_max3_f32 v158, v158, v56, v57
    v_max3_f32 v158, v158, v58, v59
    v_max3_f32 v158, v158, v60, v61
    v_max3_f32 v158, v158, v62, v63
    s_nop 1
    s_cmp_eq_u32 s67, 2
    s_cbranch_scc1 L_fb00
    s_sub_u32 s48, s46, 30720
    buffer_load_dwordx4 v[88:91], v155, s[12:15], s48 offen offset:0 sc1
    s_mov_b64 exec, s[58:59]
    buffer_load_dwordx4 v[40:43], v156, s[12:15], s48 offen sc1
    s_mov_b64 exec, -1
    s_waitcnt vmcnt(1)
    v_mfma_f32_32x32x16_bf16 v[48:63], v[88:91], v[128:131], 0
    s_waitcnt vmcnt(0)
    v_mfma_f32_32x32x8_bf16 v[48:63], v[40:41], v[144:145], v[48:63]
    s_nop 11
    v_max3_f32 v158, v158, v48, v49
    v_max3_f32 v158, v158, v50, v51
    v_max3_f32 v158, v158, v52, v53
    v_max3_f32 v158, v158, v54, v55
    v_max3_f32 v158, v158, v56, v57
    v_max3_f32 v158, v158, v58, v59
    v_max3_f32 v158, v158, v60, v61
    v_max3_f32 v158, v158, v62, v63
    s_nop 1
    s_cmp_eq_u32 s67, 3
    s_cbranch_scc1 L_fb00
    s_sub_u32 s48, s46, 40960
    buffer_load_dwordx4 v[88:91], v155, s[12:15], s48 offen offset:0 sc1
    s_mov_b64 exec, s[58:59]
    buffer_load_dwordx4 v[40:43], v156, s[12:15], s48 offen sc1
    s_mov_b64 exec, -1
    s_waitcnt vmcnt(1)
    v_mfma_f32_32x32x16_bf16 v[48:63], v[88:91], v[128:131], 0
    s_waitcnt vmcnt(0)
    v_mfma_f32_32x32x8_bf16 v[48:63], v[40:41], v[144:145], v[48:63]
    s_nop 11
    v_max3_f32 v158, v158, v48, v49
    v_max3_f32 v158, v158, v50, v51
    v_max3_f32 v158, v158, v52, v53
    v_max3_f32 v158, v158, v54, v55
    v_max3_f32 v158, v158, v56, v57
    v_max3_f32 v158, v158, v58, v59
    v_max3_f32 v158, v158, v60, v61
    v_max3_f32 v158, v158, v62, v63
    s_nop 1
    s_cmp_eq_u32 s67, 4
    s_cbranch_scc1 L_fb00
    s_sub_u32 s48, s46, 51200
    buffer_load_dwordx4 v[88:91], v155, s[12:15], s48 offen offset:0 sc1
    s_mov_b64 exec, s[58:59]
    buffer_load_dwordx4 v[40:43], v156, s[12:15], s48 offen sc1
    s_mov_b64 exec, -1
    s_waitcnt vmcnt(1)
    v_mfma_f32_32x32x16_bf16 v[48:63], v[88:91], v[128:131], 0
    s_waitcnt vmcnt(0)
    v_mfma_f32_32x32x8_bf16 v[48:63], v[40:41], v[144:145], v[48:63]
    s_nop 11
    v_max3_f32 v158, v158, v48, v49
    v_max3_f32 v158, v158, v50, v51
    v_max3_f32 v158, v158, v52, v53
    v_max3_f32 v158, v158, v54, v55
    v_max3_f32 v158, v158, v56, v57
    v_max3_f32 v158, v158, v58, v59
    v_max3_f32 v158, v158, v60, v61
    v_max3_f32 v158, v158, v62, v63
    s_nop 1
    s_cmp_eq_u32 s67, 5
    s_cbranch_scc1 L_fb00
    s_sub_u32 s48, s46, 61440
    buffer_load_dwordx4 v[88:91], v155, s[12:15], s48 offen offset:0 sc1
    s_mov_b64 exec, s[58:59]
    buffer_load_dwordx4 v[40:43], v156, s[12:15], s48 offen sc1
    s_mov_b64 exec, -1
    s_waitcnt vmcnt(1)
    v_mfma_f32_32x32x16_bf16 v[48:63], v[88:91], v[128:131], 0
    s_waitcnt vmcnt(0)
    v_mfma_f32_32x32x8_bf16 v[48:63], v[40:41], v[144:145], v[48:63]
    s_nop 11
    v_max3_f32 v158, v158, v48, v49
    v_max3_f32 v158, v158, v50, v51
    v_max3_f32 v158, v158, v52, v53
    v_max3_f32 v158, v158, v54, v55
    v_max3_f32 v158, v158, v56, v57
    v_max3_f32 v158, v158, v58, v59
    v_max3_f32 v158, v158, v60, v61
    v_max3_f32 v158, v158, v62, v63
    s_nop 1
    s_cmp_eq_u32 s67, 6
    s_cbranch_scc1 L_fb00
    s_sub_u32 s48, s46, 71680
    buffer_load_dwordx4 v[88:91], v155, s[12:15], s48 offen offset:0 sc1
    s_mov_b64 exec, s[58:59]
    buffer_load_dwordx4 v[40:43], v156, s[12:15], s48 offen sc1
    s_mov_b64 exec, -1
    s_waitcnt vmcnt(1)
    v_mfma_f32_32x32x16_bf16 v[48:63], v[88:91], v[128:131], 0
    s_waitcnt vmcnt(0)
    v_mfma_f32_32x32x8_bf16 v[48:63], v[40:41], v[144:145], v[48:63]
    s_nop 11
    v_max3_f32 v158, v158, v48, v49
    v_max3_f32 v158, v158, v50, v51
    v_max3_f32 v158, v158, v52, v53
    v_max3_f32 v158, v158, v54, v55
    v_max3_f32 v158, v158, v56, v57
    v_max3_f32 v158, v158, v58, v59
    v_max3_f32 v158, v158, v60, v61
    v_max3_f32 v158, v158, v62, v63
    s_nop 1
    s_cmp_eq_u32 s67, 7
    s_cbranch_scc1 L_fb00
    s_sub_u32 s48, s46, 81920
    buffer_load_dwordx4 v[88:91], v155, s[12:15], s48 offen offset:0 sc1
    s_mov_b64 exec, s[58:59]
    buffer_load_dwordx4 v[40:43], v156, s[12:15], s48 offen sc1
    s_mov_b64 exec, -1
    s_waitcnt vmcnt(1)
    v_mfma_f32_32x32x16_bf16 v[48:63], v[88:91], v[128:131], v[184:199]
    s_waitcnt vmcnt(0)
    v_mfma_f32_32x32x8_bf16 v[48:63], v[40:41], v[144:145], v[48:63]
    s_nop 11
    v_max3_f32 v158, v158, v48, v49
    v_max3_f32 v158, v158, v50, v51
    v_max3_f32 v158, v158, v52, v53
    v_max3_f32 v158, v158, v54, v55
    v_max3_f32 v158, v158, v56, v57
    v_max3_f32 v158, v158, v58, v59
    v_max3_f32 v158, v158, v60, v61
    v_max3_f32 v158, v158, v62, v63
    s_nop 1
L_fb00:
    v_mov_b32 v159, v158
    s_nop 1
    v_permlane32_swap_b32 v158, v159
    v_max_f32 v158, v158, v159
    v_cvt_pk_bf16_f32 v159, 0, -v158
    v_sub_f32 v160, -v158, v159
    v_cvt_pk_bf16_f32 v161, 0, v160
    v_sub_f32 v160, v160, v161
    s_mov_b64 exec, s[60:61]
    v_cvt_pk_bf16_f32 v144, v159, v161
    v_cvt_pk_bf16_f32 v145, v160, 0
    s_mov_b64 exec, -1
    s_sub_u32 s48, s46, 0
    buffer_load_dwordx4 v[88:91], v155, s[12:15], s48 offen offset:0 sc1
    s_mov_b64 exec, s[58:59]
    buffer_load_dwordx4 v[40:43], v156, s[12:15], s48 offen sc1
    s_mov_b64 exec, s[62:63]
    buffer_load_dwordx4 v[2:5], v154, s[12:15], s48 offen offset:0 sc1
    buffer_load_dwordx4 v[6:9], v154, s[12:15], s48 offen offset:512 sc1
    s_mov_b64 exec, -1
    s_waitcnt vmcnt(3)
    v_mfma_f32_32x32x16_bf16 v[48:63], v[88:91], v[128:131], v[168:183]
    s_waitcnt vmcnt(2)
    v_mfma_f32_32x32x8_bf16 v[48:63], v[40:41], v[144:145], v[48:63]
    s_nop 11
    v_exp_f32 v48, v48
    v_exp_f32 v49, v49
    v_exp_f32 v50, v50
    v_exp_f32 v51, v51
    v_exp_f32 v52, v52
    v_exp_f32 v53, v53
    v_exp_f32 v54, v54
    v_exp_f32 v55, v55
    v_exp_f32 v56, v56
    v_exp_f32 v57, v57
    v_exp_f32 v58, v58
    v_exp_f32 v59, v59
    v_exp_f32 v60, v60
    v_exp_f32 v61, v61
    v_exp_f32 v62, v62
    v_exp_f32 v63, v63
    v_cvt_pk_bf16_f32 v80, v48, v49
    v_cvt_pk_bf16_f32 v81, v50, v51
    v_cvt_pk_bf16_f32 v82, v52, v53
    v_cvt_pk_bf16_f32 v83, v54, v55
    v_cvt_pk_bf16_f32 v84, v56, v57
    v_cvt_pk_bf16_f32 v85, v58, v59
    v_cvt_pk_bf16_f32 v86, v60, v61
    v_cvt_pk_bf16_f32 v87, v62, v63
    s_waitcnt vmcnt(1)
    v_mfma_f32_32x32x16_bf16 v[200:215], v[2:5], v[80:83], 0
    s_waitcnt vmcnt(0)
    v_mfma_f32_32x32x16_bf16 v[200:215], v[6:9], v[84:87], v[200:215]
    s_nop 11
    s_cmp_eq_u32 s67, 0
    s_cbranch_scc1 L_fb01
    s_sub_u32 s48, s46, 10240
    buffer_load_dwordx4 v[88:91], v155, s[12:15], s48 offen offset:0 sc1
    s_mov_b64 exec, s[58:59]
    buffer_load_dwordx4 v[40:43], v156, s[12:15], s48 offen sc1
    s_mov_b64 exec, s[62:63]
    buffer_load_dwordx4 v[2:5], v154, s[12:15], s48 offen offset:0 sc1
    buffer_load_dwordx4 v[6:9], v154, s[12:15], s48 offen offset:512 sc1
    s_mov_b64 exec, -1
    s_waitcnt vmcnt(3)
    v_mfma_f32_32x32x16_bf16 v[48:63], v[88:91], v[128:131], 0
    s_waitcnt vmcnt(2)
    v_mfma_f32_32x32x8_bf16 v[48:63], v[40:41], v[144:145], v[48:63]
    s_nop 11
    v_exp_f32 v48, v48
    v_exp_f32 v49, v49
    v_exp_f32 v50, v50
    v_exp_f32 v51, v51
    v_exp_f32 v52, v52
    v_exp_f32 v53, v53
    v_exp_f32 v54, v54
    v_exp_f32 v55, v55
    v_exp_f32 v56, v56
    v_exp_f32 v57, v57
    v_exp_f32 v58, v58
    v_exp_f32 v59, v59
    v_exp_f32 v60, v60
    v_exp_f32 v61, v61
    v_exp_f32 v62, v62
    v_exp_f32 v63, v63
    v_cvt_pk_bf16_f32 v80, v48, v49
    v_cvt_pk_bf16_f32 v81, v50, v51
    v_cvt_pk_bf16_f32 v82, v52, v53
    v_cvt_pk_bf16_f32 v83, v54, v55
    v_cvt_pk_bf16_f32 v84, v56, v57
    v_cvt_pk_bf16_f32 v85, v58, v59
    v_cvt_pk_bf16_f32 v86, v60, v61
    v_cvt_pk_bf16_f32 v87, v62, v63
    s_waitcnt vmcnt(1)
    v_mfma_f32_32x32x16_bf16 v[200:215], v[2:5], v[80:83], v[200:215]
    s_waitcnt vmcnt(0)
    v_mfma_f32_32x32x16_bf16 v[200:215], v[6:9], v[84:87], v[200:215]
    s_nop 11
    s_cmp_eq_u32 s67, 1
    s_cbranch_scc1 L_fb01
    s_sub_u32 s48, s46, 20480
    buffer_load_dwordx4 v[88:91], v155, s[12:15], s48 offen offset:0 sc1
    s_mov_b64 exec, s[58:59]
    buffer_load_dwordx4 v[40:43], v156, s[12:15], s48 offen sc1
    s_mov_b64 exec, s[62:63]
    buffer_load_dwordx4 v[2:5], v154, s[12:15], s48 offen offset:0 sc1
    buffer_load_dwordx4 v[6:9], v154, s[12:15], s48 offen offset:512 sc1
    s_mov_b64 exec, -1
    s_waitcnt vmcnt(3)
    v_mfma_f32_32x32x16_bf16 v[48:63], v[88:91], v[128:131], 0
    s_waitcnt vmcnt(2)
    v_mfma_f32_32x32x8_bf16 v[48:63], v[40:41], v[144:145], v[48:63]
    s_nop 11
    v_exp_f32 v48, v48
    v_exp_f32 v49, v49
    v_exp_f32 v50, v50
    v_exp_f32 v51, v51
    v_exp_f32 v52, v52
    v_exp_f32 v53, v53
    v_exp_f32 v54, v54
    v_exp_f32 v55, v55
    v_exp_f32 v56, v56
    v_exp_f32 v57, v57
    v_exp_f32 v58, v58
    v_exp_f32 v59, v59
    v_exp_f32 v60, v60
    v_exp_f32 v61, v61
    v_exp_f32 v62, v62
    v_exp_f32 v63, v63
    v_cvt_pk_bf16_f32 v80, v48, v49
    v_cvt_pk_bf16_f32 v81, v50, v51
    v_cvt_pk_bf16_f32 v82, v52, v53
    v_cvt_pk_bf16_f32 v83, v54, v55
    v_cvt_pk_bf16_f32 v84, v56, v57
    v_cvt_pk_bf16_f32 v85, v58, v59
    v_cvt_pk_bf16_f32 v86, v60, v61
    v_cvt_pk_bf16_f32 v87, v62, v63
    s_waitcnt vmcnt(1)
    v_mfma_f32_32x32x16_bf16 v[200:215], v[2:5], v[80:83], v[200:215]
    s_waitcnt vmcnt(0)
    v_mfma_f32_32x32x16_bf16 v[200:215], v[6:9], v[84:87], v[200:215]
    s_nop 11
    s_cmp_eq_u32 s67, 2
    s_cbranch_scc1 L_fb01
    s_sub_u32 s48, s46, 30720
    buffer_load_dwordx4 v[88:91], v155, s[12:15], s48 offen offset:0 sc1
    s_mov_b64 exec, s[58:59]
    buffer_load_dwordx4 v[40:43], v156, s[12:15], s48 offen sc1
    s_mov_b64 exec, s[62:63]
    buffer_load_dwordx4 v[2:5], v154, s[12:15], s48 offen offset:0 sc1
    buffer_load_dwordx4 v[6:9], v154, s[12:15], s48 offen offset:512 sc1
    s_mov_b64 exec, -1
    s_waitcnt vmcnt(3)
    v_mfma_f32_32x32x16_bf16 v[48:63], v[88:91], v[128:131], 0
    s_waitcnt vmcnt(2)
    v_mfma_f32_32x32x8_bf16 v[48:63], v[40:41], v[144:145], v[48:63]
    s_nop 11
    v_exp_f32 v48, v48
    v_exp_f32 v49, v49
    v_exp_f32 v50, v50
    v_exp_f32 v51, v51
    v_exp_f32 v52, v52
    v_exp_f32 v53, v53
    v_exp_f32 v54, v54
    v_exp_f32 v55, v55
    v_exp_f32 v56, v56
    v_exp_f32 v57, v57
    v_exp_f32 v58, v58
    v_exp_f32 v59, v59
    v_exp_f32 v60, v60
    v_exp_f32 v61, v61
    v_exp_f32 v62, v62
    v_exp_f32 v63, v63
    v_cvt_pk_bf16_f32 v80, v48, v49
    v_cvt_pk_bf16_f32 v81, v50, v51
    v_cvt_pk_bf16_f32 v82, v52, v53
    v_cvt_pk_bf16_f32 v83, v54, v55
    v_cvt_pk_bf16_f32 v84, v56, v57
    v_cvt_pk_bf16_f32 v85, v58, v59
    v_cvt_pk_bf16_f32 v86, v60, v61
    v_cvt_pk_bf16_f32 v87, v62, v63
    s_waitcnt vmcnt(1)
    v_mfma_f32_32x32x16_bf16 v[200:215], v[2:5], v[80:83], v[200:215]
    s_waitcnt vmcnt(0)
    v_mfma_f32_32x32x16_bf16 v[200:215], v[6:9], v[84:87], v[200:215]
    s_nop 11
    s_cmp_eq_u32 s67, 3
    s_cbranch_scc1 L_fb01
    s_sub_u32 s48, s46, 40960
    buffer_load_dwordx4 v[88:91], v155, s[12:15], s48 offen offset:0 sc1
    s_mov_b64 exec, s[58:59]
    buffer_load_dwordx4 v[40:43], v156, s[12:15], s48 offen sc1
    s_mov_b64 exec, s[62:63]
    buffer_load_dwordx4 v[2:5], v154, s[12:15], s48 offen offset:0 sc1
    buffer_load_dwordx4 v[6:9], v154, s[12:15], s48 offen offset:512 sc1
    s_mov_b64 exec, -1
    s_waitcnt vmcnt(3)
    v_mfma_f32_32x32x16_bf16 v[48:63], v[88:91], v[128:131], 0
    s_waitcnt vmcnt(2)
    v_mfma_f32_32x32x8_bf16 v[48:63], v[40:41], v[144:145], v[48:63]
    s_nop 11
    v_exp_f32 v48, v48
    v_exp_f32 v49, v49
    v_exp_f32 v50, v50
    v_exp_f32 v51, v51
    v_exp_f32 v52, v52
    v_exp_f32 v53, v53
    v_exp_f32 v54, v54
    v_exp_f32 v55, v55
    v_exp_f32 v56, v56
    v_exp_f32 v57, v57
    v_exp_f32 v58, v58
    v_exp_f32 v59, v59
    v_exp_f32 v60, v60
    v_exp_f32 v61, v61
    v_exp_f32 v62, v62
    v_exp_f32 v63, v63
    v_cvt_pk_bf16_f32 v80, v48, v49
    v_cvt_pk_bf16_f32 v81, v50, v51
    v_cvt_pk_bf16_f32 v82, v52, v53
    v_cvt_pk_bf16_f32 v83, v54, v55
    v_cvt_pk_bf16_f32 v84, v56, v57
    v_cvt_pk_bf16_f32 v85, v58, v59
    v_cvt_pk_bf16_f32 v86, v60, v61
    v_cvt_pk_bf16_f32 v87, v62, v63
    s_waitcnt vmcnt(1)
    v_mfma_f32_32x32x16_bf16 v[200:215], v[2:5], v[80:83], v[200:215]
    s_waitcnt vmcnt(0)
    v_mfma_f32_32x32x16_bf16 v[200:215], v[6:9], v[84:87], v[200:215]
    s_nop 11
    s_cmp_eq_u32 s67, 4
    s_cbranch_scc1 L_fb01
    s_sub_u32 s48, s46, 51200
    buffer_load_dwordx4 v[88:91], v155, s[12:15], s48 offen offset:0 sc1
    s_mov_b64 exec, s[58:59]
    buffer_load_dwordx4 v[40:43], v156, s[12:15], s48 offen sc1
    s_mov_b64 exec, s[62:63]
    buffer_load_dwordx4 v[2:5], v154, s[12:15], s48 offen offset:0 sc1
    buffer_load_dwordx4 v[6:9], v154, s[12:15], s48 offen offset:512 sc1
    s_mov_b64 exec, -1
    s_waitcnt vmcnt(3)
    v_mfma_f32_32x32x16_bf16 v[48:63], v[88:91], v[128:131], 0
    s_waitcnt vmcnt(2)
    v_mfma_f32_32x32x8_bf16 v[48:63], v[40:41], v[144:145], v[48:63]
    s_nop 11
    v_exp_f32 v48, v48
    v_exp_f32 v49, v49
    v_exp_f32 v50, v50
    v_exp_f32 v51, v51
    v_exp_f32 v52, v52
    v_exp_f32 v53, v53
    v_exp_f32 v54, v54
    v_exp_f32 v55, v55
    v_exp_f32 v56, v56
    v_exp_f32 v57, v57
    v_exp_f32 v58, v58
    v_exp_f32 v59, v59
    v_exp_f32 v60, v60
    v_exp_f32 v61, v61
    v_exp_f32 v62, v62
    v_exp_f32 v63, v63
    v_cvt_pk_bf16_f32 v80, v48, v49
    v_cvt_pk_bf16_f32 v81, v50, v51
    v_cvt_pk_bf16_f32 v82, v52, v53
    v_cvt_pk_bf16_f32 v83, v54, v55
    v_cvt_pk_bf16_f32 v84, v56, v57
    v_cvt_pk_bf16_f32 v85, v58, v59
    v_cvt_pk_bf16_f32 v86, v60, v61
    v_cvt_pk_bf16_f32 v87, v62, v63
    s_waitcnt vmcnt(1)
    v_mfma_f32_32x32x16_bf16 v[200:215], v[2:5], v[80:83], v[200:215]
    s_waitcnt vmcnt(0)
    v_mfma_f32_32x32x16_bf16 v[200:215], v[6:9], v[84:87], v[200:215]
    s_nop 11
    s_cmp_eq_u32 s67, 5
    s_cbranch_scc1 L_fb01
    s_sub_u32 s48, s46, 61440
    buffer_load_dwordx4 v[88:91], v155, s[12:15], s48 offen offset:0 sc1
    s_mov_b64 exec, s[58:59]
    buffer_load_dwordx4 v[40:43], v156, s[12:15], s48 offen sc1
    s_mov_b64 exec, s[62:63]
    buffer_load_dwordx4 v[2:5], v154, s[12:15], s48 offen offset:0 sc1
    buffer_load_dwordx4 v[6:9], v154, s[12:15], s48 offen offset:512 sc1
    s_mov_b64 exec, -1
    s_waitcnt vmcnt(3)
    v_mfma_f32_32x32x16_bf16 v[48:63], v[88:91], v[128:131], 0
    s_waitcnt vmcnt(2)
    v_mfma_f32_32x32x8_bf16 v[48:63], v[40:41], v[144:145], v[48:63]
    s_nop 11
    v_exp_f32 v48, v48
    v_exp_f32 v49, v49
    v_exp_f32 v50, v50
    v_exp_f32 v51, v51
    v_exp_f32 v52, v52
    v_exp_f32 v53, v53
    v_exp_f32 v54, v54
    v_exp_f32 v55, v55
    v_exp_f32 v56, v56
    v_exp_f32 v57, v57
    v_exp_f32 v58, v58
    v_exp_f32 v59, v59
    v_exp_f32 v60, v60
    v_exp_f32 v61, v61
    v_exp_f32 v62, v62
    v_exp_f32 v63, v63
    v_cvt_pk_bf16_f32 v80, v48, v49
    v_cvt_pk_bf16_f32 v81, v50, v51
    v_cvt_pk_bf16_f32 v82, v52, v53
    v_cvt_pk_bf16_f32 v83, v54, v55
    v_cvt_pk_bf16_f32 v84, v56, v57
    v_cvt_pk_bf16_f32 v85, v58, v59
    v_cvt_pk_bf16_f32 v86, v60, v61
    v_cvt_pk_bf16_f32 v87, v62, v63
    s_waitcnt vmcnt(1)
    v_mfma_f32_32x32x16_bf16 v[200:215], v[2:5], v[80:83], v[200:215]
    s_waitcnt vmcnt(0)
    v_mfma_f32_32x32x16_bf16 v[200:215], v[6:9], v[84:87], v[200:215]
    s_nop 11
    s_cmp_eq_u32 s67, 6
    s_cbranch_scc1 L_fb01
    s_sub_u32 s48, s46, 71680
    buffer_load_dwordx4 v[88:91], v155, s[12:15], s48 offen offset:0 sc1
    s_mov_b64 exec, s[58:59]
    buffer_load_dwordx4 v[40:43], v156, s[12:15], s48 offen sc1
    s_mov_b64 exec, s[62:63]
    buffer_load_dwordx4 v[2:5], v154, s[12:15], s48 offen offset:0 sc1
    buffer_load_dwordx4 v[6:9], v154, s[12:15], s48 offen offset:512 sc1
    s_mov_b64 exec, -1
    s_waitcnt vmcnt(3)
    v_mfma_f32_32x32x16_bf16 v[48:63], v[88:91], v[128:131], 0
    s_waitcnt vmcnt(2)
    v_mfma_f32_32x32x8_bf16 v[48:63], v[40:41], v[144:145], v[48:63]
    s_nop 11
    v_exp_f32 v48, v48
    v_exp_f32 v49, v49
    v_exp_f32 v50, v50
    v_exp_f32 v51, v51
    v_exp_f32 v52, v52
    v_exp_f32 v53, v53
    v_exp_f32 v54, v54
    v_exp_f32 v55, v55
    v_exp_f32 v56, v56
    v_exp_f32 v57, v57
    v_exp_f32 v58, v58
    v_exp_f32 v59, v59
    v_exp_f32 v60, v60
    v_exp_f32 v61, v61
    v_exp_f32 v62, v62
    v_exp_f32 v63, v63
    v_cvt_pk_bf16_f32 v80, v48, v49
    v_cvt_pk_bf16_f32 v81, v50, v51
    v_cvt_pk_bf16_f32 v82, v52, v53
    v_cvt_pk_bf16_f32 v83, v54, v55
    v_cvt_pk_bf16_f32 v84, v56, v57
    v_cvt_pk_bf16_f32 v85, v58, v59
    v_cvt_pk_bf16_f32 v86, v60, v61
    v_cvt_pk_bf16_f32 v87, v62, v63
    s_waitcnt vmcnt(1)
    v_mfma_f32_32x32x16_bf16 v[200:215], v[2:5], v[80:83], v[200:215]
    s_waitcnt vmcnt(0)
    v_mfma_f32_32x32x16_bf16 v[200:215], v[6:9], v[84:87], v[200:215]
    s_nop 11
    s_cmp_eq_u32 s67, 7
    s_cbranch_scc1 L_fb01
    s_sub_u32 s48, s46, 81920
    buffer_load_dwordx4 v[88:91], v155, s[12:15], s48 offen offset:0 sc1
    s_mov_b64 exec, s[58:59]
    buffer_load_dwordx4 v[40:43], v156, s[12:15], s48 offen sc1
    s_mov_b64 exec, s[62:63]
    buffer_load_dwordx4 v[2:5], v154, s[12:15], s48 offen offset:0 sc1
    buffer_load_dwordx4 v[6:9], v154, s[12:15], s48 offen offset:512 sc1
    s_mov_b64 exec, -1
    s_waitcnt vmcnt(3)
    v_mfma_f32_32x32x16_bf16 v[48:63], v[88:91], v[128:131], v[184:199]
    s_waitcnt vmcnt(2)
    v_mfma_f32_32x32x8_bf16 v[48:63], v[40:41], v[144:145], v[48:63]
    s_nop 11
    v_exp_f32 v48, v48
    v_exp_f32 v49, v49
    v_exp_f32 v50, v50
    v_exp_f32 v51, v51
    v_exp_f32 v52, v52
    v_exp_f32 v53, v53
    v_exp_f32 v54, v54
    v_exp_f32 v55, v55
    v_exp_f32 v56, v56
    v_exp_f32 v57, v57
    v_exp_f32 v58, v58
    v_exp_f32 v59, v59
    v_exp_f32 v60, v60
    v_exp_f32 v61, v61
    v_exp_f32 v62, v62
    v_exp_f32 v63, v63
    v_cvt_pk_bf16_f32 v80, v48, v49
    v_cvt_pk_bf16_f32 v81, v50, v51
    v_cvt_pk_bf16_f32 v82, v52, v53
    v_cvt_pk_bf16_f32 v83, v54, v55
    v_cvt_pk_bf16_f32 v84, v56, v57
    v_cvt_pk_bf16_f32 v85, v58, v59
    v_cvt_pk_bf16_f32 v86, v60, v61
    v_cvt_pk_bf16_f32 v87, v62, v63
    s_waitcnt vmcnt(1)
    v_mfma_f32_32x32x16_bf16 v[200:215], v[2:5], v[80:83], v[200:215]
    s_waitcnt vmcnt(0)
    v_mfma_f32_32x32x16_bf16 v[200:215], v[6:9], v[84:87], v[200:215]
    s_nop 11
L_fb01:
    v_rcp_f32 v148, v212
    v_subrev_u32 v154, s47, v20
    s_mov_b64 exec, s[60:61]
    v_mov_b64 v[146:147], 0
    s_mov_b64 exec, -1
    s_sub_u32 s48, s46, 0
    buffer_load_dwordx4 v[88:91], v155, s[12:15], s48 offen offset:1024 sc1
    s_mov_b64 exec, s[58:59]
    buffer_load_dwordx4 v[40:43], v156, s[12:15], s48 offen sc1
    s_mov_b64 exec, -1
    s_waitcnt vmcnt(1)
    v_mfma_f32_32x32x16_bf16 v[48:63], v[88:91], v[136:139], v[168:183]
    s_waitcnt vmcnt(0)
    v_mfma_f32_32x32x8_bf16 v[48:63], v[42:43], v[146:147], v[48:63]
    s_nop 11
    v_max_f32 v158, v48, v49
    v_max3_f32 v158, v158, v50, v51
    v_max3_f32 v158, v158, v52, v53
    v_max3_f32 v158, v158, v54, v55
    v_max3_f32 v158, v158, v56, v57
    v_max3_f32 v158, v158, v58, v59
    v_max3_f32 v158, v158, v60, v61
    v_max3_f32 v158, v158, v62, v63
    s_nop 1
    s_cmp_eq_u32 s67, 0
    s_cbranch_scc1 L_fb10
    s_sub_u32 s48, s46, 10240
    buffer_load_dwordx4 v[88:91], v155, s[12:15], s48 offen offset:1024 sc1
    s_mov_b64 exec, s[58:59]
    buffer_load_dwordx4 v[40:43], v156, s[12:15], s48 offen sc1
    s_mov_b64 exec, -1
    s_waitcnt vmcnt(1)
    v_mfma_f32_32x32x16_bf16 v[48:63], v[88:91], v[136:139], 0
    s_waitcnt vmcnt(0)
    v_mfma_f32_32x32x8_bf16 v[48:63], v[42:43], v[146:147], v[48:63]
    s_nop 11
    v_max3_f32 v158, v158, v48, v49
    v_max3_f32 v158, v158, v50, v51
    v_max3_f32 v158, v158, v52, v53
    v_max3_f32 v158, v158, v54, v55
    v_max3_f32 v158, v158, v56, v57
    v_max3_f32 v158, v158, v58, v59
    v_max3_f32 v158, v158, v60, v61
    v_max3_f32 v158, v158, v62, v63
    s_nop 1
    s_cmp_eq_u32 s67, 1
    s_cbranch_scc1 L_fb10
    s_sub_u32 s48, s46, 20480
    buffer_load_dwordx4 v[88:91], v155, s[12:15], s48 offen offset:1024 sc1
    s_mov_b64 exec, s[58:59]
    buffer_load_dwordx4 v[40:43], v156, s[12:15], s48 offen sc1
    s_mov_b64 exec, -1
    s_waitcnt vmcnt(1)
    v_mfma_f32_32x32x16_bf16 v[48:63], v[88:91], v[136:139], 0
    s_waitcnt vmcnt(0)
    v_mfma_f32_32x32x8_bf16 v[48:63], v[42:43], v[146:147], v[48:63]
    s_nop 11
    v_max3_f32 v158, v158, v48, v49
    v_max3_f32 v158, v158, v50, v51
    v_max3_f32 v158, v158, v52, v53
    v_max3_f32 v158, v158, v54, v55
    v_max3_f32 v158, v158, v56, v57
    v_max3_f32 v158, v158, v58, v59
    v_max3_f32 v158, v158, v60, v61
    v_max3_f32 v158, v158, v62, v63
    s_nop 1
    s_cmp_eq_u32 s67, 2
    s_cbranch_scc1 L_fb10
    s_sub_u32 s48, s46, 30720
    buffer_load_dwordx4 v[88:91], v155, s[12:15], s48 offen offset:1024 sc1
    s_mov_b64 exec, s[58:59]
    buffer_load_dwordx4 v[40:43], v156, s[12:15], s48 offen sc1
    s_mov_b64 exec, -1
    s_waitcnt vmcnt(1)
    v_mfma_f32_32x32x16_bf16 v[48:63], v[88:91], v[136:139], 0
    s_waitcnt vmcnt(0)
    v_mfma_f32_32x32x8_bf16 v[48:63], v[42:43], v[146:147], v[48:63]
    s_nop 11
    v_max3_f32 v158, v158, v48, v49
    v_max3_f32 v158, v158, v50, v51
    v_max3_f32 v158, v158, v52, v53
    v_max3_f32 v158, v158, v54, v55
    v_max3_f32 v158, v158, v56, v57
    v_max3_f32 v158, v158, v58, v59
    v_max3_f32 v158, v158, v60, v61
    v_max3_f32 v158, v158, v62, v63
    s_nop 1
    s_cmp_eq_u32 s67, 3
    s_cbranch_scc1 L_fb10
    s_sub_u32 s48, s46, 40960
    buffer_load_dwordx4 v[88:91], v155, s[12:15], s48 offen offset:1024 sc1
    s_mov_b64 exec, s[58:59]
    buffer_load_dwordx4 v[40:43], v156, s[12:15], s48 offen sc1
    s_mov_b64 exec, -1
    s_waitcnt vmcnt(1)
    v_mfma_f32_32x32x16_bf16 v[48:63], v[88:91], v[136:139], 0
    s_waitcnt vmcnt(0)
    v_mfma_f32_32x32x8_bf16 v[48:63], v[42:43], v[146:147], v[48:63]
    s_nop 11
    v_max3_f32 v158, v158, v48, v49
    v_max3_f32 v158, v158, v50, v51
    v_max3_f32 v158, v158, v52, v53
    v_max3_f32 v158, v158, v54, v55
    v_max3_f32 v158, v158, v56, v57
    v_max3_f32 v158, v158, v58, v59
    v_max3_f32 v158, v158, v60, v61
    v_max3_f32 v158, v158, v62, v63
    s_nop 1
    s_cmp_eq_u32 s67, 4
    s_cbranch_scc1 L_fb10
    s_sub_u32 s48, s46, 51200
    buffer_load_dwordx4 v[88:91], v155, s[12:15], s48 offen offset:1024 sc1
    s_mov_b64 exec, s[58:59]
    buffer_load_dwordx4 v[40:43], v156, s[12:15], s48 offen sc1
    s_mov_b64 exec, -1
    s_waitcnt vmcnt(1)
    v_mfma_f32_32x32x16_bf16 v[48:63], v[88:91], v[136:139], 0
    s_waitcnt vmcnt(0)
    v_mfma_f32_32x32x8_bf16 v[48:63], v[42:43], v[146:147], v[48:63]
    s_nop 11
    v_max3_f32 v158, v158, v48, v49
    v_max3_f32 v158, v158, v50, v51
    v_max3_f32 v158, v158, v52, v53
    v_max3_f32 v158, v158, v54, v55
    v_max3_f32 v158, v158, v56, v57
    v_max3_f32 v158, v158, v58, v59
    v_max3_f32 v158, v158, v60, v61
    v_max3_f32 v158, v158, v62, v63
    s_nop 1
    s_cmp_eq_u32 s67, 5
    s_cbranch_scc1 L_fb10
    s_sub_u32 s48, s46, 61440
    buffer_load_dwordx4 v[88:91], v155, s[12:15], s48 offen offset:1024 sc1
    s_mov_b64 exec, s[58:59]
    buffer_load_dwordx4 v[40:43], v156, s[12:15], s48 offen sc1
    s_mov_b64 exec, -1
    s_waitcnt vmcnt(1)
    v_mfma_f32_32x32x16_bf16 v[48:63], v[88:91], v[136:139], 0
    s_waitcnt vmcnt(0)
    v_mfma_f32_32x32x8_bf16 v[48:63], v[42:43], v[146:147], v[48:63]
    s_nop 11
    v_max3_f32 v158, v158, v48, v49
    v_max3_f32 v158, v158, v50, v51
    v_max3_f32 v158, v158, v52, v53
    v_max3_f32 v158, v158, v54, v55
    v_max3_f32 v158, v158, v56, v57
    v_max3_f32 v158, v158, v58, v59
    v_max3_f32 v158, v158, v60, v61
    v_max3_f32 v158, v158, v62, v63
    s_nop 1
    s_cmp_eq_u32 s67, 6
    s_cbranch_scc1 L_fb10
    s_sub_u32 s48, s46, 71680
    buffer_load_dwordx4 v[88:91], v155, s[12:15], s48 offen offset:1024 sc1
    s_mov_b64 exec, s[58:59]
    buffer_load_dwordx4 v[40:43], v156, s[12:15], s48 offen sc1
    s_mov_b64 exec, -1
    s_waitcnt vmcnt(1)
    v_mfma_f32_32x32x16_bf16 v[48:63], v[88:91], v[136:139], 0
    s_waitcnt vmcnt(0)
    v_mfma_f32_32x32x8_bf16 v[48:63], v[42:43], v[146:147], v[48:63]
    s_nop 11
    v_max3_f32 v158, v158, v48, v49
    v_max3_f32 v158, v158, v50, v51
    v_max3_f32 v158, v158, v52, v53
    v_max3_f32 v158, v158, v54, v55
    v_max3_f32 v158, v158, v56, v57
    v_max3_f32 v158, v158, v58, v59
    v_max3_f32 v158, v158, v60, v61
    v_max3_f32 v158, v158, v62, v63
    s_nop 1
    s_cmp_eq_u32 s67, 7
    s_cbranch_scc1 L_fb10
    s_sub_u32 s48, s46, 81920
    buffer_load_dwordx4 v[88:91], v155, s[12:15], s48 offen offset:1024 sc1
    s_mov_b64 exec, s[58:59]
    buffer_load_dwordx4 v[40:43], v156, s[12:15], s48 offen sc1
    s_mov_b64 exec, -1
    s_waitcnt vmcnt(1)
    v_mfma_f32_32x32x16_bf16 v[48:63], v[88:91], v[136:139], v[184:199]
    s_waitcnt vmcnt(0)
    v_mfma_f32_32x32x8_bf16 v[48:63], v[42:43], v[146:147], v[48:63]
    s_nop 11
    v_max3_f32 v158, v158, v48, v49
    v_max3_f32 v158, v158, v50, v51
    v_max3_f32 v158, v158, v52, v53
    v_max3_f32 v158, v158, v54, v55
    v_max3_f32 v158, v158, v56, v57
    v_max3_f32 v158, v158, v58, v59
    v_max3_f32 v158, v158, v60, v61
    v_max3_f32 v158, v158, v62, v63
    s_nop 1
L_fb10:
    v_mov_b32 v159, v158
    s_nop 1
    v_permlane32_swap_b32 v158, v159
    v_max_f32 v158, v158, v159
    v_cvt_pk_bf16_f32 v159, 0, -v158
    v_sub_f32 v160, -v158, v159
    v_cvt_pk_bf16_f32 v161, 0, v160
    v_sub_f32 v160, v160, v161
    s_mov_b64 exec, s[60:61]
    v_cvt_pk_bf16_f32 v146, v159, v161
    v_cvt_pk_bf16_f32 v147, v160, 0
    s_mov_b64 exec, -1
    s_sub_u32 s48, s46, 0
    buffer_load_dwordx4 v[88:91], v155, s[12:15], s48 offen offset:1024 sc1
    s_mov_b64 exec, s[58:59]
    buffer_load_dwordx4 v[40:43], v156, s[12:15], s48 offen sc1
    s_mov_b64 exec, s[62:63]
    buffer_load_dwordx4 v[2:5], v154, s[12:15], s48 offen offset:0 sc1
    buffer_load_dwordx4 v[6:9], v154, s[12:15], s48 offen offset:512 sc1
    s_mov_b64 exec, -1
    s_waitcnt vmcnt(3)
    v_mfma_f32_32x32x16_bf16 v[48:63], v[88:91], v[136:139], v[168:183]
    s_waitcnt vmcnt(2)
    v_mfma_f32_32x32x8_bf16 v[48:63], v[42:43], v[146:147], v[48:63]
    s_nop 11
    v_exp_f32 v48, v48
    v_exp_f32 v49, v49
    v_exp_f32 v50, v50
    v_exp_f32 v51, v51
    v_exp_f32 v52, v52
    v_exp_f32 v53, v53
    v_exp_f32 v54, v54
    v_exp_f32 v55, v55
    v_exp_f32 v56, v56
    v_exp_f32 v57, v57
    v_exp_f32 v58, v58
    v_exp_f32 v59, v59
    v_exp_f32 v60, v60
    v_exp_f32 v61, v61
    v_exp_f32 v62, v62
    v_exp_f32 v63, v63
    v_cvt_pk_bf16_f32 v80, v48, v49
    v_cvt_pk_bf16_f32 v81, v50, v51
    v_cvt_pk_bf16_f32 v82, v52, v53
    v_cvt_pk_bf16_f32 v83, v54, v55
    v_cvt_pk_bf16_f32 v84, v56, v57
    v_cvt_pk_bf16_f32 v85, v58, v59
    v_cvt_pk_bf16_f32 v86, v60, v61
    v_cvt_pk_bf16_f32 v87, v62, v63
    s_waitcnt vmcnt(1)
    v_mfma_f32_32x32x16_bf16 v[216:231], v[2:5], v[80:83], 0
    s_waitcnt vmcnt(0)
    v_mfma_f32_32x32x16_bf16 v[216:231], v[6:9], v[84:87], v[216:231]
    s_nop 11
    s_cmp_eq_u32 s67, 0
    s_cbranch_scc1 L_fb11
    s_sub_u32 s48, s46, 10240
    buffer_load_dwordx4 v[88:91], v155, s[12:15], s48 offen offset:1024 sc1
    s_mov_b64 exec, s[58:59]
    buffer_load_dwordx4 v[40:43], v156, s[12:15], s48 offen sc1
    s_mov_b64 exec, s[62:63]
    buffer_load_dwordx4 v[2:5], v154, s[12:15], s48 offen offset:0 sc1
    buffer_load_dwordx4 v[6:9], v154, s[12:15], s48 offen offset:512 sc1
    s_mov_b64 exec, -1
    s_waitcnt vmcnt(3)
    v_mfma_f32_32x32x16_bf16 v[48:63], v[88:91], v[136:139], 0
    s_waitcnt vmcnt(2)
    v_mfma_f32_32x32x8_bf16 v[48:63], v[42:43], v[146:147], v[48:63]
    s_nop 11
    v_exp_f32 v48, v48
    v_exp_f32 v49, v49
    v_exp_f32 v50, v50
    v_exp_f32 v51, v51
    v_exp_f32 v52, v52
    v_exp_f32 v53, v53
    v_exp_f32 v54, v54
    v_exp_f32 v55, v55
    v_exp_f32 v56, v56
    v_exp_f32 v57, v57
    v_exp_f32 v58, v58
    v_exp_f32 v59, v59
    v_exp_f32 v60, v60
    v_exp_f32 v61, v61
    v_exp_f32 v62, v62
    v_exp_f32 v63, v63
    v_cvt_pk_bf16_f32 v80, v48, v49
    v_cvt_pk_bf16_f32 v81, v50, v51
    v_cvt_pk_bf16_f32 v82, v52, v53
    v_cvt_pk_bf16_f32 v83, v54, v55
    v_cvt_pk_bf16_f32 v84, v56, v57
    v_cvt_pk_bf16_f32 v85, v58, v59
    v_cvt_pk_bf16_f32 v86, v60, v61
    v_cvt_pk_bf16_f32 v87, v62, v63
    s_waitcnt vmcnt(1)
    v_mfma_f32_32x32x16_bf16 v[216:231], v[2:5], v[80:83], v[216:231]
    s_waitcnt vmcnt(0)
    v_mfma_f32_32x32x16_bf16 v[216:231], v[6:9], v[84:87], v[216:231]
    s_nop 11
    s_cmp_eq_u32 s67, 1
    s_cbranch_scc1 L_fb11
    s_sub_u32 s48, s46, 20480
    buffer_load_dwordx4 v[88:91], v155, s[12:15], s48 offen offset:1024 sc1
    s_mov_b64 exec, s[58:59]
    buffer_load_dwordx4 v[40:43], v156, s[12:15], s48 offen sc1
    s_mov_b64 exec, s[62:63]
    buffer_load_dwordx4 v[2:5], v154, s[12:15], s48 offen offset:0 sc1
    buffer_load_dwordx4 v[6:9], v154, s[12:15], s48 offen offset:512 sc1
    s_mov_b64 exec, -1
    s_waitcnt vmcnt(3)
    v_mfma_f32_32x32x16_bf16 v[48:63], v[88:91], v[136:139], 0
    s_waitcnt vmcnt(2)
    v_mfma_f32_32x32x8_bf16 v[48:63], v[42:43], v[146:147], v[48:63]
    s_nop 11
    v_exp_f32 v48, v48
    v_exp_f32 v49, v49
    v_exp_f32 v50, v50
    v_exp_f32 v51, v51
    v_exp_f32 v52, v52
    v_exp_f32 v53, v53
    v_exp_f32 v54, v54
    v_exp_f32 v55, v55
    v_exp_f32 v56, v56
    v_exp_f32 v57, v57
    v_exp_f32 v58, v58
    v_exp_f32 v59, v59
    v_exp_f32 v60, v60
    v_exp_f32 v61, v61
    v_exp_f32 v62, v62
    v_exp_f32 v63, v63
    v_cvt_pk_bf16_f32 v80, v48, v49
    v_cvt_pk_bf16_f32 v81, v50, v51
    v_cvt_pk_bf16_f32 v82, v52, v53
    v_cvt_pk_bf16_f32 v83, v54, v55
    v_cvt_pk_bf16_f32 v84, v56, v57
    v_cvt_pk_bf16_f32 v85, v58, v59
    v_cvt_pk_bf16_f32 v86, v60, v61
    v_cvt_pk_bf16_f32 v87, v62, v63
    s_waitcnt vmcnt(1)
    v_mfma_f32_32x32x16_bf16 v[216:231], v[2:5], v[80:83], v[216:231]
    s_waitcnt vmcnt(0)
    v_mfma_f32_32x32x16_bf16 v[216:231], v[6:9], v[84:87], v[216:231]
    s_nop 11
    s_cmp_eq_u32 s67, 2
    s_cbranch_scc1 L_fb11
    s_sub_u32 s48, s46, 30720
    buffer_load_dwordx4 v[88:91], v155, s[12:15], s48 offen offset:1024 sc1
    s_mov_b64 exec, s[58:59]
    buffer_load_dwordx4 v[40:43], v156, s[12:15], s48 offen sc1
    s_mov_b64 exec, s[62:63]
    buffer_load_dwordx4 v[2:5], v154, s[12:15], s48 offen offset:0 sc1
    buffer_load_dwordx4 v[6:9], v154, s[12:15], s48 offen offset:512 sc1
    s_mov_b64 exec, -1
    s_waitcnt vmcnt(3)
    v_mfma_f32_32x32x16_bf16 v[48:63], v[88:91], v[136:139], 0
    s_waitcnt vmcnt(2)
    v_mfma_f32_32x32x8_bf16 v[48:63], v[42:43], v[146:147], v[48:63]
    s_nop 11
    v_exp_f32 v48, v48
    v_exp_f32 v49, v49
    v_exp_f32 v50, v50
    v_exp_f32 v51, v51
    v_exp_f32 v52, v52
    v_exp_f32 v53, v53
    v_exp_f32 v54, v54
    v_exp_f32 v55, v55
    v_exp_f32 v56, v56
    v_exp_f32 v57, v57
    v_exp_f32 v58, v58
    v_exp_f32 v59, v59
    v_exp_f32 v60, v60
    v_exp_f32 v61, v61
    v_exp_f32 v62, v62
    v_exp_f32 v63, v63
    v_cvt_pk_bf16_f32 v80, v48, v49
    v_cvt_pk_bf16_f32 v81, v50, v51
    v_cvt_pk_bf16_f32 v82, v52, v53
    v_cvt_pk_bf16_f32 v83, v54, v55
    v_cvt_pk_bf16_f32 v84, v56, v57
    v_cvt_pk_bf16_f32 v85, v58, v59
    v_cvt_pk_bf16_f32 v86, v60, v61
    v_cvt_pk_bf16_f32 v87, v62, v63
    s_waitcnt vmcnt(1)
    v_mfma_f32_32x32x16_bf16 v[216:231], v[2:5], v[80:83], v[216:231]
    s_waitcnt vmcnt(0)
    v_mfma_f32_32x32x16_bf16 v[216:231], v[6:9], v[84:87], v[216:231]
    s_nop 11
    s_cmp_eq_u32 s67, 3
    s_cbranch_scc1 L_fb11
    s_sub_u32 s48, s46, 40960
    buffer_load_dwordx4 v[88:91], v155, s[12:15], s48 offen offset:1024 sc1
    s_mov_b64 exec, s[58:59]
    buffer_load_dwordx4 v[40:43], v156, s[12:15], s48 offen sc1
    s_mov_b64 exec, s[62:63]
    buffer_load_dwordx4 v[2:5], v154, s[12:15], s48 offen offset:0 sc1
    buffer_load_dwordx4 v[6:9], v154, s[12:15], s48 offen offset:512 sc1
    s_mov_b64 exec, -1
    s_waitcnt vmcnt(3)
    v_mfma_f32_32x32x16_bf16 v[48:63], v[88:91], v[136:139], 0
    s_waitcnt vmcnt(2)
    v_mfma_f32_32x32x8_bf16 v[48:63], v[42:43], v[146:147], v[48:63]
    s_nop 11
    v_exp_f32 v48, v48
    v_exp_f32 v49, v49
    v_exp_f32 v50, v50
    v_exp_f32 v51, v51
    v_exp_f32 v52, v52
    v_exp_f32 v53, v53
    v_exp_f32 v54, v54
    v_exp_f32 v55, v55
    v_exp_f32 v56, v56
    v_exp_f32 v57, v57
    v_exp_f32 v58, v58
    v_exp_f32 v59, v59
    v_exp_f32 v60, v60
    v_exp_f32 v61, v61
    v_exp_f32 v62, v62
    v_exp_f32 v63, v63
    v_cvt_pk_bf16_f32 v80, v48, v49
    v_cvt_pk_bf16_f32 v81, v50, v51
    v_cvt_pk_bf16_f32 v82, v52, v53
    v_cvt_pk_bf16_f32 v83, v54, v55
    v_cvt_pk_bf16_f32 v84, v56, v57
    v_cvt_pk_bf16_f32 v85, v58, v59
    v_cvt_pk_bf16_f32 v86, v60, v61
    v_cvt_pk_bf16_f32 v87, v62, v63
    s_waitcnt vmcnt(1)
    v_mfma_f32_32x32x16_bf16 v[216:231], v[2:5], v[80:83], v[216:231]
    s_waitcnt vmcnt(0)
    v_mfma_f32_32x32x16_bf16 v[216:231], v[6:9], v[84:87], v[216:231]
    s_nop 11
    s_cmp_eq_u32 s67, 4
    s_cbranch_scc1 L_fb11
    s_sub_u32 s48, s46, 51200
    buffer_load_dwordx4 v[88:91], v155, s[12:15], s48 offen offset:1024 sc1
    s_mov_b64 exec, s[58:59]
    buffer_load_dwordx4 v[40:43], v156, s[12:15], s48 offen sc1
    s_mov_b64 exec, s[62:63]
    buffer_load_dwordx4 v[2:5], v154, s[12:15], s48 offen offset:0 sc1
    buffer_load_dwordx4 v[6:9], v154, s[12:15], s48 offen offset:512 sc1
    s_mov_b64 exec, -1
    s_waitcnt vmcnt(3)
    v_mfma_f32_32x32x16_bf16 v[48:63], v[88:91], v[136:139], 0
    s_waitcnt vmcnt(2)
    v_mfma_f32_32x32x8_bf16 v[48:63], v[42:43], v[146:147], v[48:63]
    s_nop 11
    v_exp_f32 v48, v48
    v_exp_f32 v49, v49
    v_exp_f32 v50, v50
    v_exp_f32 v51, v51
    v_exp_f32 v52, v52
    v_exp_f32 v53, v53
    v_exp_f32 v54, v54
    v_exp_f32 v55, v55
    v_exp_f32 v56, v56
    v_exp_f32 v57, v57
    v_exp_f32 v58, v58
    v_exp_f32 v59, v59
    v_exp_f32 v60, v60
    v_exp_f32 v61, v61
    v_exp_f32 v62, v62
    v_exp_f32 v63, v63
    v_cvt_pk_bf16_f32 v80, v48, v49
    v_cvt_pk_bf16_f32 v81, v50, v51
    v_cvt_pk_bf16_f32 v82, v52, v53
    v_cvt_pk_bf16_f32 v83, v54, v55
    v_cvt_pk_bf16_f32 v84, v56, v57
    v_cvt_pk_bf16_f32 v85, v58, v59
    v_cvt_pk_bf16_f32 v86, v60, v61
    v_cvt_pk_bf16_f32 v87, v62, v63
    s_waitcnt vmcnt(1)
    v_mfma_f32_32x32x16_bf16 v[216:231], v[2:5], v[80:83], v[216:231]
    s_waitcnt vmcnt(0)
    v_mfma_f32_32x32x16_bf16 v[216:231], v[6:9], v[84:87], v[216:231]
    s_nop 11
    s_cmp_eq_u32 s67, 5
    s_cbranch_scc1 L_fb11
    s_sub_u32 s48, s46, 61440
    buffer_load_dwordx4 v[88:91], v155, s[12:15], s48 offen offset:1024 sc1
    s_mov_b64 exec, s[58:59]
    buffer_load_dwordx4 v[40:43], v156, s[12:15], s48 offen sc1
    s_mov_b64 exec, s[62:63]
    buffer_load_dwordx4 v[2:5], v154, s[12:15], s48 offen offset:0 sc1
    buffer_load_dwordx4 v[6:9], v154, s[12:15], s48 offen offset:512 sc1
    s_mov_b64 exec, -1
    s_waitcnt vmcnt(3)
    v_mfma_f32_32x32x16_bf16 v[48:63], v[88:91], v[136:139], 0
    s_waitcnt vmcnt(2)
    v_mfma_f32_32x32x8_bf16 v[48:63], v[42:43], v[146:147], v[48:63]
    s_nop 11
    v_exp_f32 v48, v48
    v_exp_f32 v49, v49
    v_exp_f32 v50, v50
    v_exp_f32 v51, v51
    v_exp_f32 v52, v52
    v_exp_f32 v53, v53
    v_exp_f32 v54, v54
    v_exp_f32 v55, v55
    v_exp_f32 v56, v56
    v_exp_f32 v57, v57
    v_exp_f32 v58, v58
    v_exp_f32 v59, v59
    v_exp_f32 v60, v60
    v_exp_f32 v61, v61
    v_exp_f32 v62, v62
    v_exp_f32 v63, v63
    v_cvt_pk_bf16_f32 v80, v48, v49
    v_cvt_pk_bf16_f32 v81, v50, v51
    v_cvt_pk_bf16_f32 v82, v52, v53
    v_cvt_pk_bf16_f32 v83, v54, v55
    v_cvt_pk_bf16_f32 v84, v56, v57
    v_cvt_pk_bf16_f32 v85, v58, v59
    v_cvt_pk_bf16_f32 v86, v60, v61
    v_cvt_pk_bf16_f32 v87, v62, v63
    s_waitcnt vmcnt(1)
    v_mfma_f32_32x32x16_bf16 v[216:231], v[2:5], v[80:83], v[216:231]
    s_waitcnt vmcnt(0)
    v_mfma_f32_32x32x16_bf16 v[216:231], v[6:9], v[84:87], v[216:231]
    s_nop 11
    s_cmp_eq_u32 s67, 6
    s_cbranch_scc1 L_fb11
    s_sub_u32 s48, s46, 71680
    buffer_load_dwordx4 v[88:91], v155, s[12:15], s48 offen offset:1024 sc1
    s_mov_b64 exec, s[58:59]
    buffer_load_dwordx4 v[40:43], v156, s[12:15], s48 offen sc1
    s_mov_b64 exec, s[62:63]
    buffer_load_dwordx4 v[2:5], v154, s[12:15], s48 offen offset:0 sc1
    buffer_load_dwordx4 v[6:9], v154, s[12:15], s48 offen offset:512 sc1
    s_mov_b64 exec, -1
    s_waitcnt vmcnt(3)
    v_mfma_f32_32x32x16_bf16 v[48:63], v[88:91], v[136:139], 0
    s_waitcnt vmcnt(2)
    v_mfma_f32_32x32x8_bf16 v[48:63], v[42:43], v[146:147], v[48:63]
    s_nop 11
    v_exp_f32 v48, v48
    v_exp_f32 v49, v49
    v_exp_f32 v50, v50
    v_exp_f32 v51, v51
    v_exp_f32 v52, v52
    v_exp_f32 v53, v53
    v_exp_f32 v54, v54
    v_exp_f32 v55, v55
    v_exp_f32 v56, v56
    v_exp_f32 v57, v57
    v_exp_f32 v58, v58
    v_exp_f32 v59, v59
    v_exp_f32 v60, v60
    v_exp_f32 v61, v61
    v_exp_f32 v62, v62
    v_exp_f32 v63, v63
    v_cvt_pk_bf16_f32 v80, v48, v49
    v_cvt_pk_bf16_f32 v81, v50, v51
    v_cvt_pk_bf16_f32 v82, v52, v53
    v_cvt_pk_bf16_f32 v83, v54, v55
    v_cvt_pk_bf16_f32 v84, v56, v57
    v_cvt_pk_bf16_f32 v85, v58, v59
    v_cvt_pk_bf16_f32 v86, v60, v61
    v_cvt_pk_bf16_f32 v87, v62, v63
    s_waitcnt vmcnt(1)
    v_mfma_f32_32x32x16_bf16 v[216:231], v[2:5], v[80:83], v[216:231]
    s_waitcnt vmcnt(0)
    v_mfma_f32_32x32x16_bf16 v[216:231], v[6:9], v[84:87], v[216:231]
    s_nop 11
    s_cmp_eq_u32 s67, 7
    s_cbranch_scc1 L_fb11
    s_sub_u32 s48, s46, 81920
    buffer_load_dwordx4 v[88:91], v155, s[12:15], s48 offen offset:1024 sc1
    s_mov_b64 exec, s[58:59]
    buffer_load_dwordx4 v[40:43], v156, s[12:15], s48 offen sc1
    s_mov_b64 exec, s[62:63]
    buffer_load_dwordx4 v[2:5], v154, s[12:15], s48 offen offset:0 sc1
    buffer_load_dwordx4 v[6:9], v154, s[12:15], s48 offen offset:512 sc1
    s_mov_b64 exec, -1
    s_waitcnt vmcnt(3)
    v_mfma_f32_32x32x16_bf16 v[48:63], v[88:91], v[136:139], v[184:199]
    s_waitcnt vmcnt(2)
    v_mfma_f32_32x32x8_bf16 v[48:63], v[42:43], v[146:147], v[48:63]
    s_nop 11
    v_exp_f32 v48, v48
    v_exp_f32 v49, v49
    v_exp_f32 v50, v50
    v_exp_f32 v51, v51
    v_exp_f32 v52, v52
    v_exp_f32 v53, v53
    v_exp_f32 v54, v54
    v_exp_f32 v55, v55
    v_exp_f32 v56, v56
    v_exp_f32 v57, v57
    v_exp_f32 v58, v58
    v_exp_f32 v59, v59
    v_exp_f32 v60, v60
    v_exp_f32 v61, v61
    v_exp_f32 v62, v62
    v_exp_f32 v63, v63
    v_cvt_pk_bf16_f32 v80, v48, v49
    v_cvt_pk_bf16_f32 v81, v50, v51
    v_cvt_pk_bf16_f32 v82, v52, v53
    v_cvt_pk_bf16_f32 v83, v54, v55
    v_cvt_pk_bf16_f32 v84, v56, v57
    v_cvt_pk_bf16_f32 v85, v58, v59
    v_cvt_pk_bf16_f32 v86, v60, v61
    v_cvt_pk_bf16_f32 v87, v62, v63
    s_waitcnt vmcnt(1)
    v_mfma_f32_32x32x16_bf16 v[216:231], v[2:5], v[80:83], v[216:231]
    s_waitcnt vmcnt(0)
    v_mfma_f32_32x32x16_bf16 v[216:231], v[6:9], v[84:87], v[216:231]
    s_nop 11
L_fb11:
    v_rcp_f32 v150, v228
    s_nop 1
    s_branch L_bnorm
L_g_exit:
    s_endpgm
L_g_end:
.section .rodata,"a"
.p2align 6
.amdhsa_kernel g_kernel
  .amdhsa_next_free_vgpr 256
  .amdhsa_next_free_sgpr 102
  .amdhsa_accum_offset 256
  .amdhsa_group_segment_fixed_size 0
  .amdhsa_kernarg_size 80
  .amdhsa_user_sgpr_count 2
  .amdhsa_user_sgpr_kernarg_segment_ptr 1
  .amdhsa_system_sgpr_workgroup_id_x 1
.end_amdhsa_kernel
```
